```python
import torch

def _softmax(x, axis=-1):
    return torch.softmax(x, dim=axis)
def _gelu(x):
    return torch.nn.functional.gelu(x, approximate="tanh")
def _silu(x):
    return torch.nn.functional.silu(x)
def _sigmoid(x):
    return torch.sigmoid(x)
def _layernorm(x, axis=-1, eps=1e-5):
    m = x.mean(dim=axis, keepdim=True)
    v = x.var(dim=axis, keepdim=True, unbiased=False)
    return (x - m) / torch.sqrt(v + eps)
def _scatter_add(tgt, idx, src, axis=0):
    return tgt.clone().index_add_(axis, idx, src)
def _segment_sum(src, seg, n):
    out = torch.zeros((n,) + src.shape[1:], dtype=src.dtype)
    return out.index_add_(0, seg, src)
def _pad(x, pw):
    flat = tuple(v for pair in reversed(pw) for v in pair)
    return torch.nn.functional.pad(x, flat)

kernel_name = 'standalone__self_sup_conv_stem_hubert__speech'

def setup_inputs():

    _w = (lambda a: (lambda t: t.to(torch.bfloat16) if t.is_floating_point() else t)(torch.as_tensor(a)))
    B, T, D, K = 2, 4000, 512, 31
    scale = (1.0 / (K * D)) ** 0.5
    return {
        "x": _w((lambda *s: torch.randn(*s, dtype=torch.bfloat16) * 0.05)(B, T, D)),
        "w": _w((lambda *s: torch.randn(*s, dtype=torch.bfloat16) * 0.05)(K, D, D) * scale),
        "b": _w((lambda *s: torch.randn(*s, dtype=torch.bfloat16) * 0.05)(D) * 0.1),
        "gamma": _w(torch.ones((D,), dtype=float)),
        "beta": _w(torch.zeros((D,), dtype=float)),
    }

def reference(x, w, b, gamma, beta):
    B, T, D = x.shape
    K = w.shape[0]
    s = 2
    L = (T - K) // s + 1
    y = torch.einsum('blc,cd->bld', x[:, 0 : s * L : s, :], w[0])
    for i in range(1, K):
        y = y + torch.einsum('blc,cd->bld', x[:, i : i + s * L : s, :], w[i])
    y = y + b[None, None, :]
    mu = y.mean(1, keepdims=True)
    var = ((y - mu) ** 2).mean(1, keepdims=True)
    yn = (y - mu) / torch.sqrt(var + 1e-5)
    yn = yn * gamma[None, None, :] + beta[None, None, :]
    return _gelu(yn)
```

```asm
; @launch grid=(256,1,1) block=(256,1,1) lds=161920
.amdgcn_target "amdgcn-amd-amdhsa--gfx950"
.text
.globl standalone__self_sup_conv_stem_hubert__speech_kernel
.p2align 14
.p2align 8
.type standalone__self_sup_conv_stem_hubert__speech_kernel,@function
standalone__self_sup_conv_stem_hubert__speech_kernel:
  s_getpc_b64 s[84:85]
  v_lshlrev_b32 v1, 6, v0
  v_min_u32 v1, 4096, v1
  global_load_dword v255, v1, s[84:85]
  s_cmp_ge_u32 s2, 256
  s_cbranch_scc1 L_end
  s_load_dwordx2 s[4:5], s[0:1], 0
  s_load_dwordx2 s[8:9], s[0:1], 8
  v_lshrrev_b32 v152, 6, v0
  v_and_b32 v158, 63, v0
  v_readfirstlane_b32 s28, v152
  s_mov_b32 s72, s2
  s_and_b32 s2, s72, 204
  s_and_b32 s3, s72, 32
  s_lshr_b32 s3, s3, 5
  s_or_b32 s2, s2, s3
  s_and_b32 s3, s72, 16
  s_lshr_b32 s3, s3, 3
  s_or_b32 s2, s2, s3
  s_and_b32 s3, s72, 2
  s_lshl_b32 s3, s3, 3
  s_or_b32 s2, s2, s3
  s_and_b32 s3, s72, 1
  s_lshl_b32 s3, s3, 5
  s_or_b32 s2, s2, s3
  s_and_b32 s3, s2, 7
  s_and_b32 s24, s3, 1
  s_and_b32 s25, s3, 6
  s_bfe_u32 s3, s2, 0x10003
  s_add_u32 s25, s25, s3
  s_bfe_u32 s26, s2, 0x10004
  s_lshr_b32 s27, s2, 5
  v_and_b32 v159, 15, v0
  v_lshrrev_b32 v160, 4, v158
  s_and_b32 s74, s27, 1
  s_mul_i32 s53, s74, 520192
  s_lshl_b32 s3, s74, 7
  s_add_u32 s3, s3, s53
  s_lshl_b32 s75, s28, 15
  s_add_u32 s3, s3, s75
  v_lshrrev_b32 v152, 3, v158
  v_and_b32 v153, 7, v0
  v_lshlrev_b32 v154, 4, v153
  v_lshl_add_u32 v154, v152, 12, v154
  v_add_u32 v1, s3, v154
  s_lshl_b32 s56, s53, 1
  s_sub_u32 s56, 520192, s56
  s_mul_i32 s29, s28, 1056
  s_mov_b32 s7, 0x20000
  s_mul_i32 s3, s24, 4096000
  s_add_u32 s6, s3, 4096000
  s_mul_i32 s75, s27, 520192
  s_add_u32 s63, s3, s75
  s_mul_i32 s3, s26, 2560
  s_add_u32 s33, s63, s3
  s_sub_u32 s33, s33, s53
  s_and_b32 s3, s28, 1
  s_lshr_b32 s51, s28, 1
  s_mul_i32 s32, s3, 34816
  s_mul_i32 s75, s51, 2176
  s_add_u32 s32, s32, 71808
  s_add_u32 s32, s32, s75
  v_and_b32 v154, 1, v160
  v_lshlrev_b32 v154, 1, v154
  v_xor_b32 v153, v153, v154
  s_lshl_b32 s75, s26, 2
  v_xor_b32 v153, s75, v153
  v_lshlrev_b32 v153, 4, v153
  v_lshl_add_u32 v5, v152, 10, v153
  s_lshl_b32 s74, s74, 1
  s_add_u32 s3, s3, s74
  s_lshl_b32 s3, s3, 1
  s_add_u32 s3, s3, s51
  s_lshl_b32 s3, s3, 14
  s_lshl_b32 s75, s25, 7
  s_add_u32 s3, s3, s75
  v_add_u32 v29, s3, v5
  v_add_u32 v30, 8192, v29
  s_mov_b32 s10, 16252928
  s_mov_b32 s11, 0x20000
  s_mul_i32 s41, s26, 1310720
  s_and_b32 s3, s27, 6
  s_add_u32 s3, s3, s24
  s_lshl_b32 s3, s3, 21
  s_and_b32 s75, s25, 4
  s_lshl_b32 s75, s75, 7
  s_add_u32 s3, s3, s75
  s_and_b32 s75, s27, 1
  s_lshl_b32 s75, s75, 16
  s_add_u32 s3, s3, s75
  s_and_b32 s75, s25, 3
  s_lshl_b32 s75, s75, 14
  s_add_u32 s3, s3, s75
  s_lshl_b32 s75, s28, 12
  s_add_u32 s3, s3, s75
  v_bfe_u32 v152, v0, 3, 2
  v_and_b32 v153, 7, v0
  v_lshlrev_b32 v153, 6, v153
  v_lshl_add_u32 v153, v152, 10, v153
  v_add_u32 v234, s3, v153
  s_and_b32 s3, s25, 1
  s_mul_i32 s75, s3, 17952
  s_add_u32 s54, s29, s75
  s_sub_u32 s75, 17952, s75
  s_add_u32 s55, s29, s75
  s_mul_i32 s75, s3, s56
  v_add_u32 v208, s75, v1
  s_sub_u32 s75, s56, s75
  v_add_u32 v209, s75, v1
  v_add_u32 v26, s56, v1
  s_and_b32 s3, s28, 1
  s_sub_u32 s75, s56, 32768
  s_mul_i32 s75, s75, s3
  s_mul_i32 s30, s3, 17952
  s_lshr_b32 s3, s28, 1
  s_lshl_b32 s74, s3, 30
  s_add_u32 s75, s75, s74
  v_add_u32 v2, s75, v1
  s_add_u32 s31, s30, 52800
  s_add_u32 s30, s30, 16896
  s_cmp_lg_u32 s3, 0
  s_cselect_b32 s30, 158848, s30
  s_cselect_b32 s31, 158848, s31
  s_waitcnt lgkmcnt(0)
  s_add_u32 m0, s54, 0
  s_add_u32 s51, s33, 0
  buffer_load_dwordx4 v208, s[4:7], s51 offen lds
  s_add_u32 m0, s54, 4224
  s_add_u32 s51, s33, 131072
  buffer_load_dwordx4 v208, s[4:7], s51 offen lds
  s_add_u32 m0, s54, 8448
  s_add_u32 s51, s33, 262144
  buffer_load_dwordx4 v208, s[4:7], s51 offen lds
  s_add_u32 m0, s54, 12672
  s_add_u32 s51, s33, 393216
  buffer_load_dwordx4 v208, s[4:7], s51 offen lds
  s_add_u32 m0, s32, 0
  s_add_u32 s50, s41, 0
  buffer_load_dwordx4 v29, s[8:11], s50 offen  lds
  s_add_u32 m0, s32, 1088
  s_nop 0
  buffer_load_dwordx4 v30, s[8:11], s50 offen  lds
  s_add_u32 m0, s32, 4352
  s_add_u32 s50, s41, 2097152
  buffer_load_dwordx4 v29, s[8:11], s50 offen  lds
  s_add_u32 m0, s32, 5440
  s_nop 0
  buffer_load_dwordx4 v30, s[8:11], s50 offen  lds
  s_add_u32 m0, s55, 0
  s_add_u32 s51, s33, 0
  buffer_load_dwordx4 v209, s[4:7], s51 offen lds
  s_add_u32 m0, s55, 4224
  s_add_u32 s51, s33, 131072
  buffer_load_dwordx4 v209, s[4:7], s51 offen lds
  s_add_u32 m0, s55, 8448
  s_add_u32 s51, s33, 262144
  buffer_load_dwordx4 v209, s[4:7], s51 offen lds
  s_add_u32 m0, s55, 12672
  s_add_u32 s51, s33, 393216
  buffer_load_dwordx4 v209, s[4:7], s51 offen lds
  s_mov_b32 m0, s30
  s_add_u32 s51, s33, 524288
  buffer_load_dwordx4 v2, s[4:7], s51 offen  lds
  s_add_u32 m0, s32, 8704
  s_add_u32 s50, s41, 4194304
  buffer_load_dwordx4 v29, s[8:11], s50 offen  lds
  s_add_u32 m0, s32, 9792
  s_nop 0
  buffer_load_dwordx4 v30, s[8:11], s50 offen  lds
  s_add_u32 m0, s32, 13056
  s_add_u32 s50, s41, 6291456
  buffer_load_dwordx4 v29, s[8:11], s50 offen  lds
  s_add_u32 m0, s32, 14144
  s_nop 0
  buffer_load_dwordx4 v30, s[8:11], s50 offen  lds
  buffer_load_dword v255, v234, s[8:11], s41 offen offset:0
  s_load_dwordx2 s[12:13], s[0:1], 56
  s_load_dwordx2 s[16:17], s[0:1], 40
  s_load_dwordx2 s[20:21], s[0:1], 48
  s_load_dwordx4 s[76:79], s[0:1], 16
  s_load_dwordx2 s[80:81], s[0:1], 32
  s_memrealtime s[86:87]
  s_lshr_b32 s51, s28, 1
  s_and_b32 s75, s28, 1
  v_mul_u32_u24 v152, 1056, v159
  v_lshl_add_u32 v152, v160, 4, v152
  s_mul_i32 s3, s51, 17952
  s_lshl_b32 s74, s75, 6
  s_add_u32 s3, s3, s74
  v_add_u32 v28, s3, v152
  v_mul_u32_u24 v152, 1088, v160
  v_bfe_u32 v153, v0, 2, 2
  v_lshl_add_u32 v12, v153, 7, v152
  s_mul_i32 s3, s75, 34816
  s_add_u32 s3, s3, 71808
  v_and_b32 v153, 3, v0
  v_bfe_u32 v154, v0, 3, 1
  v_lshl_add_u32 v155, v153, 3, v12
  v_lshlrev_b32 v156, 5, v154
  v_add3_u32 v10, v155, v156, s3
  v_sub_u32 v155, v155, v156
  v_add_u32 v11, s3, v155
  s_lshr_b32 s3, s72, 3
  s_lshl_b32 s3, s3, 11
  s_lshl_b32 s75, s28, 9
  s_add_u32 s3, s3, s75
  v_and_b32 v152, 3, v0
  v_lshlrev_b32 v152, 7, v152
  v_add_u32 v152, s3, v152
  v_min_u32 v152, L_end-standalone__self_sup_conv_stem_hubert__speech_kernel-8, v152
  global_load_dword v255, v152, s[84:85]
  s_lshr_b32 s3, s3, 2
  v_mov_b32 v253, s3
  s_lshl_b32 s3, s26, 10
  s_sub_u32 s3, 512, s3
  s_add_u32 s35, s33, s3
  s_lshl_b32 s75, s3, 9
  s_add_u32 s43, s41, s75
  s_lshl_b32 s51, s26, 9
  s_add_u32 s51, s51, 1024
  s_add_u32 s37, s63, s51
  s_lshl_b32 s45, s51, 9
  s_sub_u32 s37, s37, s53
  s_add_u32 s39, s37, s3
  s_add_u32 s39, s39, 2048
  s_add_u32 s47, s45, s75
  s_add_u32 s47, s47, 1048576
  s_add_u32 s34, s33, 256
  s_add_u32 s42, s41, 131072
  s_add_u32 s36, s35, 256
  s_add_u32 s44, s43, 131072
  s_add_u32 s38, s37, 256
  s_add_u32 s46, s45, 131072
  s_add_u32 s40, s39, 256
  s_add_u32 s48, s47, 131072
  s_lshl_b32 s51, s25, 3
  s_mov_b32 s54, 1250067
  s_mov_b32 s55, 320017171
  s_lshr_b64 s[54:55], s[54:55], s51
  s_and_b32 s50, s54, 255
  s_mov_b32 s54, 958796544
  s_mov_b32 s55, 1918848057
  s_lshr_b64 s[54:55], s[54:55], s51
  s_and_b32 s75, s54, 255
  v_mov_b32 v154, 1073741824
  v_cmp_gt_u32 vcc, s50, v158
  s_lshl_b32 s3, s24, 2
  s_add_u32 s3, s3, s28
  s_mul_i32 s3, s3, s50
  s_lshl_b32 s75, s75, 3
  s_add_u32 s3, s3, s75
  s_mul_i32 s3, s3, 128
  s_lshl_b32 s50, s27, 21
  s_add_u32 s3, s3, s50
  v_mul_u32_u24 v152, 128, v158
  v_add_u32 v152, s3, v152
  v_cndmask_b32 v232, v154, v152, vcc
  s_mov_b32 s54, 328965
  s_mov_b32 s55, 84215045
  s_lshr_b64 s[54:55], s[54:55], s51
  s_and_b32 s50, s54, 255
  s_mov_b32 s54, 252314880
  s_mov_b32 s55, 504960015
  s_lshr_b64 s[54:55], s[54:55], s51
  s_and_b32 s75, s54, 255
  s_lshl_b32 s3, s50, 1
  v_cmp_gt_u32 vcc, s3, v158
  s_mul_i32 s3, s28, s50
  s_lshl_b32 s75, s75, 2
  s_add_u32 s3, s3, s75
  s_lshl_b32 s3, s3, 12
  s_add_u32 s3, s3, s53
  v_and_b32 v152, 1, v0
  v_lshlrev_b32 v152, 7, v152
  v_lshrrev_b32 v153, 1, v158
  v_lshl_add_u32 v152, v153, 12, v152
  v_add_u32 v152, s3, v152
  v_cndmask_b32 v233, v154, v152, vcc
  buffer_load_dword v255, v233, s[4:7], s34 offen offset:0
  s_waitcnt vmcnt(7)
  s_waitcnt lgkmcnt(0)
  s_barrier
  ds_read_b128 v[48:51], v28 offset:0
  ds_read_b128 v[52:55], v28 offset:128
  ds_read_b128 v[56:59], v28 offset:256
  ds_read_b128 v[60:63], v28 offset:384
  ds_read_b128 v[64:67], v28 offset:512
  ds_read_b128 v[68:71], v28 offset:640
  ds_read_b128 v[72:75], v28 offset:768
  ds_read_b128 v[76:79], v28 offset:896
  ds_read_b64_tr_b16 a[128:129], v10 offset:0
  ds_read_b64_tr_b16 a[130:131], v10 offset:512
  ds_read_b64_tr_b16 a[132:133], v11 offset:32
  ds_read_b64_tr_b16 a[134:135], v11 offset:544
  ds_read_b64_tr_b16 a[136:137], v10 offset:64
  ds_read_b64_tr_b16 a[138:139], v10 offset:576
  ds_read_b64_tr_b16 a[140:141], v11 offset:96
  ds_read_b64_tr_b16 a[142:143], v11 offset:608
  ds_read_b64_tr_b16 a[144:145], v10 offset:4352
  ds_read_b64_tr_b16 a[146:147], v10 offset:4864
  ds_read_b64_tr_b16 a[148:149], v11 offset:4384
  ds_read_b64_tr_b16 a[150:151], v11 offset:4896
  ds_read_b64_tr_b16 a[152:153], v10 offset:4416
  ds_read_b64_tr_b16 a[154:155], v10 offset:4928
  ds_read_b64_tr_b16 a[156:157], v11 offset:4448
  ds_read_b64_tr_b16 a[158:159], v11 offset:4960
  s_waitcnt lgkmcnt(15)
  s_waitcnt lgkmcnt(14)
  v_mfma_f32_16x16x32_bf16 a[0:3], a[128:131], v[48:51], 0
  s_mov_b32 s22, 256
  s_mov_b32 s23, 0x20000
  s_add_u32 m0, s32, 17408
  s_waitcnt lgkmcnt(6)
  v_mfma_f32_16x16x32_bf16 a[0:3], a[144:147], v[52:55], a[0:3]
  s_add_u32 s50, s41, 8388608
  v_cmp_eq_u32 vcc, 0, v0
  s_waitcnt lgkmcnt(4)
  v_mfma_f32_16x16x32_bf16 a[4:7], a[148:151], v[52:55], 0
  s_or_b32 s86, s86, 1
  buffer_load_dwordx4 v29, s[8:11], s50 offen  lds
  v_mfma_f32_16x16x32_bf16 a[4:7], a[132:135], v[48:51], a[4:7]
  v_mov_b32 v153, 1073741824
  v_mov_b32 v242, s86
  v_mfma_f32_16x16x32_bf16 a[8:11], a[136:139], v[48:51], 0
  s_cmp_eq_u32 s2, 0
  s_cselect_b32 s3, 0, 1073741824
  s_waitcnt lgkmcnt(2)
  v_mov_b32 v243, s87
  v_cndmask_b32 v19, v153, 0, vcc
  v_or_b32 v244, s3, v19
  v_mfma_f32_16x16x32_bf16 a[8:11], a[152:155], v[52:55], a[8:11]
  buffer_store_dwordx2 v[242:243], v244, s[20:23], 0 offen sc1
  s_mov_b32 s14, 67108864
  s_waitcnt lgkmcnt(0)
  v_mfma_f32_16x16x32_bf16 a[12:15], a[156:159], v[52:55], 0
  s_mov_b32 s15, 0x20000
  s_mov_b32 s19, 0x20000
  s_add_u32 m0, s32, 18496
  v_mfma_f32_16x16x32_bf16 a[12:15], a[140:143], v[48:51], a[12:15]
  s_lshr_b32 s3, s28, 1
  s_lshl_b32 s74, s3, 30
  buffer_load_dwordx4 v30, s[8:11], s50 offen  lds
  v_mfma_f32_16x16x32_bf16 a[28:31], a[140:143], v[52:55], 0
  s_lshl_b32 s57, s25, 1
  s_add_u32 s57, s57, s26
  v_mfma_f32_16x16x32_bf16 a[28:31], a[156:159], v[56:59], a[28:31]
  ds_read_b128 v[80:83], v28 offset:1056
  s_lshl_b32 s58, s24, 3
  v_mfma_f32_16x16x32_bf16 a[24:27], a[152:155], v[56:59], 0
  s_add_u32 s58, s58, s27
  s_add_u32 m0, s32, 21760
  v_mul_u32_u24 v152, 2080, v159
  v_mfma_f32_16x16x32_bf16 a[24:27], a[136:139], v[52:55], a[24:27]
  s_lshl_b32 s3, s28, 6
  s_add_u32 s50, s41, 10485760
  v_lshl_add_u32 v152, v160, 4, v152
  v_mfma_f32_16x16x32_bf16 a[20:23], a[132:135], v[52:55], 0
  v_add_u32 v9, s3, v152
  s_and_b32 s3, s27, 1
  v_mfma_f32_16x16x32_bf16 a[20:23], a[148:151], v[56:59], a[20:23]
  buffer_load_dwordx4 v29, s[8:11], s50 offen  lds
  s_lshl_b32 s3, s3, 1
  v_mfma_f32_16x16x32_bf16 a[16:19], a[144:147], v[56:59], 0
  s_and_b32 s62, s28, 1
  s_add_u32 s62, s62, s3
  s_and_b32 s3, s27, 6
  v_mfma_f32_16x16x32_bf16 a[16:19], a[128:131], v[52:55], a[16:19]
  s_lshr_b32 s61, s28, 1
  s_add_u32 s61, s61, s3
  v_mfma_f32_16x16x32_bf16 a[32:35], a[128:131], v[56:59], 0
  s_lshl_b32 s3, s62, 15
  s_lshl_b32 s75, s25, 7
  s_add_u32 m0, s32, 22848
  v_mfma_f32_16x16x32_bf16 a[32:35], a[144:147], v[60:63], a[32:35]
  s_add_u32 s3, s3, s75
  buffer_load_dwordx4 v30, s[8:11], s50 offen  lds
  v_mfma_f32_16x16x32_bf16 a[36:39], a[148:151], v[60:63], 0
  v_add_u32 v5, s3, v5
  v_add_u32 v6, 8192, v5
  v_mfma_f32_16x16x32_bf16 a[36:39], a[132:135], v[56:59], a[36:39]
  v_add_u32 v7, 16384, v5
  v_add_u32 v8, 24576, v5
  v_mfma_f32_16x16x32_bf16 a[40:43], a[136:139], v[56:59], 0
  s_add_u32 m0, s32, 26112
  v_and_b32 v153, 3, v0
  v_bfe_u32 v154, v0, 3, 1
  v_mfma_f32_16x16x32_bf16 a[40:43], a[152:155], v[60:63], a[40:43]
  s_add_u32 s50, s41, 12582912
  v_lshlrev_b32 v154, 1, v154
  v_xor_b32 v153, v153, v154
  v_mfma_f32_16x16x32_bf16 a[44:47], a[156:159], v[60:63], 0
  s_mul_i32 s3, s28, 4352
  s_add_u32 s3, s3, 141440
  v_lshl_add_u32 v12, v153, 4, v12
  v_mfma_f32_16x16x32_bf16 a[44:47], a[140:143], v[56:59], a[44:47]
  buffer_load_dwordx4 v29, s[8:11], s50 offen  lds
  v_add_u32 v12, s3, v12
  v_mfma_f32_16x16x32_bf16 a[60:63], a[140:143], v[60:63], 0
  s_lshl_b32 s3, s28, 10
  v_lshlrev_b32 v157, 4, v158
  v_add_u32 v4, s3, v157
  v_mfma_f32_16x16x32_bf16 a[60:63], a[156:159], v[64:67], a[60:63]
  v_add_u32 v3, s3, v4
  v_add_u32 v4, s74, v4
  v_mfma_f32_16x16x32_bf16 a[56:59], a[152:155], v[64:67], 0
  s_mul_i32 s49, s58, 278528
  s_add_u32 s49, s49, 8388608
  s_add_u32 m0, s32, 27200
  v_mfma_f32_16x16x32_bf16 a[56:59], a[136:139], v[60:63], a[56:59]
  s_lshl_b32 s3, s28, 11
  buffer_load_dwordx4 v30, s[8:11], s50 offen  lds
  v_add_u32 v152, s3, v157
  v_mfma_f32_16x16x32_bf16 a[52:55], a[132:135], v[60:63], 0
  s_lshl_b32 s3, s57, 19
  v_add_u32 v13, s3, v152
  v_mfma_f32_16x16x32_bf16 a[52:55], a[148:151], v[64:67], a[52:55]
  s_lshl_b32 s74, s26, 1
  s_add_u32 s74, s74, s24
  v_mfma_f32_16x16x32_bf16 a[48:51], a[144:147], v[64:67], 0
  s_lshl_b32 s3, s74, 16
  s_lshl_b32 s75, s61, 13
  s_add_u32 m0, s32, 30464
  v_mfma_f32_16x16x32_bf16 a[48:51], a[128:131], v[60:63], a[48:51]
  s_add_u32 s3, s3, s75
  s_lshl_b32 s75, s25, 20
  s_add_u32 s50, s41, 14680064
  v_mfma_f32_16x16x32_bf16 a[64:67], a[128:131], v[64:67], 0
  s_waitcnt vmcnt(10)
  s_barrier
  s_add_u32 s3, s3, s75
  v_mfma_f32_16x16x32_bf16 a[64:67], a[144:147], v[68:71], a[64:67]
  buffer_load_dwordx4 v29, s[8:11], s50 offen  lds
  ds_read_b64_tr_b16 a[160:161], v10 offset:8704
  v_mfma_f32_16x16x32_bf16 a[68:71], a[148:151], v[68:71], 0
  s_lshl_b32 s75, s62, 11
  ds_read_b64_tr_b16 a[162:163], v10 offset:9216
  ds_read_b128 v[84:87], v28 offset:1184
  v_mfma_f32_16x16x32_bf16 a[68:71], a[132:135], v[64:67], a[68:71]
  ds_read_b64_tr_b16 a[164:165], v11 offset:8736
  s_add_u32 s3, s3, s75
  v_mfma_f32_16x16x32_bf16 a[72:75], a[136:139], v[64:67], 0
  s_add_u32 m0, s32, 31552
  ds_read_b64_tr_b16 a[166:167], v11 offset:9248
  v_add_u32 v14, s3, v157
  v_mfma_f32_16x16x32_bf16 a[72:75], a[152:155], v[68:71], a[72:75]
  s_mov_b32 s52, 0
  ds_read_b64_tr_b16 a[168:169], v10 offset:8768
  buffer_load_dwordx4 v30, s[8:11], s50 offen  lds
  v_mfma_f32_16x16x32_bf16 a[76:79], a[156:159], v[68:71], 0
  ds_read_b64_tr_b16 a[170:171], v10 offset:9280
  s_lshl_b32 s74, s74, 17
  v_mfma_f32_16x16x32_bf16 a[76:79], a[140:143], v[64:67], a[76:79]
  ds_read_b64_tr_b16 a[172:173], v11 offset:8800
  s_lshl_b32 s3, s61, 21
  v_mfma_f32_16x16x32_bf16 a[92:95], a[140:143], v[68:71], 0
  s_add_u32 s53, s3, s74
  ds_read_b64_tr_b16 a[174:175], v11 offset:9312
  s_add_u32 m0, s29, 35904
  v_mfma_f32_16x16x32_bf16 a[92:95], a[156:159], v[72:75], a[92:95]
  s_add_u32 s54, s53, 1048576
  s_lshl_b32 s3, s26, 20
  s_add_u32 s51, s34, 0
  v_mfma_f32_16x16x32_bf16 a[88:91], a[152:155], v[72:75], 0
  s_add_u32 s56, s53, 1572864
  s_sub_u32 s56, s56, s3
  buffer_load_dwordx4 v1, s[4:7], s51 offen  lds
  v_mfma_f32_16x16x32_bf16 a[88:91], a[136:139], v[68:71], a[88:91]
  ds_read_b64_tr_b16 a[176:177], v10 offset:13056
  s_sub_u32 s55, s56, 1048576
  v_mfma_f32_16x16x32_bf16 a[84:87], a[132:135], v[68:71], 0
  s_cmp_lt_i32 s55, 0
  ds_read_b64_tr_b16 a[178:179], v10 offset:13568
  s_cselect_b32 s55, 1073741824, s55
  v_mfma_f32_16x16x32_bf16 a[84:87], a[148:151], v[72:75], a[84:87]
  ds_read_b64_tr_b16 a[180:181], v11 offset:13088
  s_and_b32 s75, s27, 6
  v_mfma_f32_16x16x32_bf16 a[80:83], a[144:147], v[72:75], 0
  ds_read_b64_tr_b16 a[182:183], v11 offset:13600
  s_add_u32 s75, s75, s24
  v_mfma_f32_16x16x32_bf16 a[80:83], a[128:131], v[68:71], a[80:83]
  s_lshl_b32 s75, s75, 13
  ds_read_b64_tr_b16 a[184:185], v10 offset:13120
  buffer_load_dword v255, v234, s[8:11], s42 offen offset:0
  v_mfma_f32_16x16x32_bf16 a[96:99], a[128:131], v[72:75], 0
  ds_read_b64_tr_b16 a[186:187], v10 offset:13632
  s_lshl_b32 s3, s57, 19
  v_mfma_f32_16x16x32_bf16 a[96:99], a[144:147], v[76:79], a[96:99]
  ds_read_b64_tr_b16 a[188:189], v11 offset:13152
  s_add_u32 s3, s3, s75
  v_mfma_f32_16x16x32_bf16 a[100:103], a[148:151], v[76:79], 0
  s_lshl_b32 s75, s28, 11
  ds_read_b64_tr_b16 a[190:191], v11 offset:13664
  s_add_u32 m0, s32, 0
  v_mfma_f32_16x16x32_bf16 a[100:103], a[132:135], v[72:75], a[100:103]
  s_add_u32 s3, s3, s75
  s_and_b32 s75, s25, 3
  s_add_u32 s50, s42, 0
  v_mfma_f32_16x16x32_bf16 a[104:107], a[136:139], v[72:75], 0
  s_lshl_b32 s75, s75, 2
  s_add_u32 s75, s75, s28
  buffer_load_dwordx4 v29, s[8:11], s50 offen  lds
  v_mfma_f32_16x16x32_bf16 a[104:107], a[152:155], v[76:79], a[104:107]
  s_mul_i32 s75, s75, 2176
  s_add_u32 s75, s75, s49
  v_mfma_f32_16x16x32_bf16 a[108:111], a[156:159], v[76:79], 0
  s_sub_u32 s75, s75, 2048
  v_cmp_gt_u32 vcc, 33, v158
  v_mfma_f32_16x16x32_bf16 a[108:111], a[140:143], v[72:75], a[108:111]
  s_add_u32 m0, s29, 40128
  v_mov_b32 v153, s3
  v_mov_b32 v154, s75
  v_mfma_f32_16x16x32_bf16 a[124:127], a[140:143], v[76:79], 0
  s_add_u32 s51, s34, 131072
  s_waitcnt lgkmcnt(15)
  v_mov_b32 v155, 1073741824
  v_cndmask_b32 v154, v155, v154, vcc
  v_mfma_f32_16x16x32_bf16 a[124:127], a[156:159], v[80:83], a[124:127]
  v_cmp_gt_u32 vcc, 16, v158
  v_mov_b32 v156, 34816
  v_mfma_f32_16x16x32_bf16 a[120:123], a[152:155], v[80:83], 0
  buffer_load_dwordx4 v1, s[4:7], s51 offen  lds
  v_mov_b32 v155, 65536
  v_mfma_f32_16x16x32_bf16 a[120:123], a[136:139], v[76:79], a[120:123]
  v_cndmask_b32 v154, v154, v153, vcc
  v_cndmask_b32 v235, v156, v155, vcc
  v_mfma_f32_16x16x32_bf16 a[116:119], a[132:135], v[76:79], 0
  ds_read_b128 v[88:91], v28 offset:1312
  v_lshl_add_u32 v254, v158, 7, v154
  v_mfma_f32_16x16x32_bf16 a[116:119], a[148:151], v[80:83], a[116:119]
  s_lshl_b32 s3, s28, 3
  s_add_u32 m0, s32, 1088
  v_lshrrev_b32 v152, 3, v158
  v_mfma_f32_16x16x32_bf16 a[112:115], a[144:147], v[80:83], 0
  buffer_load_dwordx4 v30, s[8:11], s50 offen  lds
  v_add_u32 v152, s3, v152
  v_mfma_f32_16x16x32_bf16 a[112:115], a[128:131], v[76:79], a[112:115]
  v_and_b32 v153, 7, v0
  v_lshlrev_b32 v153, 4, v153
  v_mfma_f32_16x16x32_bf16 a[0:3], a[160:163], v[56:59], a[0:3]
  s_lshl_b32 s3, s28, 1
  s_add_u32 s3, s3, s26
  s_waitcnt lgkmcnt(7)
  v_mfma_f32_16x16x32_bf16 a[0:3], a[176:179], v[60:63], a[0:3]
  s_cmp_lg_u32 s3, 1
  s_cselect_b32 s3, 1073741824, 0
  s_add_u32 m0, s32, 4352
  s_waitcnt lgkmcnt(5)
  v_lshl_add_u32 v15, v152, 12, v153
  v_lshl_add_u32 v17, v152, 8, v153
  v_add_u32 v16, s3, v15
  v_mfma_f32_16x16x32_bf16 a[4:7], a[180:183], v[60:63], a[4:7]
  v_add_u32 v18, s3, v17
  s_lshl_b32 s3, s25, 7
  s_add_u32 s50, s42, 2097152
  v_mfma_f32_16x16x32_bf16 a[4:7], a[164:167], v[56:59], a[4:7]
  s_add_u32 s61, s63, s3
  s_lshl_b32 s3, s26, 18
  buffer_load_dwordx4 v29, s[8:11], s50 offen  lds
  v_mfma_f32_16x16x32_bf16 a[8:11], a[168:171], v[56:59], a[8:11]
  s_add_u32 s61, s61, s3
  s_add_u32 s61, s61, 2048
  s_waitcnt lgkmcnt(3)
  v_mfma_f32_16x16x32_bf16 a[8:11], a[184:187], v[60:63], a[8:11]
  s_xor_b32 s74, s25, 0
  s_lshr_b32 s3, s74, 1
  s_waitcnt lgkmcnt(1)
  v_mfma_f32_16x16x32_bf16 a[12:15], a[188:191], v[60:63], a[12:15]
  s_mul_i32 s3, s3, 34816
  s_add_u32 s62, s49, s3
  s_add_u32 m0, s29, 44352
  v_mfma_f32_16x16x32_bf16 a[12:15], a[172:175], v[56:59], a[12:15]
  s_and_b32 s3, s74, 1
  s_lshl_b32 s3, s3, 7
  s_add_u32 s51, s34, 262144
  v_mfma_f32_16x16x32_bf16 a[28:31], a[172:175], v[60:63], a[28:31]
  s_add_u32 s62, s62, s3
  s_lshl_b32 s3, s26, 14
  buffer_load_dwordx4 v1, s[4:7], s51 offen  lds
  v_mfma_f32_16x16x32_bf16 a[28:31], a[188:191], v[64:67], a[28:31]
  s_add_u32 s62, s62, s3
  s_mul_i32 s74, s28, 21760
  v_mfma_f32_16x16x32_bf16 a[24:27], a[184:187], v[64:67], a[24:27]
  s_add_u32 s74, s74, 71808
  v_add_u32 v23, s74, v157
  v_mfma_f32_16x16x32_bf16 a[24:27], a[168:171], v[60:63], a[24:27]
  s_lshl_b32 s3, s26, 12
  v_add_u32 v32, s3, v23
  v_mfma_f32_16x16x32_bf16 a[20:23], a[164:167], v[60:63], a[20:23]
  s_xor_b32 s3, s3, 4096
  s_add_u32 m0, s32, 5440
  v_add_u32 v34, s3, v23
  v_mfma_f32_16x16x32_bf16 a[20:23], a[180:183], v[64:67], a[20:23]
  s_lshl_b32 s3, s28, 12
  s_add_u32 s75, s3, 71808
  v_mfma_f32_16x16x32_bf16 a[16:19], a[176:179], v[64:67], a[16:19]
  buffer_load_dwordx4 v30, s[8:11], s50 offen  lds
  v_add_u32 v21, s75, v157
  v_mfma_f32_16x16x32_bf16 a[16:19], a[160:163], v[60:63], a[16:19]
  s_mul_i32 s75, s28, 6144
  s_add_u32 s75, s75, 16777216
  v_add_u32 v22, 43520, v21
  v_mfma_f32_16x16x32_bf16 a[32:35], a[160:163], v[64:67], a[32:35]
  s_add_u32 m0, s29, 48576
  v_add_u32 v24, s75, v157
  v_lshlrev_b32 v152, 9, v160
  v_mfma_f32_16x16x32_bf16 a[32:35], a[176:179], v[68:71], a[32:35]
  s_add_u32 s51, s34, 393216
  v_lshl_add_u32 v153, v159, 4, v152
  v_add_u32 v25, s74, v153
  v_mfma_f32_16x16x32_bf16 a[36:39], a[180:183], v[68:71], a[36:39]
  buffer_load_dwordx4 v1, s[4:7], s51 offen  lds
  v_add_u32 v31, 71808, v152
  v_mfma_f32_16x16x32_bf16 a[36:39], a[164:167], v[64:67], a[36:39]
  v_and_b32 v154, 31, v0
  v_lshrrev_b32 v155, 2, v154
  v_mfma_f32_16x16x32_bf16 a[40:43], a[168:171], v[64:67], a[40:43]
  s_waitcnt vmcnt(13)
  s_barrier
  v_mfma_f32_16x16x32_bf16 a[40:43], a[184:187], v[68:71], a[40:43]
  s_add_u32 m0, s32, 8704
  ds_read_b64_tr_b16 a[128:129], v10 offset:17408
  v_lshlrev_b32 v155, 8, v155
  v_mfma_f32_16x16x32_bf16 a[44:47], a[188:191], v[68:71], a[44:47]
  s_add_u32 s50, s42, 4194304
  ds_read_b64_tr_b16 a[130:131], v10 offset:17920
  ds_read_b128 v[92:95], v28 offset:1440
  v_mfma_f32_16x16x32_bf16 a[44:47], a[172:175], v[64:67], a[44:47]
  ds_read_b64_tr_b16 a[132:133], v11 offset:17440
  buffer_load_dwordx4 v29, s[8:11], s50 offen  lds
  v_mfma_f32_16x16x32_bf16 a[60:63], a[172:175], v[68:71], a[60:63]
  s_mov_b32 s3, 4294902032
  ds_read_b64_tr_b16 a[134:135], v11 offset:17952
  v_and_b32 v156, 3, v0
  v_mfma_f32_16x16x32_bf16 a[60:63], a[188:191], v[72:75], a[60:63]
  s_cmp_lt_u32 s28, 3
  ds_read_b64_tr_b16 a[136:137], v10 offset:17472
  s_cselect_b32 s3, 21760, s3
  v_mfma_f32_16x16x32_bf16 a[56:59], a[184:187], v[72:75], a[56:59]
  ds_read_b64_tr_b16 a[138:139], v10 offset:17984
  v_lshl_add_u32 v155, v156, 2, v155
  v_add_u32 v33, 71808, v155
  v_add_u32 v27, s3, v25
  v_mfma_f32_16x16x32_bf16 a[56:59], a[168:171], v[68:71], a[56:59]
  s_lshl_b32 s3, s24, 4
  ds_read_b64_tr_b16 a[140:141], v11 offset:17504
  s_add_u32 m0, s32, 9792
  v_mfma_f32_16x16x32_bf16 a[52:55], a[164:167], v[68:71], a[52:55]
  s_add_u32 s3, s3, s57
  ds_read_b64_tr_b16 a[142:143], v11 offset:18016
  buffer_load_dwordx4 v30, s[8:11], s50 offen  lds
  v_mfma_f32_16x16x32_bf16 a[52:55], a[180:183], v[72:75], a[52:55]
  s_lshl_b32 s3, s3, 11
  s_add_u32 s3, s3, 31522816
  v_mfma_f32_16x16x32_bf16 a[48:51], a[176:179], v[72:75], a[48:51]
  v_lshlrev_b32 v155, 3, v154
  v_bfe_u32 v156, v0, 5, 1
  v_mfma_f32_16x16x32_bf16 a[48:51], a[160:163], v[68:71], a[48:51]
  s_add_u32 m0, s29, 53856
  ds_read_b64_tr_b16 a[144:145], v10 offset:21760
  v_lshl_add_u32 v153, v156, 10, v155
  v_mfma_f32_16x16x32_bf16 a[64:67], a[160:163], v[72:75], a[64:67]
  s_add_u32 s51, s34, 0
  ds_read_b64_tr_b16 a[146:147], v10 offset:22272
  v_add_u32 v36, s3, v153
  v_mfma_f32_16x16x32_bf16 a[64:67], a[176:179], v[76:79], a[64:67]
  s_lshl_b32 s75, s27, 8
  ds_read_b64_tr_b16 a[148:149], v11 offset:21792
  buffer_load_dwordx4 v26, s[4:7], s51 offen  lds
  v_mfma_f32_16x16x32_bf16 a[68:71], a[180:183], v[76:79], a[68:71]
  ds_read_b64_tr_b16 a[150:151], v11 offset:22304
  s_add_u32 s3, s3, s75
  v_mfma_f32_16x16x32_bf16 a[68:71], a[164:167], v[72:75], a[68:71]
  ds_read_b64_tr_b16 a[152:153], v10 offset:21824
  v_add_u32 v155, s3, v155
  v_mfma_f32_16x16x32_bf16 a[72:75], a[168:171], v[72:75], a[72:75]
  s_add_u32 m0, s32, 13056
  ds_read_b64_tr_b16 a[154:155], v10 offset:22336
  v_mov_b32 v153, 1073741824
  v_mfma_f32_16x16x32_bf16 a[72:75], a[184:187], v[76:79], a[72:75]
  s_add_u32 s50, s42, 6291456
  ds_read_b64_tr_b16 a[156:157], v11 offset:21856
  v_cmp_gt_u32 vcc, 32, v0
  v_mfma_f32_16x16x32_bf16 a[76:79], a[188:191], v[76:79], a[76:79]
  s_lshl_b32 s3, s2, 6
  ds_read_b64_tr_b16 a[158:159], v11 offset:22368
  buffer_load_dwordx4 v29, s[8:11], s50 offen  lds
  v_mfma_f32_16x16x32_bf16 a[76:79], a[172:175], v[72:75], a[76:79]
  s_add_u32 s3, s3, 31465472
  v_cndmask_b32 v35, v153, v155, vcc
  v_mfma_f32_16x16x32_bf16 a[92:95], a[172:175], v[76:79], a[92:95]
  v_cmp_eq_u32 vcc, 0, v0
  v_mov_b32 v155, s3
  v_mfma_f32_16x16x32_bf16 a[92:95], a[188:191], v[80:83], a[92:95]
  v_min_u32 v38, 2, v158
  v_lshl_add_u32 v38, v38, 4, 16
  v_mfma_f32_16x16x32_bf16 a[88:91], a[184:187], v[80:83], a[88:91]
  s_add_u32 m0, s32, 14144
  v_cndmask_b32 v37, v153, v155, vcc
  v_xor_b32 v38, s2, v38
  v_mfma_f32_16x16x32_bf16 a[88:91], a[168:171], v[76:79], a[88:91]
  buffer_load_dwordx4 v30, s[8:11], s50 offen  lds
  v_lshlrev_b32 v38, 6, v38
  v_mfma_f32_16x16x32_bf16 a[84:87], a[164:167], v[76:79], a[84:87]
  s_lshl_b32 s3, s25, 9
  s_add_u32 s3, s3, 31457280
  v_add_u32 v38, 31465472, v38
  v_mfma_f32_16x16x32_bf16 a[84:87], a[180:183], v[80:83], a[84:87]
  s_lshl_b32 s75, s58, 8
  s_add_u32 s75, s75, 31461376
  v_mfma_f32_16x16x32_bf16 a[80:83], a[176:179], v[80:83], a[80:83]
  v_lshlrev_b32 v155, 4, v154
  v_add_u32 v155, s3, v155
  v_mfma_f32_16x16x32_bf16 a[80:83], a[160:163], v[76:79], a[80:83]
  ds_read_b128 v[96:99], v28 offset:1568
  v_cmp_gt_u32 vcc, 32, v158
  v_mfma_f32_16x16x32_bf16 a[96:99], a[160:163], v[80:83], a[96:99]
  buffer_load_dword v255, v233, s[4:7], s35 offen offset:0
  v_lshlrev_b32 v20, 4, v159
  v_mfma_f32_16x16x32_bf16 a[96:99], a[176:179], v[84:87], a[96:99]
  s_lshl_b32 s74, s57, 4
  v_add_u32 v20, s75, v20
  v_cndmask_b32 v20, v20, v155, vcc
  v_mfma_f32_16x16x32_bf16 a[100:103], a[180:183], v[84:87], a[100:103]
  s_add_u32 s75, s75, s74
  s_lshl_b32 s74, s27, 1
  v_mfma_f32_16x16x32_bf16 a[100:103], a[164:167], v[80:83], a[100:103]
  s_add_u32 s74, s74, s26
  s_lshl_b32 s74, s74, 1
  s_add_u32 m0, s29, 58080
  v_mfma_f32_16x16x32_bf16 a[104:107], a[168:171], v[80:83], a[104:107]
  s_add_u32 s74, s74, s24
  s_lshl_b32 s74, s74, 4
  s_add_u32 s51, s34, 131072
  v_mfma_f32_16x16x32_bf16 a[104:107], a[184:187], v[84:87], a[104:107]
  s_add_u32 s3, s3, s74
  v_cmp_eq_u32 vcc, 1, v0
  v_mfma_f32_16x16x32_bf16 a[108:111], a[188:191], v[84:87], a[108:111]
  buffer_load_dwordx4 v26, s[4:7], s51 offen  lds
  v_add_u32 v245, s3, v19
  v_mfma_f32_16x16x32_bf16 a[108:111], a[172:175], v[80:83], a[108:111]
  v_mov_b32 v155, s75
  v_cndmask_b32 v245, v245, v155, vcc
  v_cmp_eq_u32 vcc, 1, v156
  v_mfma_f32_16x16x32_bf16 a[124:127], a[172:175], v[84:87], a[124:127]
  s_waitcnt lgkmcnt(15)
  v_mov_b32 v153, 0x3e0307de
  v_mov_b32 v155, 0x3dd591dd
  v_mfma_f32_16x16x32_bf16 a[124:127], a[188:191], v[88:91], a[124:127]
  s_lshl_b32 s3, s28, 8
  v_cndmask_b32 v44, v153, v155, vcc
  v_mfma_f32_16x16x32_bf16 a[120:123], a[184:187], v[88:91], a[120:123]
  s_add_u32 m0, s29, 62304
  v_lshrrev_b32 v153, 2, v159
  v_lshlrev_b32 v153, 4, v153
  v_mfma_f32_16x16x32_bf16 a[120:123], a[168:171], v[84:87], a[120:123]
  s_add_u32 s75, s3, 159872
  s_add_u32 s51, s34, 262144
  v_lshl_add_u32 v153, v160, 6, v153
  v_mfma_f32_16x16x32_bf16 a[116:119], a[164:167], v[84:87], a[116:119]
  buffer_load_dwordx4 v26, s[4:7], s51 offen  lds
  v_add_u32 v39, s75, v153
  v_mfma_f32_16x16x32_bf16 a[116:119], a[180:183], v[88:91], a[116:119]
  v_lshrrev_b32 v153, 3, v154
  v_lshlrev_b32 v153, 6, v153
  v_mfma_f32_16x16x32_bf16 a[112:115], a[176:179], v[88:91], a[112:115]
  v_and_b32 v155, 7, v0
  v_lshl_add_u32 v153, v155, 2, v153
  v_mfma_f32_16x16x32_bf16 a[112:115], a[160:163], v[84:87], a[112:115]
  s_mov_b32 s75, 160896
  v_add_u32 v40, 159872, v153
  v_lshlrev_b32 v153, 2, v154
  v_mfma_f32_16x16x32_bf16 a[0:3], a[128:131], v[64:67], a[0:3]
  s_waitcnt lgkmcnt(7)
  v_add_u32 v41, s75, v153
  v_lshlrev_b32 v153, 5, v160
  v_mfma_f32_16x16x32_bf16 a[0:3], a[144:147], v[68:71], a[0:3]
  s_lshl_b32 s3, s28, 2
  s_waitcnt lgkmcnt(5)
  v_add_u32 v42, s75, v153
  v_mfma_f32_16x16x32_bf16 a[4:7], a[148:151], v[68:71], a[4:7]
  v_lshlrev_b32 v153, 4, v159
  v_add_u32 v153, s3, v153
  v_mfma_f32_16x16x32_bf16 a[4:7], a[132:135], v[64:67], a[4:7]
  v_lshlrev_b32 v155, 4, v160
  v_lshl_add_u32 v43, v153, 10, v155
  v_mfma_f32_16x16x32_bf16 a[8:11], a[136:139], v[64:67], a[8:11]
  s_cmp_eq_u32 s27, 7
  s_mov_b32 s75, 254
  s_mov_b32 s73, 0x3b810204
  s_cselect_b32 s75, 207, s75
  s_cselect_b32 s73, 0x3b9e4cad, s73
  s_waitcnt lgkmcnt(3)
  v_add_u32 v155, 0, v153
  v_mfma_f32_16x16x32_bf16 a[8:11], a[152:155], v[68:71], a[8:11]
  v_cmp_gt_u32 s[64:65], s75, v155
  s_waitcnt lgkmcnt(1)
  v_add_u32 v155, 1, v153
  v_mfma_f32_16x16x32_bf16 a[12:15], a[156:159], v[68:71], a[12:15]
  v_cmp_gt_u32 s[66:67], s75, v155
  v_add_u32 v155, 2, v153
  v_mfma_f32_16x16x32_bf16 a[12:15], a[140:143], v[64:67], a[12:15]
  v_cmp_gt_u32 s[68:69], s75, v155
  v_add_u32 v155, 3, v153
  v_mfma_f32_16x16x32_bf16 a[28:31], a[140:143], v[68:71], a[28:31]
  s_waitcnt vmcnt(17)
  s_barrier
  v_cmp_gt_u32 s[70:71], s75, v155
  v_mfma_f32_16x16x32_bf16 a[28:31], a[156:159], v[72:75], a[28:31]
  s_add_u32 m0, s29, 66528
  ds_read_b64_tr_b16 a[160:161], v10 offset:26112
  ds_read_b128 v[100:103], v28 offset:1696
  v_mfma_f32_16x16x32_bf16 a[24:27], a[152:155], v[72:75], a[24:27]
  s_add_u32 s51, s34, 393216
  s_mul_i32 s3, s24, 1985
  ds_read_b64_tr_b16 a[162:163], v10 offset:26624
  buffer_load_dwordx4 v26, s[4:7], s51 offen  lds
  v_mfma_f32_16x16x32_bf16 a[24:27], a[136:139], v[68:71], a[24:27]
  ds_read_b64_tr_b16 a[164:165], v11 offset:26144
  s_mul_i32 s74, s27, 254
  v_mfma_f32_16x16x32_bf16 a[20:23], a[132:135], v[68:71], a[20:23]
  ds_read_b64_tr_b16 a[166:167], v11 offset:26656
  s_add_u32 s3, s3, s74
  v_mfma_f32_16x16x32_bf16 a[20:23], a[148:151], v[72:75], a[20:23]
  s_add_u32 s75, s75, s3
  ds_read_b64_tr_b16 a[168:169], v10 offset:26176
  s_add_u32 m0, s32, 17408
  v_mfma_f32_16x16x32_bf16 a[16:19], a[144:147], v[72:75], a[16:19]
  s_lshl_b32 s18, s75, 10
  ds_read_b64_tr_b16 a[170:171], v10 offset:26688
  s_add_u32 s50, s42, 8388608
  v_mfma_f32_16x16x32_bf16 a[16:19], a[128:131], v[68:71], a[16:19]
  s_lshl_b32 s3, s3, 10
  ds_read_b64_tr_b16 a[172:173], v11 offset:26208
  buffer_load_dwordx4 v29, s[8:11], s50 offen  lds
  v_mfma_f32_16x16x32_bf16 a[32:35], a[128:131], v[72:75], a[32:35]
  ds_read_b64_tr_b16 a[174:175], v11 offset:26720
  s_lshl_b32 s74, s57, 6
  v_mfma_f32_16x16x32_bf16 a[32:35], a[144:147], v[76:79], a[32:35]
  s_add_u32 s72, s3, s74
  v_lshlrev_b32 v153, 1, v154
  v_mfma_f32_16x16x32_bf16 a[36:39], a[148:151], v[76:79], a[36:39]
  s_lshl_b32 s3, s26, 19
  v_add_u32 v236, s74, v153
  v_mfma_f32_16x16x32_bf16 a[36:39], a[132:135], v[72:75], a[36:39]
  s_xor_b32 s75, s3, 524288
  ds_read_b64_tr_b16 a[176:177], v10 offset:30464
  s_add_u32 m0, s32, 18496
  v_mfma_f32_16x16x32_bf16 a[40:43], a[136:139], v[72:75], a[40:43]
  s_mov_b32 s57, s3
  ds_read_b64_tr_b16 a[178:179], v10 offset:30976
  buffer_load_dwordx4 v30, s[8:11], s50 offen  lds
  v_mfma_f32_16x16x32_bf16 a[40:43], a[152:155], v[76:79], a[40:43]
  ds_read_b64_tr_b16 a[180:181], v11 offset:30496
  s_mov_b32 s58, s75
  v_mfma_f32_16x16x32_bf16 a[44:47], a[156:159], v[76:79], a[44:47]
  ds_read_b64_tr_b16 a[182:183], v11 offset:31008
  s_add_u32 s59, s3, 262144
  v_mfma_f32_16x16x32_bf16 a[44:47], a[140:143], v[72:75], a[44:47]
  s_add_u32 s60, s75, 262144
  ds_read_b64_tr_b16 a[184:185], v10 offset:30528
  s_mov_b32 m0, s31
  v_mfma_f32_16x16x32_bf16 a[60:63], a[140:143], v[76:79], a[60:63]
  s_xor_b32 s3, s25, 0
  ds_read_b64_tr_b16 a[186:187], v10 offset:31040
  s_add_u32 s51, s34, 524288
  v_mfma_f32_16x16x32_bf16 a[60:63], a[156:159], v[80:83], a[60:63]
  s_lshr_b32 s3, s3, 2
  ds_read_b64_tr_b16 a[188:189], v11 offset:30560
  buffer_load_dwordx4 v2, s[4:7], s51 offen  lds
  v_mfma_f32_16x16x32_bf16 a[56:59], a[152:155], v[80:83], a[56:59]
  ds_read_b64_tr_b16 a[190:191], v11 offset:31072
  s_lshl_b32 s3, s3, 11
  v_mfma_f32_16x16x32_bf16 a[56:59], a[136:139], v[76:79], a[56:59]
  s_add_u32 s24, s61, 1024
  s_sub_u32 s24, s24, s3
  v_mfma_f32_16x16x32_bf16 a[52:55], a[132:135], v[76:79], a[52:55]
  s_mul_i32 s25, s28, 4352
  s_add_u32 s25, s25, 141440
  s_add_u32 m0, s32, 21760
  v_mfma_f32_16x16x32_bf16 a[52:55], a[148:151], v[80:83], a[52:55]
  s_add_u32 s50, s42, 10485760
  v_mov_b32 v238, -1
  v_mov_b32 v239, -1
  v_mfma_f32_16x16x32_bf16 a[48:51], a[144:147], v[80:83], a[48:51]
  s_mov_b32 s82, 0xbdd2d3e8
  buffer_load_dwordx4 v29, s[8:11], s50 offen  lds
  v_mfma_f32_16x16x32_bf16 a[48:51], a[128:131], v[76:79], a[48:51]
  s_mov_b32 s83, 0xbdd2d3e8
  v_mov_b32 v0, v235
  v_mfma_f32_16x16x32_bf16 a[64:67], a[128:131], v[80:83], a[64:67]
  s_mov_b32 s86, 0x3e0307de
  v_mfma_f32_16x16x32_bf16 a[64:67], a[144:147], v[84:87], a[64:67]
  s_mov_b32 s87, 0x3a040ffe
  v_mfma_f32_16x16x32_bf16 a[68:71], a[148:151], v[84:87], a[68:71]
  s_add_u32 m0, s32, 22848
  v_mfma_f32_16x16x32_bf16 a[68:71], a[132:135], v[80:83], a[68:71]
  ds_read_b128 v[104:107], v28 offset:1824
  buffer_load_dwordx4 v30, s[8:11], s50 offen  lds
  v_mfma_f32_16x16x32_bf16 a[72:75], a[136:139], v[80:83], a[72:75]
  v_mfma_f32_16x16x32_bf16 a[72:75], a[152:155], v[84:87], a[72:75]
  v_mfma_f32_16x16x32_bf16 a[76:79], a[156:159], v[84:87], a[76:79]
  v_mfma_f32_16x16x32_bf16 a[76:79], a[140:143], v[80:83], a[76:79]
  v_mfma_f32_16x16x32_bf16 a[92:95], a[140:143], v[84:87], a[92:95]
  v_mfma_f32_16x16x32_bf16 a[92:95], a[156:159], v[88:91], a[92:95]
  v_mfma_f32_16x16x32_bf16 a[88:91], a[152:155], v[88:91], a[88:91]
  v_mfma_f32_16x16x32_bf16 a[88:91], a[136:139], v[84:87], a[88:91]
  v_mfma_f32_16x16x32_bf16 a[84:87], a[132:135], v[84:87], a[84:87]
  v_mfma_f32_16x16x32_bf16 a[84:87], a[148:151], v[88:91], a[84:87]
  v_mfma_f32_16x16x32_bf16 a[80:83], a[144:147], v[88:91], a[80:83]
  buffer_load_dword v255, v234, s[8:11], s43 offen offset:0
  v_mfma_f32_16x16x32_bf16 a[80:83], a[128:131], v[84:87], a[80:83]
  v_mfma_f32_16x16x32_bf16 a[96:99], a[128:131], v[88:91], a[96:99]
  v_mfma_f32_16x16x32_bf16 a[96:99], a[144:147], v[92:95], a[96:99]
  v_mfma_f32_16x16x32_bf16 a[100:103], a[148:151], v[92:95], a[100:103]
  v_mfma_f32_16x16x32_bf16 a[100:103], a[132:135], v[88:91], a[100:103]
  buffer_load_dword v255, v233, s[4:7], s36 offen offset:0
  v_mfma_f32_16x16x32_bf16 a[104:107], a[136:139], v[88:91], a[104:107]
  v_mfma_f32_16x16x32_bf16 a[104:107], a[152:155], v[92:95], a[104:107]
  v_mfma_f32_16x16x32_bf16 a[108:111], a[156:159], v[92:95], a[108:111]
  v_mfma_f32_16x16x32_bf16 a[108:111], a[140:143], v[88:91], a[108:111]
  v_mfma_f32_16x16x32_bf16 a[124:127], a[140:143], v[92:95], a[124:127]
  s_waitcnt lgkmcnt(15)
  v_mfma_f32_16x16x32_bf16 a[124:127], a[156:159], v[96:99], a[124:127]
  v_mfma_f32_16x16x32_bf16 a[120:123], a[152:155], v[96:99], a[120:123]
  v_mfma_f32_16x16x32_bf16 a[120:123], a[136:139], v[92:95], a[120:123]
  v_mfma_f32_16x16x32_bf16 a[116:119], a[132:135], v[92:95], a[116:119]
  v_mfma_f32_16x16x32_bf16 a[116:119], a[148:151], v[96:99], a[116:119]
  v_mfma_f32_16x16x32_bf16 a[112:115], a[144:147], v[96:99], a[112:115]
  v_mfma_f32_16x16x32_bf16 a[112:115], a[128:131], v[92:95], a[112:115]
  v_mfma_f32_16x16x32_bf16 a[0:3], a[160:163], v[72:75], a[0:3]
  s_waitcnt vmcnt(4) lgkmcnt(0)
  s_barrier
  v_mfma_f32_16x16x32_bf16 a[0:3], a[176:179], v[76:79], a[0:3]
  ds_read_b64_tr_b16 a[128:129], v10 offset:0
  s_add_u32 m0, s32, 26112
  v_mfma_f32_16x16x32_bf16 a[4:7], a[180:183], v[76:79], a[4:7]
  ds_read_b64_tr_b16 a[130:131], v10 offset:512
  s_add_u32 s50, s42, 12582912
  v_mfma_f32_16x16x32_bf16 a[4:7], a[164:167], v[72:75], a[4:7]
  ds_read_b64_tr_b16 a[132:133], v11 offset:32
  buffer_load_dwordx4 v29, s[8:11], s50 offen  lds
  v_mfma_f32_16x16x32_bf16 a[8:11], a[168:171], v[72:75], a[8:11]
  ds_read_b64_tr_b16 a[134:135], v11 offset:544
  v_mfma_f32_16x16x32_bf16 a[8:11], a[184:187], v[76:79], a[8:11]
  ds_read_b64_tr_b16 a[136:137], v10 offset:64
  v_mfma_f32_16x16x32_bf16 a[12:15], a[188:191], v[76:79], a[12:15]
  ds_read_b64_tr_b16 a[138:139], v10 offset:576
  v_mfma_f32_16x16x32_bf16 a[12:15], a[172:175], v[72:75], a[12:15]
  ds_read_b64_tr_b16 a[140:141], v11 offset:96
  s_add_u32 m0, s32, 27200
  v_mfma_f32_16x16x32_bf16 a[28:31], a[172:175], v[76:79], a[28:31]
  ds_read_b64_tr_b16 a[142:143], v11 offset:608
  buffer_load_dwordx4 v30, s[8:11], s50 offen  lds
  v_mfma_f32_16x16x32_bf16 a[28:31], a[188:191], v[80:83], a[28:31]
  v_mfma_f32_16x16x32_bf16 a[24:27], a[184:187], v[80:83], a[24:27]
  ds_read_b128 v[108:111], v28 offset:35904
  v_mfma_f32_16x16x32_bf16 a[24:27], a[168:171], v[76:79], a[24:27]
  s_add_u32 m0, s32, 30464
  v_mfma_f32_16x16x32_bf16 a[20:23], a[164:167], v[76:79], a[20:23]
  s_add_u32 s50, s42, 14680064
  v_mfma_f32_16x16x32_bf16 a[20:23], a[180:183], v[80:83], a[20:23]
  buffer_load_dwordx4 v29, s[8:11], s50 offen  lds
  v_mfma_f32_16x16x32_bf16 a[16:19], a[176:179], v[80:83], a[16:19]
  v_mfma_f32_16x16x32_bf16 a[16:19], a[160:163], v[76:79], a[16:19]
  ds_read_b128 v[112:115], v28 offset:36032
  v_mfma_f32_16x16x32_bf16 a[32:35], a[160:163], v[80:83], a[32:35]
  v_mfma_f32_16x16x32_bf16 a[32:35], a[176:179], v[84:87], a[32:35]
  s_add_u32 m0, s32, 31552
  v_mfma_f32_16x16x32_bf16 a[36:39], a[180:183], v[84:87], a[36:39]
  buffer_load_dwordx4 v30, s[8:11], s50 offen  lds
  v_mfma_f32_16x16x32_bf16 a[36:39], a[164:167], v[80:83], a[36:39]
  v_mfma_f32_16x16x32_bf16 a[40:43], a[168:171], v[80:83], a[40:43]
  v_mfma_f32_16x16x32_bf16 a[40:43], a[184:187], v[84:87], a[40:43]
  ds_read_b128 v[116:119], v28 offset:36160
  v_mfma_f32_16x16x32_bf16 a[44:47], a[188:191], v[84:87], a[44:47]
  v_mfma_f32_16x16x32_bf16 a[44:47], a[172:175], v[80:83], a[44:47]
  v_mfma_f32_16x16x32_bf16 a[60:63], a[172:175], v[84:87], a[60:63]
  v_mfma_f32_16x16x32_bf16 a[60:63], a[188:191], v[88:91], a[60:63]
  v_mfma_f32_16x16x32_bf16 a[56:59], a[184:187], v[88:91], a[56:59]
  v_mfma_f32_16x16x32_bf16 a[56:59], a[168:171], v[84:87], a[56:59]
  ds_read_b128 v[48:51], v28 offset:36288
  v_mfma_f32_16x16x32_bf16 a[52:55], a[164:167], v[84:87], a[52:55]
  v_mfma_f32_16x16x32_bf16 a[52:55], a[180:183], v[88:91], a[52:55]
  v_mfma_f32_16x16x32_bf16 a[48:51], a[176:179], v[88:91], a[48:51]
  v_mfma_f32_16x16x32_bf16 a[48:51], a[160:163], v[84:87], a[48:51]
  v_mfma_f32_16x16x32_bf16 a[64:67], a[160:163], v[88:91], a[64:67]
  v_mfma_f32_16x16x32_bf16 a[64:67], a[176:179], v[92:95], a[64:67]
  ds_read_b64_tr_b16 a[144:145], v10 offset:4352
  ds_read_b128 v[52:55], v28 offset:36416
  v_mfma_f32_16x16x32_bf16 a[68:71], a[180:183], v[92:95], a[68:71]
  ds_read_b64_tr_b16 a[146:147], v10 offset:4864
  v_mfma_f32_16x16x32_bf16 a[68:71], a[164:167], v[88:91], a[68:71]
  ds_read_b64_tr_b16 a[148:149], v11 offset:4384
  v_mfma_f32_16x16x32_bf16 a[72:75], a[168:171], v[88:91], a[72:75]
  ds_read_b64_tr_b16 a[150:151], v11 offset:4896
  v_mfma_f32_16x16x32_bf16 a[72:75], a[184:187], v[92:95], a[72:75]
  ds_read_b64_tr_b16 a[152:153], v10 offset:4416
  v_mfma_f32_16x16x32_bf16 a[76:79], a[188:191], v[92:95], a[76:79]
  ds_read_b64_tr_b16 a[154:155], v10 offset:4928
  ds_read_b128 v[56:59], v28 offset:36544
  v_mfma_f32_16x16x32_bf16 a[76:79], a[172:175], v[88:91], a[76:79]
  ds_read_b64_tr_b16 a[156:157], v11 offset:4448
  v_mfma_f32_16x16x32_bf16 a[92:95], a[172:175], v[92:95], a[92:95]
  ds_read_b64_tr_b16 a[158:159], v11 offset:4960
  v_mfma_f32_16x16x32_bf16 a[92:95], a[188:191], v[96:99], a[92:95]
  v_mfma_f32_16x16x32_bf16 a[88:91], a[184:187], v[96:99], a[88:91]
  v_mfma_f32_16x16x32_bf16 a[88:91], a[168:171], v[92:95], a[88:91]
  v_mfma_f32_16x16x32_bf16 a[84:87], a[164:167], v[92:95], a[84:87]
  ds_read_b128 v[60:63], v28 offset:36672
  v_mfma_f32_16x16x32_bf16 a[84:87], a[180:183], v[96:99], a[84:87]
  v_mfma_f32_16x16x32_bf16 a[80:83], a[176:179], v[96:99], a[80:83]
  v_mfma_f32_16x16x32_bf16 a[80:83], a[160:163], v[92:95], a[80:83]
  v_mfma_f32_16x16x32_bf16 a[96:99], a[160:163], v[96:99], a[96:99]
  v_mfma_f32_16x16x32_bf16 a[96:99], a[176:179], v[100:103], a[96:99]
  v_mfma_f32_16x16x32_bf16 a[100:103], a[180:183], v[100:103], a[100:103]
  ds_read_b128 v[64:67], v28 offset:36800
  v_mfma_f32_16x16x32_bf16 a[100:103], a[164:167], v[96:99], a[100:103]
  v_mfma_f32_16x16x32_bf16 a[104:107], a[168:171], v[96:99], a[104:107]
  v_mfma_f32_16x16x32_bf16 a[104:107], a[184:187], v[100:103], a[104:107]
  v_mfma_f32_16x16x32_bf16 a[108:111], a[188:191], v[100:103], a[108:111]
  v_mfma_f32_16x16x32_bf16 a[108:111], a[172:175], v[96:99], a[108:111]
  v_mfma_f32_16x16x32_bf16 a[124:127], a[172:175], v[100:103], a[124:127]
  v_mfma_f32_16x16x32_bf16 a[124:127], a[188:191], v[104:107], a[124:127]
  v_mfma_f32_16x16x32_bf16 a[120:123], a[184:187], v[104:107], a[120:123]
  v_mfma_f32_16x16x32_bf16 a[120:123], a[168:171], v[100:103], a[120:123]
  v_mfma_f32_16x16x32_bf16 a[116:119], a[164:167], v[100:103], a[116:119]
  v_mfma_f32_16x16x32_bf16 a[116:119], a[180:183], v[104:107], a[116:119]
  v_mfma_f32_16x16x32_bf16 a[112:115], a[176:179], v[104:107], a[112:115]
  v_mfma_f32_16x16x32_bf16 a[112:115], a[160:163], v[100:103], a[112:115]
  s_waitcnt lgkmcnt(15)
  v_mfma_f32_16x16x32_bf16 a[0:3], a[128:131], v[108:111], a[0:3]
  s_waitcnt lgkmcnt(2)
  s_barrier
  v_mfma_f32_16x16x32_bf16 a[0:3], a[144:147], v[112:115], a[0:3]
  ds_read_b64_tr_b16 a[160:161], v10 offset:8704
  s_add_u32 m0, s29, 0
  v_mfma_f32_16x16x32_bf16 a[4:7], a[148:151], v[112:115], a[4:7]
  ds_read_b64_tr_b16 a[162:163], v10 offset:9216
  s_add_u32 s51, s35, 0
  v_mfma_f32_16x16x32_bf16 a[4:7], a[132:135], v[108:111], a[4:7]
  ds_read_b64_tr_b16 a[164:165], v11 offset:8736
  buffer_load_dwordx4 v1, s[4:7], s51 offen  lds
  v_mfma_f32_16x16x32_bf16 a[8:11], a[136:139], v[108:111], a[8:11]
  ds_read_b64_tr_b16 a[166:167], v11 offset:9248
  v_mfma_f32_16x16x32_bf16 a[8:11], a[152:155], v[112:115], a[8:11]
  ds_read_b64_tr_b16 a[168:169], v10 offset:8768
  v_mfma_f32_16x16x32_bf16 a[12:15], a[156:159], v[112:115], a[12:15]
  ds_read_b64_tr_b16 a[170:171], v10 offset:9280
  s_add_u32 m0, s32, 0
  v_mfma_f32_16x16x32_bf16 a[12:15], a[140:143], v[108:111], a[12:15]
  ds_read_b64_tr_b16 a[172:173], v11 offset:8800
  s_add_u32 s50, s43, 0
  v_mfma_f32_16x16x32_bf16 a[28:31], a[140:143], v[112:115], a[28:31]
  ds_read_b64_tr_b16 a[174:175], v11 offset:9312
  buffer_load_dwordx4 v29, s[8:11], s50 offen  lds
  v_mfma_f32_16x16x32_bf16 a[28:31], a[156:159], v[116:119], a[28:31]
  ds_read_b128 v[68:71], v28 offset:36960
  v_mfma_f32_16x16x32_bf16 a[24:27], a[152:155], v[116:119], a[24:27]
  v_mfma_f32_16x16x32_bf16 a[24:27], a[136:139], v[112:115], a[24:27]
  v_mfma_f32_16x16x32_bf16 a[20:23], a[132:135], v[112:115], a[20:23]
  s_add_u32 m0, s32, 1088
  v_mfma_f32_16x16x32_bf16 a[20:23], a[148:151], v[116:119], a[20:23]
  buffer_load_dwordx4 v30, s[8:11], s50 offen  lds
  v_mfma_f32_16x16x32_bf16 a[16:19], a[144:147], v[116:119], a[16:19]
  v_mfma_f32_16x16x32_bf16 a[16:19], a[128:131], v[112:115], a[16:19]
  v_mfma_f32_16x16x32_bf16 a[32:35], a[128:131], v[116:119], a[32:35]
  s_add_u32 m0, s29, 4224
  v_mfma_f32_16x16x32_bf16 a[32:35], a[144:147], v[48:51], a[32:35]
  s_add_u32 s51, s35, 131072
  v_mfma_f32_16x16x32_bf16 a[36:39], a[148:151], v[48:51], a[36:39]
  buffer_load_dwordx4 v1, s[4:7], s51 offen  lds
  v_mfma_f32_16x16x32_bf16 a[36:39], a[132:135], v[116:119], a[36:39]
  v_mfma_f32_16x16x32_bf16 a[40:43], a[136:139], v[116:119], a[40:43]
  v_mfma_f32_16x16x32_bf16 a[40:43], a[152:155], v[48:51], a[40:43]
  s_add_u32 m0, s32, 4352
  v_mfma_f32_16x16x32_bf16 a[44:47], a[156:159], v[48:51], a[44:47]
  s_add_u32 s50, s43, 2097152
  v_mfma_f32_16x16x32_bf16 a[44:47], a[140:143], v[116:119], a[44:47]
  buffer_load_dwordx4 v29, s[8:11], s50 offen  lds
  v_mfma_f32_16x16x32_bf16 a[60:63], a[140:143], v[48:51], a[60:63]
  v_mfma_f32_16x16x32_bf16 a[60:63], a[156:159], v[52:55], a[60:63]
  v_mfma_f32_16x16x32_bf16 a[56:59], a[152:155], v[52:55], a[56:59]
  v_mfma_f32_16x16x32_bf16 a[56:59], a[136:139], v[48:51], a[56:59]
  s_add_u32 m0, s32, 5440
  v_mfma_f32_16x16x32_bf16 a[52:55], a[132:135], v[48:51], a[52:55]
  buffer_load_dwordx4 v30, s[8:11], s50 offen  lds
  v_mfma_f32_16x16x32_bf16 a[52:55], a[148:151], v[52:55], a[52:55]
  v_mfma_f32_16x16x32_bf16 a[48:51], a[144:147], v[52:55], a[48:51]
  v_mfma_f32_16x16x32_bf16 a[48:51], a[128:131], v[48:51], a[48:51]
  s_add_u32 m0, s29, 8448
  v_mfma_f32_16x16x32_bf16 a[64:67], a[128:131], v[52:55], a[64:67]
  s_add_u32 s51, s35, 262144
  v_mfma_f32_16x16x32_bf16 a[64:67], a[144:147], v[56:59], a[64:67]
  ds_read_b64_tr_b16 a[176:177], v10 offset:13056
  buffer_load_dwordx4 v1, s[4:7], s51 offen  lds
  v_mfma_f32_16x16x32_bf16 a[68:71], a[148:151], v[56:59], a[68:71]
  ds_read_b64_tr_b16 a[178:179], v10 offset:13568
  ds_read_b128 v[72:75], v28 offset:37088
  v_mfma_f32_16x16x32_bf16 a[68:71], a[132:135], v[52:55], a[68:71]
  ds_read_b64_tr_b16 a[180:181], v11 offset:13088
  v_mfma_f32_16x16x32_bf16 a[72:75], a[136:139], v[52:55], a[72:75]
  ds_read_b64_tr_b16 a[182:183], v11 offset:13600
  v_mfma_f32_16x16x32_bf16 a[72:75], a[152:155], v[56:59], a[72:75]
  ds_read_b64_tr_b16 a[184:185], v10 offset:13120
  v_mfma_f32_16x16x32_bf16 a[76:79], a[156:159], v[56:59], a[76:79]
  ds_read_b64_tr_b16 a[186:187], v10 offset:13632
  global_load_ushort v47, v236, s[76:77]
  v_mfma_f32_16x16x32_bf16 a[76:79], a[140:143], v[52:55], a[76:79]
  ds_read_b64_tr_b16 a[188:189], v11 offset:13152
  v_mfma_f32_16x16x32_bf16 a[92:95], a[140:143], v[56:59], a[92:95]
  ds_read_b64_tr_b16 a[190:191], v11 offset:13664
  s_waitcnt lgkmcnt(15)
  v_mfma_f32_16x16x32_bf16 a[92:95], a[156:159], v[60:63], a[92:95]
  v_mfma_f32_16x16x32_bf16 a[88:91], a[152:155], v[60:63], a[88:91]
  v_mfma_f32_16x16x32_bf16 a[88:91], a[136:139], v[56:59], a[88:91]
  global_load_ushort v45, v236, s[78:79]
  v_mfma_f32_16x16x32_bf16 a[84:87], a[132:135], v[56:59], a[84:87]
  v_mfma_f32_16x16x32_bf16 a[84:87], a[148:151], v[60:63], a[84:87]
  v_mfma_f32_16x16x32_bf16 a[80:83], a[144:147], v[60:63], a[80:83]
  s_add_u32 m0, s29, 12672
  v_mfma_f32_16x16x32_bf16 a[80:83], a[128:131], v[56:59], a[80:83]
  s_add_u32 s51, s35, 393216
  v_mfma_f32_16x16x32_bf16 a[96:99], a[128:131], v[60:63], a[96:99]
  buffer_load_dwordx4 v1, s[4:7], s51 offen  lds
  v_mfma_f32_16x16x32_bf16 a[96:99], a[144:147], v[64:67], a[96:99]
  v_mfma_f32_16x16x32_bf16 a[100:103], a[148:151], v[64:67], a[100:103]
L_it0:
  v_add_u32 v252, L_it0-standalone__self_sup_conv_stem_hubert__speech_kernel+3072, v253
  v_mfma_f32_16x16x32_bf16 a[100:103], a[132:135], v[60:63], a[100:103]
  v_min_u32 v252, L_end-standalone__self_sup_conv_stem_hubert__speech_kernel-8, v252
  v_mfma_f32_16x16x32_bf16 a[104:107], a[136:139], v[60:63], a[104:107]
  v_mfma_f32_16x16x32_bf16 a[104:107], a[152:155], v[64:67], a[104:107]
  global_load_dword v255, v252, s[84:85]
  v_mfma_f32_16x16x32_bf16 a[108:111], a[156:159], v[64:67], a[108:111]
  v_mfma_f32_16x16x32_bf16 a[108:111], a[140:143], v[60:63], a[108:111]
  v_mfma_f32_16x16x32_bf16 a[124:127], a[140:143], v[64:67], a[124:127]
  s_waitcnt lgkmcnt(9)
  v_mfma_f32_16x16x32_bf16 a[124:127], a[156:159], v[68:71], a[124:127]
  v_mfma_f32_16x16x32_bf16 a[120:123], a[152:155], v[68:71], a[120:123]
  global_load_ushort v46, v236, s[80:81]
  v_mfma_f32_16x16x32_bf16 a[120:123], a[136:139], v[64:67], a[120:123]
  v_mfma_f32_16x16x32_bf16 a[116:119], a[132:135], v[64:67], a[116:119]
  ds_read_b128 v[76:79], v28 offset:37216
  v_mfma_f32_16x16x32_bf16 a[116:119], a[148:151], v[68:71], a[116:119]
  s_add_u32 m0, s29, 17952
  v_mfma_f32_16x16x32_bf16 a[112:115], a[144:147], v[68:71], a[112:115]
  s_add_u32 s51, s35, 0
  v_mfma_f32_16x16x32_bf16 a[112:115], a[128:131], v[64:67], a[112:115]
  buffer_load_dwordx4 v26, s[4:7], s51 offen  lds
  v_mfma_f32_16x16x32_bf16 a[0:3], a[160:163], v[116:119], a[0:3]
  s_waitcnt vmcnt(19) lgkmcnt(1)
  s_barrier
  v_mfma_f32_16x16x32_bf16 a[0:3], a[176:179], v[48:51], a[0:3]
  ds_read_b64_tr_b16 a[128:129], v10 offset:17408
  v_mfma_f32_16x16x32_bf16 a[4:7], a[180:183], v[48:51], a[4:7]
  ds_read_b64_tr_b16 a[130:131], v10 offset:17920
  v_mfma_f32_16x16x32_bf16 a[4:7], a[164:167], v[116:119], a[4:7]
  ds_read_b64_tr_b16 a[132:133], v11 offset:17440
  v_mfma_f32_16x16x32_bf16 a[8:11], a[168:171], v[116:119], a[8:11]
  ds_read_b64_tr_b16 a[134:135], v11 offset:17952
  buffer_load_dwordx2 v[240:241], off, s[20:23], 0 sc1
  v_mfma_f32_16x16x32_bf16 a[8:11], a[184:187], v[48:51], a[8:11]
  ds_read_b64_tr_b16 a[136:137], v10 offset:17472
  v_mfma_f32_16x16x32_bf16 a[12:15], a[188:191], v[48:51], a[12:15]
  ds_read_b64_tr_b16 a[138:139], v10 offset:17984
  v_mfma_f32_16x16x32_bf16 a[12:15], a[172:175], v[116:119], a[12:15]
  ds_read_b64_tr_b16 a[140:141], v11 offset:17504
  s_add_u32 m0, s29, 22176
  v_mfma_f32_16x16x32_bf16 a[28:31], a[172:175], v[48:51], a[28:31]
  ds_read_b64_tr_b16 a[142:143], v11 offset:18016
  s_add_u32 s51, s35, 131072
  v_mfma_f32_16x16x32_bf16 a[28:31], a[188:191], v[52:55], a[28:31]
  buffer_load_dwordx4 v26, s[4:7], s51 offen  lds
  v_mfma_f32_16x16x32_bf16 a[24:27], a[184:187], v[52:55], a[24:27]
  v_mfma_f32_16x16x32_bf16 a[24:27], a[168:171], v[48:51], a[24:27]
  v_mfma_f32_16x16x32_bf16 a[20:23], a[164:167], v[48:51], a[20:23]
  v_mfma_f32_16x16x32_bf16 a[20:23], a[180:183], v[52:55], a[20:23]
  v_mfma_f32_16x16x32_bf16 a[16:19], a[176:179], v[52:55], a[16:19]
  buffer_store_dwordx2 v[238:239], v35, s[12:15], 0 offen sc1
  v_mfma_f32_16x16x32_bf16 a[16:19], a[160:163], v[48:51], a[16:19]
  v_mfma_f32_16x16x32_bf16 a[32:35], a[160:163], v[52:55], a[32:35]
  v_mfma_f32_16x16x32_bf16 a[32:35], a[176:179], v[56:59], a[32:35]
  v_mfma_f32_16x16x32_bf16 a[36:39], a[180:183], v[56:59], a[36:39]
  s_add_u32 m0, s25, 0
  v_mfma_f32_16x16x32_bf16 a[36:39], a[164:167], v[52:55], a[36:39]
  buffer_load_dwordx4 v5, s[8:11], s53 offen  lds
  v_mfma_f32_16x16x32_bf16 a[40:43], a[168:171], v[52:55], a[40:43]
  v_mfma_f32_16x16x32_bf16 a[40:43], a[184:187], v[56:59], a[40:43]
  v_mfma_f32_16x16x32_bf16 a[44:47], a[188:191], v[56:59], a[44:47]
  ds_read_b128 v[80:83], v28 offset:37344
  s_add_u32 m0, s29, 26400
  v_mfma_f32_16x16x32_bf16 a[44:47], a[172:175], v[52:55], a[44:47]
  s_add_u32 s51, s35, 262144
  v_mfma_f32_16x16x32_bf16 a[60:63], a[172:175], v[56:59], a[60:63]
  buffer_load_dwordx4 v26, s[4:7], s51 offen  lds
  v_mfma_f32_16x16x32_bf16 a[60:63], a[188:191], v[60:63], a[60:63]
  v_mfma_f32_16x16x32_bf16 a[56:59], a[184:187], v[60:63], a[56:59]
  v_mfma_f32_16x16x32_bf16 a[56:59], a[168:171], v[56:59], a[56:59]
  v_mfma_f32_16x16x32_bf16 a[52:55], a[164:167], v[56:59], a[52:55]
  s_add_u32 m0, s25, 1088
  v_mfma_f32_16x16x32_bf16 a[52:55], a[180:183], v[60:63], a[52:55]
  buffer_load_dwordx4 v6, s[8:11], s53 offen  lds
  v_mfma_f32_16x16x32_bf16 a[48:51], a[176:179], v[60:63], a[48:51]
  v_mfma_f32_16x16x32_bf16 a[48:51], a[160:163], v[56:59], a[48:51]
  v_mfma_f32_16x16x32_bf16 a[64:67], a[160:163], v[60:63], a[64:67]
  v_mfma_f32_16x16x32_bf16 a[64:67], a[176:179], v[64:67], a[64:67]
  ds_read_b64_tr_b16 a[144:145], v10 offset:21760
  s_add_u32 m0, s25, 2176
  v_mfma_f32_16x16x32_bf16 a[68:71], a[180:183], v[64:67], a[68:71]
  ds_read_b64_tr_b16 a[146:147], v10 offset:22272
  buffer_load_dwordx4 v7, s[8:11], s53 offen  lds
  v_mfma_f32_16x16x32_bf16 a[68:71], a[164:167], v[60:63], a[68:71]
  ds_read_b64_tr_b16 a[148:149], v11 offset:21792
  v_mfma_f32_16x16x32_bf16 a[72:75], a[168:171], v[60:63], a[72:75]
  ds_read_b64_tr_b16 a[150:151], v11 offset:22304
  v_mfma_f32_16x16x32_bf16 a[72:75], a[184:187], v[64:67], a[72:75]
  ds_read_b64_tr_b16 a[152:153], v10 offset:21824
  s_add_u32 m0, s29, 30624
  v_mfma_f32_16x16x32_bf16 a[76:79], a[188:191], v[64:67], a[76:79]
  ds_read_b64_tr_b16 a[154:155], v10 offset:22336
  s_add_u32 s51, s35, 393216
  v_mfma_f32_16x16x32_bf16 a[76:79], a[172:175], v[60:63], a[76:79]
  ds_read_b64_tr_b16 a[156:157], v11 offset:21856
  buffer_load_dwordx4 v26, s[4:7], s51 offen  lds
  v_mfma_f32_16x16x32_bf16 a[92:95], a[172:175], v[64:67], a[92:95]
  ds_read_b64_tr_b16 a[158:159], v11 offset:22368
  v_mfma_f32_16x16x32_bf16 a[92:95], a[188:191], v[68:71], a[92:95]
  v_mfma_f32_16x16x32_bf16 a[88:91], a[184:187], v[68:71], a[88:91]
  v_mfma_f32_16x16x32_bf16 a[88:91], a[168:171], v[64:67], a[88:91]
  s_add_u32 m0, s25, 3264
  v_mfma_f32_16x16x32_bf16 a[84:87], a[164:167], v[64:67], a[84:87]
  buffer_load_dwordx4 v8, s[8:11], s53 offen  lds
  v_mfma_f32_16x16x32_bf16 a[84:87], a[180:183], v[68:71], a[84:87]
  v_mfma_f32_16x16x32_bf16 a[80:83], a[176:179], v[68:71], a[80:83]
  v_mfma_f32_16x16x32_bf16 a[80:83], a[160:163], v[64:67], a[80:83]
  ds_read_b128 v[84:87], v28 offset:37472
  s_add_u32 m0, s32, 8704
  v_mfma_f32_16x16x32_bf16 a[96:99], a[160:163], v[68:71], a[96:99]
  s_add_u32 s50, s43, 4194304
  v_mfma_f32_16x16x32_bf16 a[96:99], a[176:179], v[72:75], a[96:99]
  buffer_load_dwordx4 v29, s[8:11], s50 offen  lds
  v_mfma_f32_16x16x32_bf16 a[100:103], a[180:183], v[72:75], a[100:103]
  v_mfma_f32_16x16x32_bf16 a[100:103], a[164:167], v[68:71], a[100:103]
  v_mfma_f32_16x16x32_bf16 a[104:107], a[168:171], v[68:71], a[104:107]
  s_mov_b32 m0, s30
  v_mfma_f32_16x16x32_bf16 a[104:107], a[184:187], v[72:75], a[104:107]
  s_add_u32 s51, s35, 524288
  v_mfma_f32_16x16x32_bf16 a[108:111], a[188:191], v[72:75], a[108:111]
  buffer_load_dwordx4 v2, s[4:7], s51 offen  lds
  v_mfma_f32_16x16x32_bf16 a[108:111], a[172:175], v[68:71], a[108:111]
  v_mfma_f32_16x16x32_bf16 a[124:127], a[172:175], v[72:75], a[124:127]
  s_waitcnt lgkmcnt(15)
  v_mfma_f32_16x16x32_bf16 a[124:127], a[188:191], v[76:79], a[124:127]
  v_mfma_f32_16x16x32_bf16 a[120:123], a[184:187], v[76:79], a[120:123]
  s_add_u32 m0, s32, 9792
  v_mfma_f32_16x16x32_bf16 a[120:123], a[168:171], v[72:75], a[120:123]
  buffer_load_dwordx4 v30, s[8:11], s50 offen  lds
  v_mfma_f32_16x16x32_bf16 a[116:119], a[164:167], v[72:75], a[116:119]
  v_mfma_f32_16x16x32_bf16 a[116:119], a[180:183], v[76:79], a[116:119]
  v_mfma_f32_16x16x32_bf16 a[112:115], a[176:179], v[76:79], a[112:115]
  s_add_u32 m0, s32, 13056
  v_mfma_f32_16x16x32_bf16 a[112:115], a[160:163], v[72:75], a[112:115]
  s_add_u32 s50, s43, 6291456
  v_mfma_f32_16x16x32_bf16 a[0:3], a[128:131], v[52:55], a[0:3]
  s_waitcnt vmcnt(25) lgkmcnt(1)
  s_barrier
  v_mfma_f32_16x16x32_bf16 a[0:3], a[144:147], v[56:59], a[0:3]
  buffer_load_dwordx4 v29, s[8:11], s50 offen  lds
  ds_read_b64_tr_b16 a[160:161], v10 offset:26112
  v_mfma_f32_16x16x32_bf16 a[4:7], a[148:151], v[56:59], a[4:7]
  ds_read_b64_tr_b16 a[162:163], v10 offset:26624
  v_mfma_f32_16x16x32_bf16 a[4:7], a[132:135], v[52:55], a[4:7]
  ds_read_b64_tr_b16 a[164:165], v11 offset:26144
  v_mfma_f32_16x16x32_bf16 a[8:11], a[136:139], v[52:55], a[8:11]
  ds_read_b64_tr_b16 a[166:167], v11 offset:26656
  s_add_u32 m0, s32, 14144
  v_mfma_f32_16x16x32_bf16 a[8:11], a[152:155], v[56:59], a[8:11]
  ds_read_b64_tr_b16 a[168:169], v10 offset:26176
  buffer_load_dwordx4 v30, s[8:11], s50 offen  lds
  v_mfma_f32_16x16x32_bf16 a[12:15], a[156:159], v[56:59], a[12:15]
  ds_read_b64_tr_b16 a[170:171], v10 offset:26688
  v_mfma_f32_16x16x32_bf16 a[12:15], a[140:143], v[52:55], a[12:15]
  ds_read_b64_tr_b16 a[172:173], v11 offset:26208
  v_mfma_f32_16x16x32_bf16 a[28:31], a[140:143], v[56:59], a[28:31]
  ds_read_b64_tr_b16 a[174:175], v11 offset:26720
  s_add_u32 m0, s32, 17408
  v_mfma_f32_16x16x32_bf16 a[28:31], a[156:159], v[60:63], a[28:31]
  ds_read_b128 v[88:91], v28 offset:37600
  s_add_u32 s50, s43, 8388608
  v_mfma_f32_16x16x32_bf16 a[24:27], a[152:155], v[60:63], a[24:27]
  buffer_load_dwordx4 v29, s[8:11], s50 offen  lds
  v_mfma_f32_16x16x32_bf16 a[24:27], a[136:139], v[56:59], a[24:27]
  v_mfma_f32_16x16x32_bf16 a[20:23], a[132:135], v[56:59], a[20:23]
  v_mfma_f32_16x16x32_bf16 a[20:23], a[148:151], v[60:63], a[20:23]
  v_mfma_f32_16x16x32_bf16 a[16:19], a[144:147], v[60:63], a[16:19]
  s_add_u32 m0, s32, 18496
  v_mfma_f32_16x16x32_bf16 a[16:19], a[128:131], v[56:59], a[16:19]
  buffer_load_dwordx4 v30, s[8:11], s50 offen  lds
  v_mfma_f32_16x16x32_bf16 a[32:35], a[128:131], v[60:63], a[32:35]
  v_mfma_f32_16x16x32_bf16 a[32:35], a[144:147], v[64:67], a[32:35]
  v_mfma_f32_16x16x32_bf16 a[36:39], a[148:151], v[64:67], a[36:39]
  s_add_u32 m0, s32, 21760
  v_mfma_f32_16x16x32_bf16 a[36:39], a[132:135], v[60:63], a[36:39]
  s_add_u32 s50, s43, 10485760
  v_mfma_f32_16x16x32_bf16 a[40:43], a[136:139], v[60:63], a[40:43]
  buffer_load_dwordx4 v29, s[8:11], s50 offen  lds
  v_mfma_f32_16x16x32_bf16 a[40:43], a[152:155], v[64:67], a[40:43]
  v_mfma_f32_16x16x32_bf16 a[44:47], a[156:159], v[64:67], a[44:47]
  v_mfma_f32_16x16x32_bf16 a[44:47], a[140:143], v[60:63], a[44:47]
  v_mfma_f32_16x16x32_bf16 a[60:63], a[140:143], v[64:67], a[60:63]
  s_add_u32 m0, s32, 22848
  v_mfma_f32_16x16x32_bf16 a[60:63], a[156:159], v[68:71], a[60:63]
  buffer_load_dwordx4 v30, s[8:11], s50 offen  lds
  v_mfma_f32_16x16x32_bf16 a[56:59], a[152:155], v[68:71], a[56:59]
  v_mfma_f32_16x16x32_bf16 a[56:59], a[136:139], v[64:67], a[56:59]
  v_mfma_f32_16x16x32_bf16 a[52:55], a[132:135], v[64:67], a[52:55]
  v_mfma_f32_16x16x32_bf16 a[52:55], a[148:151], v[68:71], a[52:55]
  v_mfma_f32_16x16x32_bf16 a[48:51], a[144:147], v[68:71], a[48:51]
  s_waitcnt vmcnt(17)
  v_readfirstlane_b32 s26, v240
  v_readfirstlane_b32 s27, v241
  v_mfma_f32_16x16x32_bf16 a[48:51], a[128:131], v[64:67], a[48:51]
  v_mfma_f32_16x16x32_bf16 a[64:67], a[128:131], v[68:71], a[64:67]
  s_cmp_lg_u32 s26, 0
  s_cbranch_scc0 L_slow_non
L_back_non:
  v_mfma_f32_16x16x32_bf16 a[64:67], a[144:147], v[72:75], a[64:67]
  ds_read_b64_tr_b16 a[176:177], v10 offset:30464
  v_mfma_f32_16x16x32_bf16 a[68:71], a[148:151], v[72:75], a[68:71]
  ds_read_b64_tr_b16 a[178:179], v10 offset:30976
  v_mfma_f32_16x16x32_bf16 a[68:71], a[132:135], v[68:71], a[68:71]
  ds_read_b64_tr_b16 a[180:181], v11 offset:30496
  ds_read_b128 v[92:95], v28 offset:37728
  v_mfma_f32_16x16x32_bf16 a[72:75], a[136:139], v[68:71], a[72:75]
  ds_read_b64_tr_b16 a[182:183], v11 offset:31008
  v_mfma_f32_16x16x32_bf16 a[72:75], a[152:155], v[72:75], a[72:75]
  ds_read_b64_tr_b16 a[184:185], v10 offset:30528
  v_mfma_f32_16x16x32_bf16 a[76:79], a[156:159], v[72:75], a[76:79]
  ds_read_b64_tr_b16 a[186:187], v10 offset:31040
  v_mfma_f32_16x16x32_bf16 a[76:79], a[140:143], v[68:71], a[76:79]
  ds_read_b64_tr_b16 a[188:189], v11 offset:30560
  v_mfma_f32_16x16x32_bf16 a[92:95], a[140:143], v[72:75], a[92:95]
  ds_read_b64_tr_b16 a[190:191], v11 offset:31072
  v_mfma_f32_16x16x32_bf16 a[92:95], a[156:159], v[76:79], a[92:95]
  v_mfma_f32_16x16x32_bf16 a[88:91], a[152:155], v[76:79], a[88:91]
  v_mfma_f32_16x16x32_bf16 a[88:91], a[136:139], v[72:75], a[88:91]
  v_mfma_f32_16x16x32_bf16 a[84:87], a[132:135], v[72:75], a[84:87]
  v_mfma_f32_16x16x32_bf16 a[84:87], a[148:151], v[76:79], a[84:87]
  v_mfma_f32_16x16x32_bf16 a[80:83], a[144:147], v[76:79], a[80:83]
  buffer_load_dword v255, v234, s[8:11], s44 offen offset:0
  v_mfma_f32_16x16x32_bf16 a[80:83], a[128:131], v[72:75], a[80:83]
  v_mfma_f32_16x16x32_bf16 a[96:99], a[128:131], v[76:79], a[96:99]
  v_mfma_f32_16x16x32_bf16 a[96:99], a[144:147], v[80:83], a[96:99]
  v_mfma_f32_16x16x32_bf16 a[100:103], a[148:151], v[80:83], a[100:103]
  v_mfma_f32_16x16x32_bf16 a[100:103], a[132:135], v[76:79], a[100:103]
  buffer_load_dword v255, v233, s[4:7], s37 offen offset:0
  v_mfma_f32_16x16x32_bf16 a[104:107], a[136:139], v[76:79], a[104:107]
  v_mfma_f32_16x16x32_bf16 a[104:107], a[152:155], v[80:83], a[104:107]
  v_mfma_f32_16x16x32_bf16 a[108:111], a[156:159], v[80:83], a[108:111]
  v_mfma_f32_16x16x32_bf16 a[108:111], a[140:143], v[76:79], a[108:111]
  v_mfma_f32_16x16x32_bf16 a[124:127], a[140:143], v[80:83], a[124:127]
  s_waitcnt lgkmcnt(15)
  v_mfma_f32_16x16x32_bf16 a[124:127], a[156:159], v[84:87], a[124:127]
  v_mfma_f32_16x16x32_bf16 a[120:123], a[152:155], v[84:87], a[120:123]
  v_mfma_f32_16x16x32_bf16 a[120:123], a[136:139], v[80:83], a[120:123]
  v_mfma_f32_16x16x32_bf16 a[116:119], a[132:135], v[80:83], a[116:119]
  v_mfma_f32_16x16x32_bf16 a[116:119], a[148:151], v[84:87], a[116:119]
  v_mfma_f32_16x16x32_bf16 a[112:115], a[144:147], v[84:87], a[112:115]
  v_mfma_f32_16x16x32_bf16 a[112:115], a[128:131], v[80:83], a[112:115]
  v_mfma_f32_16x16x32_bf16 a[0:3], a[160:163], v[60:63], a[0:3]
  s_waitcnt vmcnt(9) lgkmcnt(0)
  s_barrier
  v_mfma_f32_16x16x32_bf16 a[0:3], a[176:179], v[64:67], a[0:3]
  ds_read_b64_tr_b16 a[128:129], v10 offset:0
  s_add_u32 m0, s32, 26112
  v_mfma_f32_16x16x32_bf16 a[4:7], a[180:183], v[64:67], a[4:7]
  ds_read_b64_tr_b16 a[130:131], v10 offset:512
  s_add_u32 s50, s43, 12582912
  v_mfma_f32_16x16x32_bf16 a[4:7], a[164:167], v[60:63], a[4:7]
  ds_read_b64_tr_b16 a[132:133], v11 offset:32
  buffer_load_dwordx4 v29, s[8:11], s50 offen  lds
  v_mfma_f32_16x16x32_bf16 a[8:11], a[168:171], v[60:63], a[8:11]
  ds_read_b64_tr_b16 a[134:135], v11 offset:544
  v_mfma_f32_16x16x32_bf16 a[8:11], a[184:187], v[64:67], a[8:11]
  ds_read_b64_tr_b16 a[136:137], v10 offset:64
  v_mfma_f32_16x16x32_bf16 a[12:15], a[188:191], v[64:67], a[12:15]
  ds_read_b64_tr_b16 a[138:139], v10 offset:576
  v_mfma_f32_16x16x32_bf16 a[12:15], a[172:175], v[60:63], a[12:15]
  ds_read_b64_tr_b16 a[140:141], v11 offset:96
  s_add_u32 m0, s32, 27200
  v_mfma_f32_16x16x32_bf16 a[28:31], a[172:175], v[64:67], a[28:31]
  ds_read_b64_tr_b16 a[142:143], v11 offset:608
  buffer_load_dwordx4 v30, s[8:11], s50 offen  lds
  v_mfma_f32_16x16x32_bf16 a[28:31], a[188:191], v[68:71], a[28:31]
  v_mfma_f32_16x16x32_bf16 a[24:27], a[184:187], v[68:71], a[24:27]
  ds_read_b128 v[96:99], v28 offset:0
  v_mfma_f32_16x16x32_bf16 a[24:27], a[168:171], v[64:67], a[24:27]
  s_add_u32 m0, s32, 30464
  v_mfma_f32_16x16x32_bf16 a[20:23], a[164:167], v[64:67], a[20:23]
  s_add_u32 s50, s43, 14680064
  v_mfma_f32_16x16x32_bf16 a[20:23], a[180:183], v[68:71], a[20:23]
  buffer_load_dwordx4 v29, s[8:11], s50 offen  lds
  v_mfma_f32_16x16x32_bf16 a[16:19], a[176:179], v[68:71], a[16:19]
  v_mfma_f32_16x16x32_bf16 a[16:19], a[160:163], v[64:67], a[16:19]
  ds_read_b128 v[104:107], v28 offset:128
  v_mfma_f32_16x16x32_bf16 a[32:35], a[160:163], v[68:71], a[32:35]
  v_mfma_f32_16x16x32_bf16 a[32:35], a[176:179], v[72:75], a[32:35]
  s_add_u32 m0, s32, 31552
  v_mfma_f32_16x16x32_bf16 a[36:39], a[180:183], v[72:75], a[36:39]
  buffer_load_dwordx4 v30, s[8:11], s50 offen  lds
  v_mfma_f32_16x16x32_bf16 a[36:39], a[164:167], v[68:71], a[36:39]
  v_mfma_f32_16x16x32_bf16 a[40:43], a[168:171], v[68:71], a[40:43]
  v_mfma_f32_16x16x32_bf16 a[40:43], a[184:187], v[72:75], a[40:43]
  ds_read_b128 v[100:103], v28 offset:256
  v_mfma_f32_16x16x32_bf16 a[44:47], a[188:191], v[72:75], a[44:47]
  v_mfma_f32_16x16x32_bf16 a[44:47], a[172:175], v[68:71], a[44:47]
  v_mfma_f32_16x16x32_bf16 a[60:63], a[172:175], v[72:75], a[60:63]
  v_mfma_f32_16x16x32_bf16 a[60:63], a[188:191], v[76:79], a[60:63]
  v_mfma_f32_16x16x32_bf16 a[56:59], a[184:187], v[76:79], a[56:59]
  v_mfma_f32_16x16x32_bf16 a[56:59], a[168:171], v[72:75], a[56:59]
  ds_read_b128 v[108:111], v28 offset:384
  v_mfma_f32_16x16x32_bf16 a[52:55], a[164:167], v[72:75], a[52:55]
  v_mfma_f32_16x16x32_bf16 a[52:55], a[180:183], v[76:79], a[52:55]
  v_mfma_f32_16x16x32_bf16 a[48:51], a[176:179], v[76:79], a[48:51]
  v_mfma_f32_16x16x32_bf16 a[48:51], a[160:163], v[72:75], a[48:51]
  v_mfma_f32_16x16x32_bf16 a[64:67], a[160:163], v[76:79], a[64:67]
  v_mfma_f32_16x16x32_bf16 a[64:67], a[176:179], v[80:83], a[64:67]
  ds_read_b64_tr_b16 a[144:145], v10 offset:4352
  ds_read_b128 v[112:115], v28 offset:512
  v_mfma_f32_16x16x32_bf16 a[68:71], a[180:183], v[80:83], a[68:71]
  ds_read_b64_tr_b16 a[146:147], v10 offset:4864
  v_mfma_f32_16x16x32_bf16 a[68:71], a[164:167], v[76:79], a[68:71]
  ds_read_b64_tr_b16 a[148:149], v11 offset:4384
  v_mfma_f32_16x16x32_bf16 a[72:75], a[168:171], v[76:79], a[72:75]
  ds_read_b64_tr_b16 a[150:151], v11 offset:4896
  v_mfma_f32_16x16x32_bf16 a[72:75], a[184:187], v[80:83], a[72:75]
  ds_read_b64_tr_b16 a[152:153], v10 offset:4416
  v_mfma_f32_16x16x32_bf16 a[76:79], a[188:191], v[80:83], a[76:79]
  ds_read_b64_tr_b16 a[154:155], v10 offset:4928
  ds_read_b128 v[116:119], v28 offset:640
  v_mfma_f32_16x16x32_bf16 a[76:79], a[172:175], v[76:79], a[76:79]
  ds_read_b64_tr_b16 a[156:157], v11 offset:4448
  v_mfma_f32_16x16x32_bf16 a[92:95], a[172:175], v[80:83], a[92:95]
  ds_read_b64_tr_b16 a[158:159], v11 offset:4960
  v_mfma_f32_16x16x32_bf16 a[92:95], a[188:191], v[84:87], a[92:95]
  v_mfma_f32_16x16x32_bf16 a[88:91], a[184:187], v[84:87], a[88:91]
  v_mfma_f32_16x16x32_bf16 a[88:91], a[168:171], v[80:83], a[88:91]
  v_mfma_f32_16x16x32_bf16 a[84:87], a[164:167], v[80:83], a[84:87]
  ds_read_b128 v[48:51], v28 offset:768
  v_mfma_f32_16x16x32_bf16 a[84:87], a[180:183], v[84:87], a[84:87]
  v_mfma_f32_16x16x32_bf16 a[80:83], a[176:179], v[84:87], a[80:83]
  v_mfma_f32_16x16x32_bf16 a[80:83], a[160:163], v[80:83], a[80:83]
  ds_read_b64_tr_b16 v[152:153], v12 offset:0
  v_mfma_f32_16x16x32_bf16 a[96:99], a[160:163], v[84:87], a[96:99]
  ds_read_b64_tr_b16 v[154:155], v12 offset:512
  v_mfma_f32_16x16x32_bf16 a[96:99], a[176:179], v[88:91], a[96:99]
  ds_read_b64_tr_b16 v[156:157], v12 offset:8
  v_mfma_f32_16x16x32_bf16 a[100:103], a[180:183], v[88:91], a[100:103]
  ds_read_b64_tr_b16 v[158:159], v12 offset:520
  ds_read_b128 v[52:55], v28 offset:896
  v_mfma_f32_16x16x32_bf16 a[100:103], a[164:167], v[84:87], a[100:103]
  ds_read_b64_tr_b16 v[160:161], v12 offset:64
  v_mfma_f32_16x16x32_bf16 a[104:107], a[168:171], v[84:87], a[104:107]
  ds_read_b64_tr_b16 v[162:163], v12 offset:576
  v_mfma_f32_16x16x32_bf16 a[104:107], a[184:187], v[88:91], a[104:107]
  ds_read_b64_tr_b16 v[164:165], v12 offset:72
  v_mfma_f32_16x16x32_bf16 a[108:111], a[188:191], v[88:91], a[108:111]
  ds_read_b64_tr_b16 v[166:167], v12 offset:584
  v_mfma_f32_16x16x32_bf16 a[108:111], a[172:175], v[84:87], a[108:111]
  v_mfma_f32_16x16x32_bf16 a[124:127], a[172:175], v[88:91], a[124:127]
  v_mfma_f32_16x16x32_bf16 a[124:127], a[188:191], v[92:95], a[124:127]
  v_mfma_f32_16x16x32_bf16 a[120:123], a[184:187], v[92:95], a[120:123]
  v_mfma_f32_16x16x32_bf16 a[120:123], a[168:171], v[88:91], a[120:123]
  v_mfma_f32_16x16x32_bf16 a[116:119], a[164:167], v[88:91], a[116:119]
  s_waitcnt lgkmcnt(0)
  v_mfma_f32_16x16x32_bf16 a[116:119], a[180:183], v[92:95], a[116:119]
  v_mfma_f32_16x16x32_bf16 a[112:115], a[176:179], v[92:95], a[112:115]
  v_mfma_f32_16x16x32_bf16 a[112:115], a[160:163], v[88:91], a[112:115]
  v_mfma_f32_16x16x32_bf16 a[0:3], a[128:131], v[96:99], a[0:3]
  s_waitcnt vmcnt(10)
  s_barrier
  v_mfma_f32_16x16x32_bf16 a[0:3], a[144:147], v[104:107], a[0:3]
  ds_read_b64_tr_b16 a[160:161], v10 offset:8704
  s_add_u32 m0, s25, 0
  v_mfma_f32_16x16x32_bf16 a[4:7], a[148:151], v[104:107], a[4:7]
  ds_read_b64_tr_b16 a[162:163], v10 offset:9216
  buffer_load_dwordx4 v5, s[8:11], s54 offen  lds
  v_mfma_f32_16x16x32_bf16 a[4:7], a[132:135], v[96:99], a[4:7]
  ds_read_b64_tr_b16 a[164:165], v11 offset:8736
  v_mfma_f32_16x16x32_bf16 a[8:11], a[136:139], v[96:99], a[8:11]
  ds_read_b64_tr_b16 a[166:167], v11 offset:9248
  v_mfma_f32_16x16x32_bf16 a[8:11], a[152:155], v[104:107], a[8:11]
  ds_read_b64_tr_b16 a[168:169], v10 offset:8768
  s_add_u32 m0, s29, 35904
  v_mfma_f32_16x16x32_bf16 a[12:15], a[156:159], v[104:107], a[12:15]
  ds_read_b64_tr_b16 a[170:171], v10 offset:9280
  s_add_u32 s51, s36, 0
  v_mfma_f32_16x16x32_bf16 a[12:15], a[140:143], v[96:99], a[12:15]
  ds_read_b64_tr_b16 a[172:173], v11 offset:8800
  buffer_load_dwordx4 v1, s[4:7], s51 offen  lds
  v_mfma_f32_16x16x32_bf16 a[28:31], a[140:143], v[104:107], a[28:31]
  ds_read_b64_tr_b16 a[174:175], v11 offset:9312
  v_mfma_f32_16x16x32_bf16 a[28:31], a[156:159], v[100:103], a[28:31]
  ds_read_b128 v[56:59], v28 offset:1056
  v_mfma_f32_16x16x32_bf16 a[24:27], a[152:155], v[100:103], a[24:27]
  v_mfma_f32_16x16x32_bf16 a[24:27], a[136:139], v[104:107], a[24:27]
  s_add_u32 m0, s25, 1088
  v_mfma_f32_16x16x32_bf16 a[20:23], a[132:135], v[104:107], a[20:23]
  buffer_load_dwordx4 v6, s[8:11], s54 offen  lds
  v_mfma_f32_16x16x32_bf16 a[20:23], a[148:151], v[100:103], a[20:23]
  v_mfma_f32_16x16x32_bf16 a[16:19], a[144:147], v[100:103], a[16:19]
  v_mfma_f32_16x16x32_bf16 a[16:19], a[128:131], v[104:107], a[16:19]
  s_add_u32 m0, s29, 40128
  v_mfma_f32_16x16x32_bf16 a[32:35], a[128:131], v[100:103], a[32:35]
  s_add_u32 s51, s36, 131072
  v_mfma_f32_16x16x32_bf16 a[32:35], a[144:147], v[108:111], a[32:35]
  buffer_load_dwordx4 v1, s[4:7], s51 offen  lds
  v_mfma_f32_16x16x32_bf16 a[36:39], a[148:151], v[108:111], a[36:39]
  v_mfma_f32_16x16x32_bf16 a[36:39], a[132:135], v[100:103], a[36:39]
  v_mfma_f32_16x16x32_bf16 a[40:43], a[136:139], v[100:103], a[40:43]
  v_mfma_f32_16x16x32_bf16 a[40:43], a[152:155], v[108:111], a[40:43]
  s_add_u32 m0, s25, 2176
  v_mfma_f32_16x16x32_bf16 a[44:47], a[156:159], v[108:111], a[44:47]
  buffer_load_dwordx4 v7, s[8:11], s54 offen  lds
  v_mfma_f32_16x16x32_bf16 a[44:47], a[140:143], v[100:103], a[44:47]
  v_mfma_f32_16x16x32_bf16 a[60:63], a[140:143], v[108:111], a[60:63]
  v_mfma_f32_16x16x32_bf16 a[60:63], a[156:159], v[112:115], a[60:63]
  v_mfma_f32_16x16x32_bf16 a[56:59], a[152:155], v[112:115], a[56:59]
  s_add_u32 m0, s25, 3264
  v_mfma_f32_16x16x32_bf16 a[56:59], a[136:139], v[108:111], a[56:59]
  buffer_load_dwordx4 v8, s[8:11], s54 offen  lds
  v_mfma_f32_16x16x32_bf16 a[52:55], a[132:135], v[108:111], a[52:55]
  v_mfma_f32_16x16x32_bf16 a[52:55], a[148:151], v[112:115], a[52:55]
  v_mfma_f32_16x16x32_bf16 a[48:51], a[144:147], v[112:115], a[48:51]
  s_add_u32 m0, s29, 44352
  v_mfma_f32_16x16x32_bf16 a[48:51], a[128:131], v[108:111], a[48:51]
  s_add_u32 s51, s36, 262144
  v_mfma_f32_16x16x32_bf16 a[64:67], a[128:131], v[112:115], a[64:67]
  buffer_load_dwordx4 v1, s[4:7], s51 offen  lds
  v_mfma_f32_16x16x32_bf16 a[64:67], a[144:147], v[116:119], a[64:67]
  ds_read_b64_tr_b16 a[176:177], v10 offset:13056
  v_mfma_f32_16x16x32_bf16 a[68:71], a[148:151], v[116:119], a[68:71]
  ds_read_b64_tr_b16 a[178:179], v10 offset:13568
  ds_read_b128 v[60:63], v28 offset:1184
  v_mfma_f32_16x16x32_bf16 a[68:71], a[132:135], v[112:115], a[68:71]
  ds_read_b64_tr_b16 a[180:181], v11 offset:13088
  v_mfma_f32_16x16x32_bf16 a[72:75], a[136:139], v[112:115], a[72:75]
  ds_read_b64_tr_b16 a[182:183], v11 offset:13600
  s_add_u32 s63, s61, 0
  v_mfma_f32_16x16x32_bf16 a[72:75], a[152:155], v[116:119], a[72:75]
  ds_read_b64_tr_b16 a[184:185], v10 offset:13120
  buffer_load_dwordx4 v[184:187], v15, s[4:7], s63 offen offset:0
  v_mfma_f32_16x16x32_bf16 a[76:79], a[156:159], v[116:119], a[76:79]
  ds_read_b64_tr_b16 a[186:187], v10 offset:13632
  v_mfma_f32_16x16x32_bf16 a[76:79], a[140:143], v[112:115], a[76:79]
  ds_read_b64_tr_b16 a[188:189], v11 offset:13152
  v_mfma_f32_16x16x32_bf16 a[92:95], a[140:143], v[116:119], a[92:95]
  ds_read_b64_tr_b16 a[190:191], v11 offset:13664
  v_mfma_f32_16x16x32_bf16 a[92:95], a[156:159], v[48:51], a[92:95]
  v_mfma_f32_16x16x32_bf16 a[88:91], a[152:155], v[48:51], a[88:91]
  buffer_load_dwordx4 v[188:191], v15, s[4:7], s63 offen offset:2048
  v_mfma_f32_16x16x32_bf16 a[88:91], a[136:139], v[116:119], a[88:91]
  v_mfma_f32_16x16x32_bf16 a[84:87], a[132:135], v[116:119], a[84:87]
  v_mfma_f32_16x16x32_bf16 a[84:87], a[148:151], v[48:51], a[84:87]
  s_add_u32 m0, s29, 48576
  v_mfma_f32_16x16x32_bf16 a[80:83], a[144:147], v[48:51], a[80:83]
  s_add_u32 s51, s36, 393216
  v_mfma_f32_16x16x32_bf16 a[80:83], a[128:131], v[116:119], a[80:83]
  buffer_load_dwordx4 v1, s[4:7], s51 offen  lds
  v_mfma_f32_16x16x32_bf16 a[96:99], a[128:131], v[48:51], a[96:99]
  v_mfma_f32_16x16x32_bf16 a[96:99], a[144:147], v[52:55], a[96:99]
  v_mfma_f32_16x16x32_bf16 a[100:103], a[148:151], v[52:55], a[100:103]
  v_mfma_f32_16x16x32_bf16 a[100:103], a[132:135], v[48:51], a[100:103]
  s_add_u32 s63, s61, 131072
  v_mfma_f32_16x16x32_bf16 a[104:107], a[136:139], v[48:51], a[104:107]
  buffer_load_dwordx4 v[192:195], v15, s[4:7], s63 offen offset:0
  v_mfma_f32_16x16x32_bf16 a[104:107], a[152:155], v[52:55], a[104:107]
  v_mfma_f32_16x16x32_bf16 a[108:111], a[156:159], v[52:55], a[108:111]
  v_mfma_f32_16x16x32_bf16 a[108:111], a[140:143], v[48:51], a[108:111]
  v_mfma_f32_16x16x32_bf16 a[124:127], a[140:143], v[52:55], a[124:127]
  s_waitcnt lgkmcnt(9)
  v_mfma_f32_16x16x32_bf16 a[124:127], a[156:159], v[56:59], a[124:127]
  buffer_load_dwordx4 v[196:199], v15, s[4:7], s63 offen offset:2048
  v_mfma_f32_16x16x32_bf16 a[120:123], a[152:155], v[56:59], a[120:123]
  v_mfma_f32_16x16x32_bf16 a[120:123], a[136:139], v[52:55], a[120:123]
  v_mfma_f32_16x16x32_bf16 a[116:119], a[132:135], v[52:55], a[116:119]
  ds_read_b128 v[64:67], v28 offset:1312
  s_add_u32 m0, s29, 53856
  v_mfma_f32_16x16x32_bf16 a[116:119], a[148:151], v[56:59], a[116:119]
  s_add_u32 s51, s36, 0
  v_mfma_f32_16x16x32_bf16 a[112:115], a[144:147], v[56:59], a[112:115]
  buffer_load_dwordx4 v26, s[4:7], s51 offen  lds
  v_mfma_f32_16x16x32_bf16 a[112:115], a[128:131], v[52:55], a[112:115]
  v_mfma_f32_16x16x32_bf16 a[0:3], a[160:163], v[100:103], a[0:3]
  s_waitcnt vmcnt(19) lgkmcnt(1)
  s_barrier
  v_mfma_f32_16x16x32_bf16 a[0:3], a[176:179], v[108:111], a[0:3]
  ds_read_b64_tr_b16 a[128:129], v10 offset:17408
  v_mfma_f32_16x16x32_bf16 a[4:7], a[180:183], v[108:111], a[4:7]
  ds_read_b64_tr_b16 a[130:131], v10 offset:17920
  s_add_u32 s63, s61, 262144
  v_mfma_f32_16x16x32_bf16 a[4:7], a[164:167], v[100:103], a[4:7]
  ds_read_b64_tr_b16 a[132:133], v11 offset:17440
  buffer_load_dwordx4 v[200:203], v16, s[4:7], s63 offen offset:0
  v_mfma_f32_16x16x32_bf16 a[8:11], a[168:171], v[100:103], a[8:11]
  ds_read_b64_tr_b16 a[134:135], v11 offset:17952
  v_mfma_f32_16x16x32_bf16 a[8:11], a[184:187], v[108:111], a[8:11]
  ds_read_b64_tr_b16 a[136:137], v10 offset:17472
  v_mfma_f32_16x16x32_bf16 a[12:15], a[188:191], v[108:111], a[12:15]
  ds_read_b64_tr_b16 a[138:139], v10 offset:17984
  v_mfma_f32_16x16x32_bf16 a[12:15], a[172:175], v[100:103], a[12:15]
  ds_read_b64_tr_b16 a[140:141], v11 offset:17504
  v_mfma_f32_16x16x32_bf16 a[28:31], a[172:175], v[108:111], a[28:31]
  ds_read_b64_tr_b16 a[142:143], v11 offset:18016
  buffer_load_dwordx4 v[204:207], v16, s[4:7], s63 offen offset:2048
  v_mfma_f32_16x16x32_bf16 a[28:31], a[188:191], v[112:115], a[28:31]
  v_mfma_f32_16x16x32_bf16 a[24:27], a[184:187], v[112:115], a[24:27]
  v_mfma_f32_16x16x32_bf16 a[24:27], a[168:171], v[108:111], a[24:27]
  s_add_u32 m0, s29, 58080
  v_mfma_f32_16x16x32_bf16 a[20:23], a[164:167], v[108:111], a[20:23]
  s_add_u32 s51, s36, 131072
  v_mfma_f32_16x16x32_bf16 a[20:23], a[180:183], v[112:115], a[20:23]
  buffer_load_dwordx4 v26, s[4:7], s51 offen  lds
  v_mfma_f32_16x16x32_bf16 a[16:19], a[176:179], v[112:115], a[16:19]
  v_mfma_f32_16x16x32_bf16 a[16:19], a[160:163], v[108:111], a[16:19]
  v_mfma_f32_16x16x32_bf16 a[32:35], a[160:163], v[112:115], a[32:35]
  s_add_u32 m0, s32, 0
  v_mfma_f32_16x16x32_bf16 a[32:35], a[176:179], v[116:119], a[32:35]
  s_add_u32 s50, s44, 0
  v_mfma_f32_16x16x32_bf16 a[36:39], a[180:183], v[116:119], a[36:39]
  buffer_load_dwordx4 v29, s[8:11], s50 offen  lds
  v_mfma_f32_16x16x32_bf16 a[36:39], a[164:167], v[112:115], a[36:39]
  v_mfma_f32_16x16x32_bf16 a[40:43], a[168:171], v[112:115], a[40:43]
  v_mfma_f32_16x16x32_bf16 a[40:43], a[184:187], v[116:119], a[40:43]
  s_add_u32 m0, s29, 62304
  v_mfma_f32_16x16x32_bf16 a[44:47], a[188:191], v[116:119], a[44:47]
  ds_read_b128 v[68:71], v28 offset:1440
  s_add_u32 s51, s36, 262144
  v_mfma_f32_16x16x32_bf16 a[44:47], a[172:175], v[112:115], a[44:47]
  buffer_load_dwordx4 v26, s[4:7], s51 offen  lds
  v_mfma_f32_16x16x32_bf16 a[60:63], a[172:175], v[116:119], a[60:63]
  v_mfma_f32_16x16x32_bf16 a[60:63], a[188:191], v[48:51], a[60:63]
  v_mfma_f32_16x16x32_bf16 a[56:59], a[184:187], v[48:51], a[56:59]
  v_mfma_f32_16x16x32_bf16 a[56:59], a[168:171], v[116:119], a[56:59]
  s_add_u32 m0, s32, 1088
  v_mfma_f32_16x16x32_bf16 a[52:55], a[164:167], v[116:119], a[52:55]
  buffer_load_dwordx4 v30, s[8:11], s50 offen  lds
  v_mfma_f32_16x16x32_bf16 a[52:55], a[180:183], v[48:51], a[52:55]
  v_mfma_f32_16x16x32_bf16 a[48:51], a[176:179], v[48:51], a[48:51]
  v_mfma_f32_16x16x32_bf16 a[48:51], a[160:163], v[116:119], a[48:51]
  s_add_u32 m0, s32, 4352
  v_mfma_f32_16x16x32_bf16 a[64:67], a[160:163], v[48:51], a[64:67]
  s_waitcnt vmcnt(11)
  s_waitcnt vmcnt(10)
  s_add_u32 s50, s44, 2097152
  v_mfma_f32_16x16x32_bf16 a[64:67], a[176:179], v[52:55], a[64:67]
  ds_read_b64_tr_b16 a[144:145], v10 offset:21760
  buffer_load_dwordx4 v29, s[8:11], s50 offen  lds
  v_mfma_f32_16x16x32_bf16 a[68:71], a[180:183], v[52:55], a[68:71]
  ds_read_b64_tr_b16 a[146:147], v10 offset:22272
  v_lshlrev_b32 v224, 16, v184
  v_mfma_f32_16x16x32_bf16 a[68:71], a[164:167], v[48:51], a[68:71]
  ds_read_b64_tr_b16 a[148:149], v11 offset:21792
  v_lshlrev_b32 v225, 16, v188
  v_mfma_f32_16x16x32_bf16 a[72:75], a[168:171], v[48:51], a[72:75]
  s_add_u32 m0, s29, 66528
  ds_read_b64_tr_b16 a[150:151], v11 offset:22304
  v_and_b32 v226, 0xffff0000, v184
  v_mfma_f32_16x16x32_bf16 a[72:75], a[184:187], v[52:55], a[72:75]
  s_add_u32 s51, s36, 393216
  ds_read_b64_tr_b16 a[152:153], v10 offset:21824
  v_and_b32 v227, 0xffff0000, v188
  v_mfma_f32_16x16x32_bf16 a[76:79], a[188:191], v[52:55], a[76:79]
  ds_read_b64_tr_b16 a[154:155], v10 offset:22336
  buffer_load_dwordx4 v26, s[4:7], s51 offen  lds
  v_mfma_f32_16x16x32_bf16 a[76:79], a[172:175], v[48:51], a[76:79]
  ds_read_b64_tr_b16 a[156:157], v11 offset:21856
  v_add_f32 v224, v224, v225
  v_mfma_f32_16x16x32_bf16 a[92:95], a[172:175], v[52:55], a[92:95]
  ds_read_b64_tr_b16 a[158:159], v11 offset:22368
  v_add_f32 v226, v226, v227
  v_mfma_f32_16x16x32_bf16 a[92:95], a[188:191], v[56:59], a[92:95]
  v_cvt_pk_bf16_f32 v184, v224, v226
  v_lshlrev_b32 v228, 16, v185
  v_mfma_f32_16x16x32_bf16 a[88:91], a[184:187], v[56:59], a[88:91]
  s_add_u32 m0, s32, 5440
  v_lshlrev_b32 v229, 16, v189
  v_and_b32 v230, 0xffff0000, v185
  v_mfma_f32_16x16x32_bf16 a[88:91], a[168:171], v[52:55], a[88:91]
  buffer_load_dwordx4 v30, s[8:11], s50 offen  lds
  v_and_b32 v231, 0xffff0000, v189
  v_mfma_f32_16x16x32_bf16 a[84:87], a[164:167], v[52:55], a[84:87]
  v_add_f32 v228, v228, v229
  v_add_f32 v230, v230, v231
  v_mfma_f32_16x16x32_bf16 a[84:87], a[180:183], v[56:59], a[84:87]
  v_cvt_pk_bf16_f32 v185, v228, v230
  v_lshlrev_b32 v224, 16, v186
  v_mfma_f32_16x16x32_bf16 a[80:83], a[176:179], v[56:59], a[80:83]
  s_add_u32 m0, s32, 8704
  v_lshlrev_b32 v225, 16, v190
  v_and_b32 v226, 0xffff0000, v186
  v_mfma_f32_16x16x32_bf16 a[80:83], a[160:163], v[52:55], a[80:83]
  s_add_u32 s50, s44, 4194304
  ds_read_b128 v[72:75], v28 offset:1568
  v_and_b32 v227, 0xffff0000, v190
  v_mfma_f32_16x16x32_bf16 a[96:99], a[160:163], v[56:59], a[96:99]
  buffer_load_dwordx4 v29, s[8:11], s50 offen  lds
  v_add_f32 v224, v224, v225
  v_mfma_f32_16x16x32_bf16 a[96:99], a[176:179], v[60:63], a[96:99]
  v_add_f32 v226, v226, v227
  v_cvt_pk_bf16_f32 v186, v224, v226
  v_mfma_f32_16x16x32_bf16 a[100:103], a[180:183], v[60:63], a[100:103]
  v_lshlrev_b32 v228, 16, v187
  v_lshlrev_b32 v229, 16, v191
  v_mfma_f32_16x16x32_bf16 a[100:103], a[164:167], v[56:59], a[100:103]
  s_mov_b32 m0, s31
  v_and_b32 v230, 0xffff0000, v187
  v_and_b32 v231, 0xffff0000, v191
  v_mfma_f32_16x16x32_bf16 a[104:107], a[168:171], v[56:59], a[104:107]
  s_add_u32 s51, s36, 524288
  v_add_f32 v228, v228, v229
  v_add_f32 v230, v230, v231
  v_mfma_f32_16x16x32_bf16 a[104:107], a[184:187], v[60:63], a[104:107]
  buffer_load_dwordx4 v2, s[4:7], s51 offen  lds
  v_cvt_pk_bf16_f32 v187, v228, v230
  v_mfma_f32_16x16x32_bf16 a[108:111], a[188:191], v[60:63], a[108:111]
  v_mfma_f32_16x16x32_bf16 a[108:111], a[172:175], v[56:59], a[108:111]
  v_mfma_f32_16x16x32_bf16 a[124:127], a[172:175], v[60:63], a[124:127]
  s_waitcnt lgkmcnt(15)
  v_mfma_f32_16x16x32_bf16 a[124:127], a[188:191], v[64:67], a[124:127]
  s_add_u32 s74, s62, 0
  v_mfma_f32_16x16x32_bf16 a[120:123], a[184:187], v[64:67], a[120:123]
  buffer_store_dwordx4 v[184:187], v17, s[12:15], s74 offen sc1
  v_mfma_f32_16x16x32_bf16 a[120:123], a[168:171], v[60:63], a[120:123]
  v_mfma_f32_16x16x32_bf16 a[116:119], a[164:167], v[60:63], a[116:119]
  v_mfma_f32_16x16x32_bf16 a[116:119], a[180:183], v[64:67], a[116:119]
  v_mfma_f32_16x16x32_bf16 a[112:115], a[176:179], v[64:67], a[112:115]
  s_add_u32 m0, s32, 9792
  v_mfma_f32_16x16x32_bf16 a[112:115], a[160:163], v[60:63], a[112:115]
  buffer_load_dwordx4 v30, s[8:11], s50 offen  lds
  v_mfma_f32_16x16x32_bf16 a[0:3], a[128:131], v[112:115], a[0:3]
  s_waitcnt lgkmcnt(1)
  s_barrier
  v_mfma_f32_16x16x32_bf16 a[0:3], a[144:147], v[116:119], a[0:3]
  ds_read_b64_tr_b16 a[160:161], v10 offset:26112
  v_mfma_f32_16x16x32_bf16 a[4:7], a[148:151], v[116:119], a[4:7]
  ds_read_b64_tr_b16 a[162:163], v10 offset:26624
  s_add_u32 m0, s32, 13056
  v_mfma_f32_16x16x32_bf16 a[4:7], a[132:135], v[112:115], a[4:7]
  ds_read_b64_tr_b16 a[164:165], v11 offset:26144
  s_add_u32 s50, s44, 6291456
  v_mfma_f32_16x16x32_bf16 a[8:11], a[136:139], v[112:115], a[8:11]
  ds_read_b64_tr_b16 a[166:167], v11 offset:26656
  buffer_load_dwordx4 v29, s[8:11], s50 offen  lds
  v_mfma_f32_16x16x32_bf16 a[8:11], a[152:155], v[116:119], a[8:11]
  ds_read_b64_tr_b16 a[168:169], v10 offset:26176
  v_mfma_f32_16x16x32_bf16 a[12:15], a[156:159], v[116:119], a[12:15]
  ds_read_b64_tr_b16 a[170:171], v10 offset:26688
  v_mfma_f32_16x16x32_bf16 a[12:15], a[140:143], v[112:115], a[12:15]
  ds_read_b64_tr_b16 a[172:173], v11 offset:26208
  v_mfma_f32_16x16x32_bf16 a[28:31], a[140:143], v[116:119], a[28:31]
  ds_read_b64_tr_b16 a[174:175], v11 offset:26720
  s_add_u32 m0, s32, 14144
  v_mfma_f32_16x16x32_bf16 a[28:31], a[156:159], v[48:51], a[28:31]
  ds_read_b128 v[76:79], v28 offset:1696
  buffer_load_dwordx4 v30, s[8:11], s50 offen  lds
  v_mfma_f32_16x16x32_bf16 a[24:27], a[152:155], v[48:51], a[24:27]
  v_mfma_f32_16x16x32_bf16 a[24:27], a[136:139], v[116:119], a[24:27]
  v_mfma_f32_16x16x32_bf16 a[20:23], a[132:135], v[116:119], a[20:23]
  s_add_u32 m0, s32, 17408
  v_mfma_f32_16x16x32_bf16 a[20:23], a[148:151], v[48:51], a[20:23]
  s_add_u32 s50, s44, 8388608
  v_mfma_f32_16x16x32_bf16 a[16:19], a[144:147], v[48:51], a[16:19]
  s_waitcnt vmcnt(17)
  s_waitcnt vmcnt(16)
  v_lshlrev_b32 v224, 16, v192
  v_mfma_f32_16x16x32_bf16 a[16:19], a[128:131], v[116:119], a[16:19]
  buffer_load_dwordx4 v29, s[8:11], s50 offen  lds
  v_lshlrev_b32 v225, 16, v196
  v_mfma_f32_16x16x32_bf16 a[32:35], a[128:131], v[48:51], a[32:35]
  v_and_b32 v226, 0xffff0000, v192
  v_and_b32 v227, 0xffff0000, v196
  v_mfma_f32_16x16x32_bf16 a[32:35], a[144:147], v[52:55], a[32:35]
  v_add_f32 v224, v224, v225
  v_add_f32 v226, v226, v227
  v_mfma_f32_16x16x32_bf16 a[36:39], a[148:151], v[52:55], a[36:39]
  s_add_u32 m0, s32, 18496
  v_cvt_pk_bf16_f32 v192, v224, v226
  v_lshlrev_b32 v228, 16, v193
  v_mfma_f32_16x16x32_bf16 a[36:39], a[132:135], v[48:51], a[36:39]
  buffer_load_dwordx4 v30, s[8:11], s50 offen  lds
  v_lshlrev_b32 v229, 16, v197
  v_mfma_f32_16x16x32_bf16 a[40:43], a[136:139], v[48:51], a[40:43]
  v_and_b32 v230, 0xffff0000, v193
  v_and_b32 v231, 0xffff0000, v197
  v_mfma_f32_16x16x32_bf16 a[40:43], a[152:155], v[52:55], a[40:43]
  v_add_f32 v228, v228, v229
  v_add_f32 v230, v230, v231
  v_mfma_f32_16x16x32_bf16 a[44:47], a[156:159], v[52:55], a[44:47]
  s_add_u32 m0, s32, 21760
  v_cvt_pk_bf16_f32 v193, v228, v230
  v_lshlrev_b32 v224, 16, v194
  v_mfma_f32_16x16x32_bf16 a[44:47], a[140:143], v[48:51], a[44:47]
  s_add_u32 s50, s44, 10485760
  v_lshlrev_b32 v225, 16, v198
  v_and_b32 v226, 0xffff0000, v194
  v_mfma_f32_16x16x32_bf16 a[60:63], a[140:143], v[52:55], a[60:63]
  buffer_load_dwordx4 v29, s[8:11], s50 offen  lds
  v_and_b32 v227, 0xffff0000, v198
  v_mfma_f32_16x16x32_bf16 a[60:63], a[156:159], v[56:59], a[60:63]
  v_add_f32 v224, v224, v225
  v_add_f32 v226, v226, v227
  v_mfma_f32_16x16x32_bf16 a[56:59], a[152:155], v[56:59], a[56:59]
  v_cvt_pk_bf16_f32 v194, v224, v226
  v_lshlrev_b32 v228, 16, v195
  v_mfma_f32_16x16x32_bf16 a[56:59], a[136:139], v[52:55], a[56:59]
  v_lshlrev_b32 v229, 16, v199
  v_and_b32 v230, 0xffff0000, v195
  v_mfma_f32_16x16x32_bf16 a[52:55], a[132:135], v[52:55], a[52:55]
  s_add_u32 s74, s62, 8192
  v_and_b32 v231, 0xffff0000, v199
  v_add_f32 v228, v228, v229
  v_add_f32 v230, v230, v231
  v_cvt_pk_bf16_f32 v195, v228, v230
  v_mfma_f32_16x16x32_bf16 a[52:55], a[148:151], v[56:59], a[52:55]
  buffer_store_dwordx4 v[192:195], v17, s[12:15], s74 offen sc1
  v_mfma_f32_16x16x32_bf16 a[48:51], a[144:147], v[56:59], a[48:51]
  v_mfma_f32_16x16x32_bf16 a[48:51], a[128:131], v[52:55], a[48:51]
  v_mfma_f32_16x16x32_bf16 a[64:67], a[128:131], v[56:59], a[64:67]
  v_mfma_f32_16x16x32_bf16 a[64:67], a[144:147], v[60:63], a[64:67]
  ds_read_b64_tr_b16 a[176:177], v10 offset:30464
  s_add_u32 m0, s32, 22848
  v_mfma_f32_16x16x32_bf16 a[68:71], a[148:151], v[60:63], a[68:71]
  ds_read_b64_tr_b16 a[178:179], v10 offset:30976
  buffer_load_dwordx4 v30, s[8:11], s50 offen  lds
  v_mfma_f32_16x16x32_bf16 a[68:71], a[132:135], v[56:59], a[68:71]
  ds_read_b64_tr_b16 a[180:181], v11 offset:30496
  ds_read_b128 v[80:83], v28 offset:1824
  v_mfma_f32_16x16x32_bf16 a[72:75], a[136:139], v[56:59], a[72:75]
  ds_read_b64_tr_b16 a[182:183], v11 offset:31008
  v_mfma_f32_16x16x32_bf16 a[72:75], a[152:155], v[60:63], a[72:75]
  ds_read_b64_tr_b16 a[184:185], v10 offset:30528
  v_mfma_f32_16x16x32_bf16 a[76:79], a[156:159], v[60:63], a[76:79]
  ds_read_b64_tr_b16 a[186:187], v10 offset:31040
  v_mfma_f32_16x16x32_bf16 a[76:79], a[140:143], v[56:59], a[76:79]
  ds_read_b64_tr_b16 a[188:189], v11 offset:30560
  v_mfma_f32_16x16x32_bf16 a[92:95], a[140:143], v[60:63], a[92:95]
  ds_read_b64_tr_b16 a[190:191], v11 offset:31072
  v_mfma_f32_16x16x32_bf16 a[92:95], a[156:159], v[64:67], a[92:95]
  v_mfma_f32_16x16x32_bf16 a[88:91], a[152:155], v[64:67], a[88:91]
  v_mfma_f32_16x16x32_bf16 a[88:91], a[136:139], v[60:63], a[88:91]
  v_mfma_f32_16x16x32_bf16 a[84:87], a[132:135], v[60:63], a[84:87]
  v_mfma_f32_16x16x32_bf16 a[84:87], a[148:151], v[64:67], a[84:87]
  v_mfma_f32_16x16x32_bf16 a[80:83], a[144:147], v[64:67], a[80:83]
  buffer_load_dword v255, v234, s[8:11], s45 offen offset:0
  v_mfma_f32_16x16x32_bf16 a[80:83], a[128:131], v[60:63], a[80:83]
  ds_read_b64_tr_b16 v[168:169], v12 offset:0
  v_mfma_f32_16x16x32_bf16 a[96:99], a[128:131], v[64:67], a[96:99]
  ds_read_b64_tr_b16 v[170:171], v12 offset:512
  v_mfma_f32_16x16x32_bf16 a[96:99], a[144:147], v[68:71], a[96:99]
  ds_read_b64_tr_b16 v[172:173], v12 offset:8
  v_mfma_f32_16x16x32_bf16 a[100:103], a[148:151], v[68:71], a[100:103]
  ds_read_b64_tr_b16 v[174:175], v12 offset:520
  v_mfma_f32_16x16x32_bf16 a[100:103], a[132:135], v[64:67], a[100:103]
  ds_read_b64_tr_b16 v[176:177], v12 offset:64
  buffer_load_dword v255, v233, s[4:7], s38 offen offset:0
  v_mfma_f32_16x16x32_bf16 a[104:107], a[136:139], v[64:67], a[104:107]
  ds_read_b64_tr_b16 v[178:179], v12 offset:576
  v_mfma_f32_16x16x32_bf16 a[104:107], a[152:155], v[68:71], a[104:107]
  ds_read_b64_tr_b16 v[180:181], v12 offset:72
  v_mfma_f32_16x16x32_bf16 a[108:111], a[156:159], v[68:71], a[108:111]
  ds_read_b64_tr_b16 v[182:183], v12 offset:584
  v_mfma_f32_16x16x32_bf16 a[108:111], a[140:143], v[64:67], a[108:111]
  s_waitcnt vmcnt(21)
  s_waitcnt vmcnt(20)
  v_lshlrev_b32 v224, 16, v200
  v_mfma_f32_16x16x32_bf16 a[124:127], a[140:143], v[68:71], a[124:127]
  s_waitcnt lgkmcnt(15)
  v_lshlrev_b32 v225, 16, v204
  v_and_b32 v226, 0xffff0000, v200
  v_mfma_f32_16x16x32_bf16 a[124:127], a[156:159], v[72:75], a[124:127]
  v_and_b32 v227, 0xffff0000, v204
  v_add_f32 v224, v224, v225
  v_mfma_f32_16x16x32_bf16 a[120:123], a[152:155], v[72:75], a[120:123]
  v_add_f32 v226, v226, v227
  v_cvt_pk_bf16_f32 v200, v224, v226
  v_mfma_f32_16x16x32_bf16 a[120:123], a[136:139], v[68:71], a[120:123]
  v_lshlrev_b32 v228, 16, v201
  v_lshlrev_b32 v229, 16, v205
  v_mfma_f32_16x16x32_bf16 a[116:119], a[132:135], v[68:71], a[116:119]
  s_waitcnt lgkmcnt(0)
  v_and_b32 v230, 0xffff0000, v201
  v_and_b32 v231, 0xffff0000, v205
  v_mfma_f32_16x16x32_bf16 a[116:119], a[148:151], v[72:75], a[116:119]
  v_add_f32 v228, v228, v229
  v_add_f32 v230, v230, v231
  v_mfma_f32_16x16x32_bf16 a[112:115], a[144:147], v[72:75], a[112:115]
  v_cvt_pk_bf16_f32 v201, v228, v230
  v_lshlrev_b32 v224, 16, v202
  v_mfma_f32_16x16x32_bf16 a[112:115], a[128:131], v[68:71], a[112:115]
  v_lshlrev_b32 v225, 16, v206
  v_and_b32 v226, 0xffff0000, v202
  v_mfma_f32_16x16x32_bf16 a[0:3], a[160:163], v[48:51], a[0:3]
  s_waitcnt vmcnt(11)
  s_barrier
  v_mfma_f32_16x16x32_bf16 a[0:3], a[176:179], v[52:55], a[0:3]
  s_add_u32 m0, s32, 26112
  ds_read_b64_tr_b16 a[128:129], v10 offset:0
  v_and_b32 v227, 0xffff0000, v206
  v_mfma_f32_16x16x32_bf16 a[4:7], a[180:183], v[52:55], a[4:7]
  s_add_u32 s50, s44, 12582912
  ds_read_b64_tr_b16 a[130:131], v10 offset:512
  v_add_f32 v224, v224, v225
  v_mfma_f32_16x16x32_bf16 a[4:7], a[164:167], v[48:51], a[4:7]
  ds_read_b64_tr_b16 a[132:133], v11 offset:32
  buffer_load_dwordx4 v29, s[8:11], s50 offen  lds
  v_mfma_f32_16x16x32_bf16 a[8:11], a[168:171], v[48:51], a[8:11]
  ds_read_b64_tr_b16 a[134:135], v11 offset:544
  v_add_f32 v226, v226, v227
  v_mfma_f32_16x16x32_bf16 a[8:11], a[184:187], v[52:55], a[8:11]
  ds_read_b64_tr_b16 a[136:137], v10 offset:64
  v_cvt_pk_bf16_f32 v202, v224, v226
  v_mfma_f32_16x16x32_bf16 a[12:15], a[188:191], v[52:55], a[12:15]
  ds_read_b64_tr_b16 a[138:139], v10 offset:576
  v_lshlrev_b32 v228, 16, v203
  v_mfma_f32_16x16x32_bf16 a[12:15], a[172:175], v[48:51], a[12:15]
  s_add_u32 m0, s32, 27200
  ds_read_b64_tr_b16 a[140:141], v11 offset:96
  v_lshlrev_b32 v229, 16, v207
  v_mfma_f32_16x16x32_bf16 a[28:31], a[172:175], v[52:55], a[28:31]
  ds_read_b64_tr_b16 a[142:143], v11 offset:608
  buffer_load_dwordx4 v30, s[8:11], s50 offen  lds
  v_mfma_f32_16x16x32_bf16 a[28:31], a[188:191], v[56:59], a[28:31]
  v_and_b32 v230, 0xffff0000, v203
  v_and_b32 v231, 0xffff0000, v207
  v_mfma_f32_16x16x32_bf16 a[24:27], a[184:187], v[56:59], a[24:27]
  ds_read_b128 v[84:87], v28 offset:35904
  v_add_f32 v228, v228, v229
  v_mfma_f32_16x16x32_bf16 a[24:27], a[168:171], v[52:55], a[24:27]
  v_add_f32 v230, v230, v231
  v_cvt_pk_bf16_f32 v203, v228, v230
  v_mfma_f32_16x16x32_bf16 a[20:23], a[164:167], v[52:55], a[20:23]
  s_add_u32 s74, s62, 16384
  v_mfma_f32_16x16x32_bf16 a[20:23], a[180:183], v[56:59], a[20:23]
  buffer_store_dwordx4 v[200:203], v18, s[12:15], s74 offen sc1
  v_mfma_f32_16x16x32_bf16 a[16:19], a[176:179], v[56:59], a[16:19]
  v_mfma_f32_16x16x32_bf16 a[16:19], a[160:163], v[52:55], a[16:19]
  ds_read_b128 v[92:95], v28 offset:36032
  v_mfma_f32_16x16x32_bf16 a[32:35], a[160:163], v[56:59], a[32:35]
  s_add_u32 m0, s32, 30464
  v_mfma_f32_16x16x32_bf16 a[32:35], a[176:179], v[60:63], a[32:35]
  s_add_u32 s50, s44, 14680064
  v_mfma_f32_16x16x32_bf16 a[36:39], a[180:183], v[60:63], a[36:39]
  buffer_load_dwordx4 v29, s[8:11], s50 offen  lds
  v_mfma_f32_16x16x32_bf16 a[36:39], a[164:167], v[56:59], a[36:39]
  v_mfma_f32_16x16x32_bf16 a[40:43], a[168:171], v[56:59], a[40:43]
  v_mfma_f32_16x16x32_bf16 a[40:43], a[184:187], v[60:63], a[40:43]
  ds_read_b128 v[88:91], v28 offset:36160
  v_mfma_f32_16x16x32_bf16 a[44:47], a[188:191], v[60:63], a[44:47]
  s_add_u32 m0, s32, 31552
  v_mfma_f32_16x16x32_bf16 a[44:47], a[172:175], v[56:59], a[44:47]
  buffer_load_dwordx4 v30, s[8:11], s50 offen  lds
  v_mfma_f32_16x16x32_bf16 a[60:63], a[172:175], v[60:63], a[60:63]
  v_mfma_f32_16x16x32_bf16 a[60:63], a[188:191], v[64:67], a[60:63]
  v_mfma_f32_16x16x32_bf16 a[56:59], a[184:187], v[64:67], a[56:59]
  v_mfma_f32_16x16x32_bf16 a[56:59], a[168:171], v[60:63], a[56:59]
  ds_read_b128 v[96:99], v28 offset:36288
  v_mfma_f32_16x16x32_bf16 a[52:55], a[164:167], v[60:63], a[52:55]
  v_mfma_f32_16x16x32_bf16 a[52:55], a[180:183], v[64:67], a[52:55]
  v_mfma_f32_16x16x32_bf16 a[48:51], a[176:179], v[64:67], a[48:51]
  v_mfma_f32_16x16x32_bf16 a[48:51], a[160:163], v[60:63], a[48:51]
  v_mfma_f32_16x16x32_bf16 a[64:67], a[160:163], v[64:67], a[64:67]
  v_mfma_f32_16x16x32_bf16 a[64:67], a[176:179], v[68:71], a[64:67]
  ds_read_b64_tr_b16 a[144:145], v10 offset:4352
  ds_read_b128 v[104:107], v28 offset:36416
  v_mfma_f32_16x16x32_bf16 a[68:71], a[180:183], v[68:71], a[68:71]
  ds_read_b64_tr_b16 a[146:147], v10 offset:4864
  v_mfma_f32_16x16x32_bf16 a[68:71], a[164:167], v[64:67], a[68:71]
  ds_read_b64_tr_b16 a[148:149], v11 offset:4384
  v_mfma_f32_16x16x32_bf16 a[72:75], a[168:171], v[64:67], a[72:75]
  ds_read_b64_tr_b16 a[150:151], v11 offset:4896
  v_mfma_f32_16x16x32_bf16 a[72:75], a[184:187], v[68:71], a[72:75]
  ds_read_b64_tr_b16 a[152:153], v10 offset:4416
  v_lshlrev_b32 v224, 16, v152
  v_mfma_f32_16x16x32_bf16 a[76:79], a[188:191], v[68:71], a[76:79]
  ds_read_b64_tr_b16 a[154:155], v10 offset:4928
  ds_read_b128 v[100:103], v28 offset:36544
  v_mfma_f32_16x16x32_bf16 a[76:79], a[172:175], v[64:67], a[76:79]
  ds_read_b64_tr_b16 a[156:157], v11 offset:4448
  v_lshlrev_b32 v225, 16, v168
  v_mfma_f32_16x16x32_bf16 a[92:95], a[172:175], v[68:71], a[92:95]
  ds_read_b64_tr_b16 a[158:159], v11 offset:4960
  v_and_b32 v226, 0xffff0000, v152
  v_mfma_f32_16x16x32_bf16 a[92:95], a[188:191], v[72:75], a[92:95]
  v_and_b32 v227, 0xffff0000, v168
  v_add_f32 v224, v224, v225
  v_mfma_f32_16x16x32_bf16 a[88:91], a[184:187], v[72:75], a[88:91]
  v_add_f32 v226, v226, v227
  v_cvt_pk_bf16_f32 v152, v224, v226
  v_mfma_f32_16x16x32_bf16 a[88:91], a[168:171], v[68:71], a[88:91]
  v_lshlrev_b32 v228, 16, v153
  v_lshlrev_b32 v229, 16, v169
  v_mfma_f32_16x16x32_bf16 a[84:87], a[164:167], v[68:71], a[84:87]
  ds_read_b128 v[108:111], v28 offset:36672
  v_and_b32 v230, 0xffff0000, v153
  v_mfma_f32_16x16x32_bf16 a[84:87], a[180:183], v[72:75], a[84:87]
  v_and_b32 v231, 0xffff0000, v169
  v_add_f32 v228, v228, v229
  v_mfma_f32_16x16x32_bf16 a[80:83], a[176:179], v[72:75], a[80:83]
  v_add_f32 v230, v230, v231
  v_cvt_pk_bf16_f32 v153, v228, v230
  v_mfma_f32_16x16x32_bf16 a[80:83], a[160:163], v[68:71], a[80:83]
  v_lshlrev_b32 v224, 16, v154
  v_lshlrev_b32 v225, 16, v170
  v_mfma_f32_16x16x32_bf16 a[96:99], a[160:163], v[72:75], a[96:99]
  v_and_b32 v226, 0xffff0000, v154
  v_and_b32 v227, 0xffff0000, v170
  v_mfma_f32_16x16x32_bf16 a[96:99], a[176:179], v[76:79], a[96:99]
  v_add_f32 v224, v224, v225
  v_add_f32 v226, v226, v227
  v_mfma_f32_16x16x32_bf16 a[100:103], a[180:183], v[76:79], a[100:103]
  ds_read_b128 v[112:115], v28 offset:36800
  v_cvt_pk_bf16_f32 v154, v224, v226
  v_mfma_f32_16x16x32_bf16 a[100:103], a[164:167], v[72:75], a[100:103]
  v_lshlrev_b32 v228, 16, v155
  v_lshlrev_b32 v229, 16, v171
  v_mfma_f32_16x16x32_bf16 a[104:107], a[168:171], v[72:75], a[104:107]
  v_and_b32 v230, 0xffff0000, v155
  v_and_b32 v231, 0xffff0000, v171
  v_mfma_f32_16x16x32_bf16 a[104:107], a[184:187], v[76:79], a[104:107]
  v_add_f32 v228, v228, v229
  v_add_f32 v230, v230, v231
  v_mfma_f32_16x16x32_bf16 a[108:111], a[188:191], v[76:79], a[108:111]
  v_cvt_pk_bf16_f32 v155, v228, v230
  v_mfma_f32_16x16x32_bf16 a[108:111], a[172:175], v[72:75], a[108:111]
  buffer_store_dwordx4 v[152:155], v14, s[12:15], s57 offen offset:0 sc1
  v_mfma_f32_16x16x32_bf16 a[124:127], a[172:175], v[76:79], a[124:127]
  v_mfma_f32_16x16x32_bf16 a[124:127], a[188:191], v[80:83], a[124:127]
  v_mfma_f32_16x16x32_bf16 a[120:123], a[184:187], v[80:83], a[120:123]
  v_mfma_f32_16x16x32_bf16 a[120:123], a[168:171], v[76:79], a[120:123]
  v_mfma_f32_16x16x32_bf16 a[116:119], a[164:167], v[76:79], a[116:119]
  v_mfma_f32_16x16x32_bf16 a[116:119], a[180:183], v[80:83], a[116:119]
  v_mfma_f32_16x16x32_bf16 a[112:115], a[176:179], v[80:83], a[112:115]
  v_mfma_f32_16x16x32_bf16 a[112:115], a[160:163], v[76:79], a[112:115]
  s_waitcnt lgkmcnt(15)
  v_mfma_f32_16x16x32_bf16 a[0:3], a[128:131], v[84:87], a[0:3]
  s_waitcnt vmcnt(13) lgkmcnt(2)
  s_barrier
  v_mfma_f32_16x16x32_bf16 a[0:3], a[144:147], v[92:95], a[0:3]
  ds_read_b64_tr_b16 a[160:161], v10 offset:8704
  s_add_u32 m0, s29, 0
  v_mfma_f32_16x16x32_bf16 a[4:7], a[148:151], v[92:95], a[4:7]
  ds_read_b64_tr_b16 a[162:163], v10 offset:9216
  s_add_u32 s51, s37, 0
  v_mfma_f32_16x16x32_bf16 a[4:7], a[132:135], v[84:87], a[4:7]
  ds_read_b64_tr_b16 a[164:165], v11 offset:8736
  buffer_load_dwordx4 v1, s[4:7], s51 offen  lds
  v_mfma_f32_16x16x32_bf16 a[8:11], a[136:139], v[84:87], a[8:11]
  ds_read_b64_tr_b16 a[166:167], v11 offset:9248
  v_mfma_f32_16x16x32_bf16 a[8:11], a[152:155], v[92:95], a[8:11]
  ds_read_b64_tr_b16 a[168:169], v10 offset:8768
  v_mfma_f32_16x16x32_bf16 a[12:15], a[156:159], v[92:95], a[12:15]
  ds_read_b64_tr_b16 a[170:171], v10 offset:9280
  s_add_u32 m0, s32, 0
  v_mfma_f32_16x16x32_bf16 a[12:15], a[140:143], v[84:87], a[12:15]
  ds_read_b64_tr_b16 a[172:173], v11 offset:8800
  s_add_u32 s50, s45, 0
  v_mfma_f32_16x16x32_bf16 a[28:31], a[140:143], v[92:95], a[28:31]
  ds_read_b64_tr_b16 a[174:175], v11 offset:9312
  buffer_load_dwordx4 v29, s[8:11], s50 offen  lds
  v_mfma_f32_16x16x32_bf16 a[28:31], a[156:159], v[88:91], a[28:31]
  ds_read_b128 v[116:119], v28 offset:36960
  v_mfma_f32_16x16x32_bf16 a[24:27], a[152:155], v[88:91], a[24:27]
  v_mfma_f32_16x16x32_bf16 a[24:27], a[136:139], v[92:95], a[24:27]
  v_mfma_f32_16x16x32_bf16 a[20:23], a[132:135], v[92:95], a[20:23]
  s_add_u32 m0, s32, 1088
  v_mfma_f32_16x16x32_bf16 a[20:23], a[148:151], v[88:91], a[20:23]
  buffer_load_dwordx4 v30, s[8:11], s50 offen  lds
  v_mfma_f32_16x16x32_bf16 a[16:19], a[144:147], v[88:91], a[16:19]
  v_mfma_f32_16x16x32_bf16 a[16:19], a[128:131], v[92:95], a[16:19]
  v_mfma_f32_16x16x32_bf16 a[32:35], a[128:131], v[88:91], a[32:35]
  s_add_u32 m0, s29, 4224
  v_mfma_f32_16x16x32_bf16 a[32:35], a[144:147], v[96:99], a[32:35]
  s_add_u32 s51, s37, 131072
  v_mfma_f32_16x16x32_bf16 a[36:39], a[148:151], v[96:99], a[36:39]
  buffer_load_dwordx4 v1, s[4:7], s51 offen  lds
  v_mfma_f32_16x16x32_bf16 a[36:39], a[132:135], v[88:91], a[36:39]
  v_mfma_f32_16x16x32_bf16 a[40:43], a[136:139], v[88:91], a[40:43]
  v_mfma_f32_16x16x32_bf16 a[40:43], a[152:155], v[96:99], a[40:43]
  s_add_u32 m0, s32, 4352
  v_mfma_f32_16x16x32_bf16 a[44:47], a[156:159], v[96:99], a[44:47]
  s_add_u32 s50, s45, 2097152
  v_mfma_f32_16x16x32_bf16 a[44:47], a[140:143], v[88:91], a[44:47]
  buffer_load_dwordx4 v29, s[8:11], s50 offen  lds
  v_mfma_f32_16x16x32_bf16 a[60:63], a[140:143], v[96:99], a[60:63]
  v_lshlrev_b32 v224, 16, v156
  v_lshlrev_b32 v225, 16, v172
  v_mfma_f32_16x16x32_bf16 a[60:63], a[156:159], v[104:107], a[60:63]
  v_and_b32 v226, 0xffff0000, v156
  v_and_b32 v227, 0xffff0000, v172
  v_mfma_f32_16x16x32_bf16 a[56:59], a[152:155], v[104:107], a[56:59]
  v_add_f32 v224, v224, v225
  v_add_f32 v226, v226, v227
  v_mfma_f32_16x16x32_bf16 a[56:59], a[136:139], v[96:99], a[56:59]
  s_add_u32 m0, s32, 5440
  v_cvt_pk_bf16_f32 v156, v224, v226
  v_lshlrev_b32 v228, 16, v157
  v_mfma_f32_16x16x32_bf16 a[52:55], a[132:135], v[96:99], a[52:55]
  buffer_load_dwordx4 v30, s[8:11], s50 offen  lds
  v_lshlrev_b32 v229, 16, v173
  v_mfma_f32_16x16x32_bf16 a[52:55], a[148:151], v[104:107], a[52:55]
  v_and_b32 v230, 0xffff0000, v157
  v_and_b32 v231, 0xffff0000, v173
  v_mfma_f32_16x16x32_bf16 a[48:51], a[144:147], v[104:107], a[48:51]
  v_add_f32 v228, v228, v229
  v_add_f32 v230, v230, v231
  v_mfma_f32_16x16x32_bf16 a[48:51], a[128:131], v[96:99], a[48:51]
  s_add_u32 m0, s29, 8448
  v_cvt_pk_bf16_f32 v157, v228, v230
  v_lshlrev_b32 v224, 16, v158
  v_mfma_f32_16x16x32_bf16 a[64:67], a[128:131], v[104:107], a[64:67]
  s_add_u32 s51, s37, 262144
  v_lshlrev_b32 v225, 16, v174
  v_and_b32 v226, 0xffff0000, v158
  v_mfma_f32_16x16x32_bf16 a[64:67], a[144:147], v[100:103], a[64:67]
  ds_read_b64_tr_b16 a[176:177], v10 offset:13056
  buffer_load_dwordx4 v1, s[4:7], s51 offen  lds
  v_mfma_f32_16x16x32_bf16 a[68:71], a[148:151], v[100:103], a[68:71]
  ds_read_b64_tr_b16 a[178:179], v10 offset:13568
  ds_read_b128 v[48:51], v28 offset:37088
  v_mfma_f32_16x16x32_bf16 a[68:71], a[132:135], v[104:107], a[68:71]
  ds_read_b64_tr_b16 a[180:181], v11 offset:13088
  v_and_b32 v227, 0xffff0000, v174
  v_mfma_f32_16x16x32_bf16 a[72:75], a[136:139], v[104:107], a[72:75]
  ds_read_b64_tr_b16 a[182:183], v11 offset:13600
  v_add_f32 v224, v224, v225
  v_mfma_f32_16x16x32_bf16 a[72:75], a[152:155], v[100:103], a[72:75]
  ds_read_b64_tr_b16 a[184:185], v10 offset:13120
  v_add_f32 v226, v226, v227
  v_mfma_f32_16x16x32_bf16 a[76:79], a[156:159], v[100:103], a[76:79]
  ds_read_b64_tr_b16 a[186:187], v10 offset:13632
  v_cvt_pk_bf16_f32 v158, v224, v226
  v_mfma_f32_16x16x32_bf16 a[76:79], a[140:143], v[104:107], a[76:79]
  ds_read_b64_tr_b16 a[188:189], v11 offset:13152
  v_lshlrev_b32 v228, 16, v159
  v_mfma_f32_16x16x32_bf16 a[92:95], a[140:143], v[100:103], a[92:95]
  s_waitcnt lgkmcnt(14)
  ds_read_b64_tr_b16 a[190:191], v11 offset:13664
  v_lshlrev_b32 v229, 16, v175
  v_mfma_f32_16x16x32_bf16 a[92:95], a[156:159], v[108:111], a[92:95]
  v_and_b32 v230, 0xffff0000, v159
  v_and_b32 v231, 0xffff0000, v175
  v_mfma_f32_16x16x32_bf16 a[88:91], a[152:155], v[108:111], a[88:91]
  v_add_f32 v228, v228, v229
  v_add_f32 v230, v230, v231
  v_cvt_pk_bf16_f32 v159, v228, v230
  v_mfma_f32_16x16x32_bf16 a[88:91], a[136:139], v[100:103], a[88:91]
  buffer_store_dwordx4 v[156:159], v14, s[12:15], s57 offen offset:1024 sc1
  v_mfma_f32_16x16x32_bf16 a[84:87], a[132:135], v[100:103], a[84:87]
  v_mfma_f32_16x16x32_bf16 a[84:87], a[148:151], v[108:111], a[84:87]
  v_mfma_f32_16x16x32_bf16 a[80:83], a[144:147], v[108:111], a[80:83]
  s_add_u32 m0, s29, 12672
  v_mfma_f32_16x16x32_bf16 a[80:83], a[128:131], v[100:103], a[80:83]
  s_add_u32 s51, s37, 393216
  v_mfma_f32_16x16x32_bf16 a[96:99], a[128:131], v[108:111], a[96:99]
  buffer_load_dwordx4 v1, s[4:7], s51 offen  lds
  v_mfma_f32_16x16x32_bf16 a[96:99], a[144:147], v[112:115], a[96:99]
  v_mfma_f32_16x16x32_bf16 a[100:103], a[148:151], v[112:115], a[100:103]
  v_mfma_f32_16x16x32_bf16 a[100:103], a[132:135], v[108:111], a[100:103]
  v_mfma_f32_16x16x32_bf16 a[104:107], a[136:139], v[108:111], a[104:107]
  v_mfma_f32_16x16x32_bf16 a[104:107], a[152:155], v[112:115], a[104:107]
  v_mfma_f32_16x16x32_bf16 a[108:111], a[156:159], v[112:115], a[108:111]
  v_mfma_f32_16x16x32_bf16 a[108:111], a[140:143], v[108:111], a[108:111]
  v_mfma_f32_16x16x32_bf16 a[124:127], a[140:143], v[112:115], a[124:127]
  s_waitcnt lgkmcnt(9)
  v_mfma_f32_16x16x32_bf16 a[124:127], a[156:159], v[116:119], a[124:127]
  s_add_u32 m0, s29, 17952
  v_mfma_f32_16x16x32_bf16 a[120:123], a[152:155], v[116:119], a[120:123]
  s_add_u32 s51, s37, 0
  v_mfma_f32_16x16x32_bf16 a[120:123], a[136:139], v[112:115], a[120:123]
  buffer_load_dwordx4 v26, s[4:7], s51 offen  lds
  v_mfma_f32_16x16x32_bf16 a[116:119], a[132:135], v[112:115], a[116:119]
  ds_read_b128 v[52:55], v28 offset:37216
  v_mfma_f32_16x16x32_bf16 a[116:119], a[148:151], v[116:119], a[116:119]
  v_mfma_f32_16x16x32_bf16 a[112:115], a[144:147], v[116:119], a[112:115]
  v_mfma_f32_16x16x32_bf16 a[112:115], a[128:131], v[112:115], a[112:115]
  v_mfma_f32_16x16x32_bf16 a[0:3], a[160:163], v[88:91], a[0:3]
  s_waitcnt vmcnt(18) lgkmcnt(1)
  s_barrier
  v_mfma_f32_16x16x32_bf16 a[0:3], a[176:179], v[96:99], a[0:3]
  ds_read_b64_tr_b16 a[128:129], v10 offset:17408
  s_add_u32 m0, s32, 8704
  v_mfma_f32_16x16x32_bf16 a[4:7], a[180:183], v[96:99], a[4:7]
  ds_read_b64_tr_b16 a[130:131], v10 offset:17920
  s_add_u32 s50, s45, 4194304
  v_mfma_f32_16x16x32_bf16 a[4:7], a[164:167], v[88:91], a[4:7]
  ds_read_b64_tr_b16 a[132:133], v11 offset:17440
  buffer_load_dwordx4 v29, s[8:11], s50 offen  lds
  v_mfma_f32_16x16x32_bf16 a[8:11], a[168:171], v[88:91], a[8:11]
  ds_read_b64_tr_b16 a[134:135], v11 offset:17952
  v_mfma_f32_16x16x32_bf16 a[8:11], a[184:187], v[96:99], a[8:11]
  ds_read_b64_tr_b16 a[136:137], v10 offset:17472
  v_mfma_f32_16x16x32_bf16 a[12:15], a[188:191], v[96:99], a[12:15]
  ds_read_b64_tr_b16 a[138:139], v10 offset:17984
  v_mfma_f32_16x16x32_bf16 a[12:15], a[172:175], v[88:91], a[12:15]
  ds_read_b64_tr_b16 a[140:141], v11 offset:17504
  s_add_u32 m0, s32, 9792
  v_mfma_f32_16x16x32_bf16 a[28:31], a[172:175], v[96:99], a[28:31]
  ds_read_b64_tr_b16 a[142:143], v11 offset:18016
  buffer_load_dwordx4 v30, s[8:11], s50 offen  lds
  v_mfma_f32_16x16x32_bf16 a[28:31], a[188:191], v[104:107], a[28:31]
  v_mfma_f32_16x16x32_bf16 a[24:27], a[184:187], v[104:107], a[24:27]
  v_mfma_f32_16x16x32_bf16 a[24:27], a[168:171], v[96:99], a[24:27]
  s_add_u32 m0, s29, 22176
  v_mfma_f32_16x16x32_bf16 a[20:23], a[164:167], v[96:99], a[20:23]
  s_add_u32 s51, s37, 131072
  v_lshlrev_b32 v224, 16, v160
  v_lshlrev_b32 v225, 16, v176
  v_mfma_f32_16x16x32_bf16 a[20:23], a[180:183], v[104:107], a[20:23]
  buffer_load_dwordx4 v26, s[4:7], s51 offen  lds
  v_and_b32 v226, 0xffff0000, v160
  v_mfma_f32_16x16x32_bf16 a[16:19], a[176:179], v[104:107], a[16:19]
  v_and_b32 v227, 0xffff0000, v176
  v_add_f32 v224, v224, v225
  v_mfma_f32_16x16x32_bf16 a[16:19], a[160:163], v[96:99], a[16:19]
  v_add_f32 v226, v226, v227
  v_cvt_pk_bf16_f32 v160, v224, v226
  v_mfma_f32_16x16x32_bf16 a[32:35], a[160:163], v[104:107], a[32:35]
  s_add_u32 m0, s32, 13056
  v_lshlrev_b32 v228, 16, v161
  v_lshlrev_b32 v229, 16, v177
  v_mfma_f32_16x16x32_bf16 a[32:35], a[176:179], v[100:103], a[32:35]
  s_add_u32 s50, s45, 6291456
  v_and_b32 v230, 0xffff0000, v161
  v_and_b32 v231, 0xffff0000, v177
  v_mfma_f32_16x16x32_bf16 a[36:39], a[180:183], v[100:103], a[36:39]
  buffer_load_dwordx4 v29, s[8:11], s50 offen  lds
  v_add_f32 v228, v228, v229
  v_mfma_f32_16x16x32_bf16 a[36:39], a[164:167], v[104:107], a[36:39]
  v_add_f32 v230, v230, v231
  v_cvt_pk_bf16_f32 v161, v228, v230
  v_mfma_f32_16x16x32_bf16 a[40:43], a[168:171], v[104:107], a[40:43]
  v_lshlrev_b32 v224, 16, v162
  v_lshlrev_b32 v225, 16, v178
  v_mfma_f32_16x16x32_bf16 a[40:43], a[184:187], v[100:103], a[40:43]
  s_add_u32 m0, s29, 26400
  v_and_b32 v226, 0xffff0000, v162
  v_and_b32 v227, 0xffff0000, v178
  v_mfma_f32_16x16x32_bf16 a[44:47], a[188:191], v[100:103], a[44:47]
  s_add_u32 s51, s37, 262144
  ds_read_b128 v[56:59], v28 offset:37344
  v_add_f32 v224, v224, v225
  v_mfma_f32_16x16x32_bf16 a[44:47], a[172:175], v[104:107], a[44:47]
  buffer_load_dwordx4 v26, s[4:7], s51 offen  lds
  v_add_f32 v226, v226, v227
  v_mfma_f32_16x16x32_bf16 a[60:63], a[172:175], v[100:103], a[60:63]
  v_cvt_pk_bf16_f32 v162, v224, v226
  v_lshlrev_b32 v228, 16, v163
  v_mfma_f32_16x16x32_bf16 a[60:63], a[188:191], v[108:111], a[60:63]
  v_lshlrev_b32 v229, 16, v179
  v_and_b32 v230, 0xffff0000, v163
  v_mfma_f32_16x16x32_bf16 a[56:59], a[184:187], v[108:111], a[56:59]
  v_and_b32 v231, 0xffff0000, v179
  v_add_f32 v228, v228, v229
  v_mfma_f32_16x16x32_bf16 a[56:59], a[168:171], v[100:103], a[56:59]
  v_add_f32 v230, v230, v231
  v_cvt_pk_bf16_f32 v163, v228, v230
  v_mfma_f32_16x16x32_bf16 a[52:55], a[164:167], v[100:103], a[52:55]
  buffer_store_dwordx4 v[160:163], v14, s[12:15], s58 offen offset:0 sc1
  v_mfma_f32_16x16x32_bf16 a[52:55], a[180:183], v[108:111], a[52:55]
  v_mfma_f32_16x16x32_bf16 a[48:51], a[176:179], v[108:111], a[48:51]
  v_mfma_f32_16x16x32_bf16 a[48:51], a[160:163], v[100:103], a[48:51]
  v_mfma_f32_16x16x32_bf16 a[64:67], a[160:163], v[108:111], a[64:67]
  s_add_u32 m0, s32, 14144
  v_mfma_f32_16x16x32_bf16 a[64:67], a[176:179], v[112:115], a[64:67]
  ds_read_b64_tr_b16 a[144:145], v10 offset:21760
  buffer_load_dwordx4 v30, s[8:11], s50 offen  lds
  v_mfma_f32_16x16x32_bf16 a[68:71], a[180:183], v[112:115], a[68:71]
  ds_read_b64_tr_b16 a[146:147], v10 offset:22272
  v_mfma_f32_16x16x32_bf16 a[68:71], a[164:167], v[108:111], a[68:71]
  ds_read_b64_tr_b16 a[148:149], v11 offset:21792
  v_mfma_f32_16x16x32_bf16 a[72:75], a[168:171], v[108:111], a[72:75]
  ds_read_b64_tr_b16 a[150:151], v11 offset:22304
  s_add_u32 m0, s29, 30624
  v_mfma_f32_16x16x32_bf16 a[72:75], a[184:187], v[112:115], a[72:75]
  ds_read_b64_tr_b16 a[152:153], v10 offset:21824
  s_add_u32 s51, s37, 393216
  v_mfma_f32_16x16x32_bf16 a[76:79], a[188:191], v[112:115], a[76:79]
  ds_read_b64_tr_b16 a[154:155], v10 offset:22336
  buffer_load_dwordx4 v26, s[4:7], s51 offen  lds
  v_mfma_f32_16x16x32_bf16 a[76:79], a[172:175], v[108:111], a[76:79]
  ds_read_b64_tr_b16 a[156:157], v11 offset:21856
  v_mfma_f32_16x16x32_bf16 a[92:95], a[172:175], v[112:115], a[92:95]
  ds_read_b64_tr_b16 a[158:159], v11 offset:22368
  v_mfma_f32_16x16x32_bf16 a[92:95], a[188:191], v[116:119], a[92:95]
  v_mfma_f32_16x16x32_bf16 a[88:91], a[184:187], v[116:119], a[88:91]
  v_mfma_f32_16x16x32_bf16 a[88:91], a[168:171], v[112:115], a[88:91]
  v_mfma_f32_16x16x32_bf16 a[84:87], a[164:167], v[112:115], a[84:87]
  v_mfma_f32_16x16x32_bf16 a[84:87], a[180:183], v[116:119], a[84:87]
  v_mfma_f32_16x16x32_bf16 a[80:83], a[176:179], v[116:119], a[80:83]
  v_mfma_f32_16x16x32_bf16 a[80:83], a[160:163], v[112:115], a[80:83]
  ds_read_b128 v[60:63], v28 offset:37472
  v_mfma_f32_16x16x32_bf16 a[96:99], a[160:163], v[116:119], a[96:99]
  v_mfma_f32_16x16x32_bf16 a[96:99], a[176:179], v[48:51], a[96:99]
  s_mov_b32 m0, s30
  v_mfma_f32_16x16x32_bf16 a[100:103], a[180:183], v[48:51], a[100:103]
  s_add_u32 s51, s37, 524288
  v_mfma_f32_16x16x32_bf16 a[100:103], a[164:167], v[116:119], a[100:103]
  buffer_load_dwordx4 v2, s[4:7], s51 offen  lds
  v_mfma_f32_16x16x32_bf16 a[104:107], a[168:171], v[116:119], a[104:107]
  v_mfma_f32_16x16x32_bf16 a[104:107], a[184:187], v[48:51], a[104:107]
  v_mfma_f32_16x16x32_bf16 a[108:111], a[188:191], v[48:51], a[108:111]
  v_mfma_f32_16x16x32_bf16 a[108:111], a[172:175], v[116:119], a[108:111]
  v_mfma_f32_16x16x32_bf16 a[124:127], a[172:175], v[48:51], a[124:127]
  s_waitcnt lgkmcnt(15)
  v_mfma_f32_16x16x32_bf16 a[124:127], a[188:191], v[52:55], a[124:127]
  v_mfma_f32_16x16x32_bf16 a[120:123], a[184:187], v[52:55], a[120:123]
  v_mfma_f32_16x16x32_bf16 a[120:123], a[168:171], v[48:51], a[120:123]
  v_mfma_f32_16x16x32_bf16 a[116:119], a[164:167], v[48:51], a[116:119]
  v_lshlrev_b32 v224, 16, v164
  v_lshlrev_b32 v225, 16, v180
  v_mfma_f32_16x16x32_bf16 a[116:119], a[180:183], v[52:55], a[116:119]
  v_and_b32 v226, 0xffff0000, v164
  v_and_b32 v227, 0xffff0000, v180
  v_mfma_f32_16x16x32_bf16 a[112:115], a[176:179], v[52:55], a[112:115]
  v_add_f32 v224, v224, v225
  v_add_f32 v226, v226, v227
  v_mfma_f32_16x16x32_bf16 a[112:115], a[160:163], v[48:51], a[112:115]
  v_cvt_pk_bf16_f32 v164, v224, v226
  v_lshlrev_b32 v228, 16, v165
  v_mfma_f32_16x16x32_bf16 a[0:3], a[128:131], v[104:107], a[0:3]
  s_waitcnt vmcnt(20) lgkmcnt(1)
  s_barrier
  v_mfma_f32_16x16x32_bf16 a[0:3], a[144:147], v[100:103], a[0:3]
  s_add_u32 m0, s32, 17408
  ds_read_b64_tr_b16 a[160:161], v10 offset:26112
  v_lshlrev_b32 v229, 16, v181
  v_mfma_f32_16x16x32_bf16 a[4:7], a[148:151], v[100:103], a[4:7]
  s_add_u32 s50, s45, 8388608
  ds_read_b64_tr_b16 a[162:163], v10 offset:26624
  v_and_b32 v230, 0xffff0000, v165
  v_mfma_f32_16x16x32_bf16 a[4:7], a[132:135], v[104:107], a[4:7]
  ds_read_b64_tr_b16 a[164:165], v11 offset:26144
  buffer_load_dwordx4 v29, s[8:11], s50 offen  lds
  v_mfma_f32_16x16x32_bf16 a[8:11], a[136:139], v[104:107], a[8:11]
  ds_read_b64_tr_b16 a[166:167], v11 offset:26656
  v_and_b32 v231, 0xffff0000, v181
  v_mfma_f32_16x16x32_bf16 a[8:11], a[152:155], v[100:103], a[8:11]
  ds_read_b64_tr_b16 a[168:169], v10 offset:26176
  v_add_f32 v228, v228, v229
  v_mfma_f32_16x16x32_bf16 a[12:15], a[156:159], v[100:103], a[12:15]
  ds_read_b64_tr_b16 a[170:171], v10 offset:26688
  v_add_f32 v230, v230, v231
  v_mfma_f32_16x16x32_bf16 a[12:15], a[140:143], v[104:107], a[12:15]
  s_add_u32 m0, s32, 18496
  ds_read_b64_tr_b16 a[172:173], v11 offset:26208
  v_cvt_pk_bf16_f32 v165, v228, v230
  v_mfma_f32_16x16x32_bf16 a[28:31], a[140:143], v[100:103], a[28:31]
  ds_read_b64_tr_b16 a[174:175], v11 offset:26720
  buffer_load_dwordx4 v30, s[8:11], s50 offen  lds
  v_mfma_f32_16x16x32_bf16 a[28:31], a[156:159], v[108:111], a[28:31]
  ds_read_b128 v[64:67], v28 offset:37600
  v_lshlrev_b32 v224, 16, v166
  v_mfma_f32_16x16x32_bf16 a[24:27], a[152:155], v[108:111], a[24:27]
  v_lshlrev_b32 v225, 16, v182
  v_and_b32 v226, 0xffff0000, v166
  v_mfma_f32_16x16x32_bf16 a[24:27], a[136:139], v[100:103], a[24:27]
  s_add_u32 m0, s32, 21760
  v_and_b32 v227, 0xffff0000, v182
  v_add_f32 v224, v224, v225
  v_mfma_f32_16x16x32_bf16 a[20:23], a[132:135], v[100:103], a[20:23]
  s_add_u32 s50, s45, 10485760
  v_add_f32 v226, v226, v227
  v_cvt_pk_bf16_f32 v166, v224, v226
  v_mfma_f32_16x16x32_bf16 a[20:23], a[148:151], v[108:111], a[20:23]
  buffer_load_dwordx4 v29, s[8:11], s50 offen  lds
  v_lshlrev_b32 v228, 16, v167
  v_mfma_f32_16x16x32_bf16 a[16:19], a[144:147], v[108:111], a[16:19]
  v_lshlrev_b32 v229, 16, v183
  v_and_b32 v230, 0xffff0000, v167
  v_mfma_f32_16x16x32_bf16 a[16:19], a[128:131], v[100:103], a[16:19]
  v_and_b32 v231, 0xffff0000, v183
  v_add_f32 v228, v228, v229
  v_mfma_f32_16x16x32_bf16 a[32:35], a[128:131], v[108:111], a[32:35]
  v_add_f32 v230, v230, v231
  v_cvt_pk_bf16_f32 v167, v228, v230
  v_mfma_f32_16x16x32_bf16 a[32:35], a[144:147], v[112:115], a[32:35]
  v_mfma_f32_16x16x32_bf16 a[36:39], a[148:151], v[112:115], a[36:39]
  buffer_store_dwordx4 v[164:167], v14, s[12:15], s58 offen offset:1024 sc1
  v_mfma_f32_16x16x32_bf16 a[36:39], a[132:135], v[108:111], a[36:39]
  v_mfma_f32_16x16x32_bf16 a[40:43], a[136:139], v[108:111], a[40:43]
  v_mfma_f32_16x16x32_bf16 a[40:43], a[152:155], v[112:115], a[40:43]
  v_mfma_f32_16x16x32_bf16 a[44:47], a[156:159], v[112:115], a[44:47]
  s_add_u32 m0, s32, 22848
  v_mfma_f32_16x16x32_bf16 a[44:47], a[140:143], v[108:111], a[44:47]
  buffer_load_dwordx4 v30, s[8:11], s50 offen  lds
  v_mfma_f32_16x16x32_bf16 a[60:63], a[140:143], v[112:115], a[60:63]
  v_mfma_f32_16x16x32_bf16 a[60:63], a[156:159], v[116:119], a[60:63]
  v_mfma_f32_16x16x32_bf16 a[56:59], a[152:155], v[116:119], a[56:59]
  v_mfma_f32_16x16x32_bf16 a[56:59], a[136:139], v[112:115], a[56:59]
  v_mfma_f32_16x16x32_bf16 a[52:55], a[132:135], v[112:115], a[52:55]
  v_mfma_f32_16x16x32_bf16 a[52:55], a[148:151], v[116:119], a[52:55]
  v_mfma_f32_16x16x32_bf16 a[48:51], a[144:147], v[116:119], a[48:51]
  v_mfma_f32_16x16x32_bf16 a[48:51], a[128:131], v[112:115], a[48:51]
  v_mfma_f32_16x16x32_bf16 a[64:67], a[128:131], v[116:119], a[64:67]
  v_mfma_f32_16x16x32_bf16 a[64:67], a[144:147], v[48:51], a[64:67]
  ds_read_b64_tr_b16 a[176:177], v10 offset:30464
  v_mfma_f32_16x16x32_bf16 a[68:71], a[148:151], v[48:51], a[68:71]
  ds_read_b64_tr_b16 a[178:179], v10 offset:30976
  v_mfma_f32_16x16x32_bf16 a[68:71], a[132:135], v[116:119], a[68:71]
  ds_read_b64_tr_b16 a[180:181], v11 offset:30496
  ds_read_b128 v[68:71], v28 offset:37728
  v_mfma_f32_16x16x32_bf16 a[72:75], a[136:139], v[116:119], a[72:75]
  ds_read_b64_tr_b16 a[182:183], v11 offset:31008
  v_mfma_f32_16x16x32_bf16 a[72:75], a[152:155], v[48:51], a[72:75]
  ds_read_b64_tr_b16 a[184:185], v10 offset:30528
  v_mfma_f32_16x16x32_bf16 a[76:79], a[156:159], v[48:51], a[76:79]
  ds_read_b64_tr_b16 a[186:187], v10 offset:31040
  v_mfma_f32_16x16x32_bf16 a[76:79], a[140:143], v[116:119], a[76:79]
  ds_read_b64_tr_b16 a[188:189], v11 offset:30560
  v_mfma_f32_16x16x32_bf16 a[92:95], a[140:143], v[48:51], a[92:95]
  ds_read_b64_tr_b16 a[190:191], v11 offset:31072
  v_mfma_f32_16x16x32_bf16 a[92:95], a[156:159], v[52:55], a[92:95]
  v_mfma_f32_16x16x32_bf16 a[88:91], a[152:155], v[52:55], a[88:91]
  v_mfma_f32_16x16x32_bf16 a[88:91], a[136:139], v[48:51], a[88:91]
  v_mfma_f32_16x16x32_bf16 a[84:87], a[132:135], v[48:51], a[84:87]
  v_mfma_f32_16x16x32_bf16 a[84:87], a[148:151], v[52:55], a[84:87]
  v_mfma_f32_16x16x32_bf16 a[80:83], a[144:147], v[52:55], a[80:83]
  buffer_load_dword v255, v234, s[8:11], s46 offen offset:0
  v_mfma_f32_16x16x32_bf16 a[80:83], a[128:131], v[48:51], a[80:83]
  v_mfma_f32_16x16x32_bf16 a[96:99], a[128:131], v[52:55], a[96:99]
  v_mfma_f32_16x16x32_bf16 a[96:99], a[144:147], v[56:59], a[96:99]
  v_mfma_f32_16x16x32_bf16 a[100:103], a[148:151], v[56:59], a[100:103]
  v_mfma_f32_16x16x32_bf16 a[100:103], a[132:135], v[52:55], a[100:103]
  buffer_load_dword v255, v233, s[4:7], s39 offen offset:0
  v_mfma_f32_16x16x32_bf16 a[104:107], a[136:139], v[52:55], a[104:107]
  v_mfma_f32_16x16x32_bf16 a[104:107], a[152:155], v[56:59], a[104:107]
  v_mfma_f32_16x16x32_bf16 a[108:111], a[156:159], v[56:59], a[108:111]
  v_mfma_f32_16x16x32_bf16 a[108:111], a[140:143], v[52:55], a[108:111]
  v_mfma_f32_16x16x32_bf16 a[124:127], a[140:143], v[56:59], a[124:127]
  s_waitcnt lgkmcnt(15)
  v_mfma_f32_16x16x32_bf16 a[124:127], a[156:159], v[60:63], a[124:127]
  v_mfma_f32_16x16x32_bf16 a[120:123], a[152:155], v[60:63], a[120:123]
  v_mfma_f32_16x16x32_bf16 a[120:123], a[136:139], v[56:59], a[120:123]
  v_mfma_f32_16x16x32_bf16 a[116:119], a[132:135], v[56:59], a[116:119]
  v_mfma_f32_16x16x32_bf16 a[116:119], a[148:151], v[60:63], a[116:119]
  v_mfma_f32_16x16x32_bf16 a[112:115], a[144:147], v[60:63], a[112:115]
  v_mfma_f32_16x16x32_bf16 a[112:115], a[128:131], v[56:59], a[112:115]
  v_mfma_f32_16x16x32_bf16 a[0:3], a[160:163], v[108:111], a[0:3]
  s_waitcnt vmcnt(3) lgkmcnt(0)
  s_barrier
  v_mfma_f32_16x16x32_bf16 a[0:3], a[176:179], v[112:115], a[0:3]
  ds_read_b64_tr_b16 a[128:129], v10 offset:0
  buffer_store_dwordx2 v[240:241], v245, s[12:15], 0 offen offset:0 sc1
  v_mfma_f32_16x16x32_bf16 a[4:7], a[180:183], v[112:115], a[4:7]
  ds_read_b64_tr_b16 a[130:131], v10 offset:512
  v_mfma_f32_16x16x32_bf16 a[4:7], a[164:167], v[108:111], a[4:7]
  ds_read_b64_tr_b16 a[132:133], v11 offset:32
  v_mfma_f32_16x16x32_bf16 a[8:11], a[168:171], v[108:111], a[8:11]
  ds_read_b64_tr_b16 a[134:135], v11 offset:544
  s_add_u32 m0, s32, 26112
  v_mfma_f32_16x16x32_bf16 a[8:11], a[184:187], v[112:115], a[8:11]
  ds_read_b64_tr_b16 a[136:137], v10 offset:64
  s_add_u32 s50, s45, 12582912
  v_mfma_f32_16x16x32_bf16 a[12:15], a[188:191], v[112:115], a[12:15]
  ds_read_b64_tr_b16 a[138:139], v10 offset:576
  buffer_load_dwordx4 v29, s[8:11], s50 offen  lds
  v_mfma_f32_16x16x32_bf16 a[12:15], a[172:175], v[108:111], a[12:15]
  ds_read_b64_tr_b16 a[140:141], v11 offset:96
  v_mfma_f32_16x16x32_bf16 a[28:31], a[172:175], v[112:115], a[28:31]
  ds_read_b64_tr_b16 a[142:143], v11 offset:608
  v_mfma_f32_16x16x32_bf16 a[28:31], a[188:191], v[116:119], a[28:31]
  v_mfma_f32_16x16x32_bf16 a[24:27], a[184:187], v[116:119], a[24:27]
  ds_read_b128 v[72:75], v28 offset:0
  s_add_u32 m0, s32, 27200
  v_mfma_f32_16x16x32_bf16 a[24:27], a[168:171], v[112:115], a[24:27]
  buffer_load_dwordx4 v30, s[8:11], s50 offen  lds
  v_mfma_f32_16x16x32_bf16 a[20:23], a[164:167], v[112:115], a[20:23]
  v_mfma_f32_16x16x32_bf16 a[20:23], a[180:183], v[116:119], a[20:23]
  v_mfma_f32_16x16x32_bf16 a[16:19], a[176:179], v[116:119], a[16:19]
  s_add_u32 m0, s32, 30464
  v_mfma_f32_16x16x32_bf16 a[16:19], a[160:163], v[112:115], a[16:19]
  ds_read_b128 v[80:83], v28 offset:128
  s_add_u32 s50, s45, 14680064
  v_mfma_f32_16x16x32_bf16 a[32:35], a[160:163], v[116:119], a[32:35]
  buffer_load_dwordx4 v29, s[8:11], s50 offen  lds
  v_mfma_f32_16x16x32_bf16 a[32:35], a[176:179], v[48:51], a[32:35]
  v_mfma_f32_16x16x32_bf16 a[36:39], a[180:183], v[48:51], a[36:39]
  v_mfma_f32_16x16x32_bf16 a[36:39], a[164:167], v[116:119], a[36:39]
  v_mfma_f32_16x16x32_bf16 a[40:43], a[168:171], v[116:119], a[40:43]
  s_add_u32 m0, s32, 31552
  v_mfma_f32_16x16x32_bf16 a[40:43], a[184:187], v[48:51], a[40:43]
  ds_read_b128 v[76:79], v28 offset:256
  buffer_load_dwordx4 v30, s[8:11], s50 offen  lds
  v_mfma_f32_16x16x32_bf16 a[44:47], a[188:191], v[48:51], a[44:47]
  v_mfma_f32_16x16x32_bf16 a[44:47], a[172:175], v[116:119], a[44:47]
  v_mfma_f32_16x16x32_bf16 a[60:63], a[172:175], v[48:51], a[60:63]
  v_mfma_f32_16x16x32_bf16 a[60:63], a[188:191], v[52:55], a[60:63]
  v_mfma_f32_16x16x32_bf16 a[56:59], a[184:187], v[52:55], a[56:59]
  v_mfma_f32_16x16x32_bf16 a[56:59], a[168:171], v[48:51], a[56:59]
  ds_read_b128 v[84:87], v28 offset:384
  v_mfma_f32_16x16x32_bf16 a[52:55], a[164:167], v[48:51], a[52:55]
  v_mfma_f32_16x16x32_bf16 a[52:55], a[180:183], v[52:55], a[52:55]
  v_mfma_f32_16x16x32_bf16 a[48:51], a[176:179], v[52:55], a[48:51]
  v_mfma_f32_16x16x32_bf16 a[48:51], a[160:163], v[48:51], a[48:51]
  v_mfma_f32_16x16x32_bf16 a[64:67], a[160:163], v[52:55], a[64:67]
  v_mfma_f32_16x16x32_bf16 a[64:67], a[176:179], v[56:59], a[64:67]
  ds_read_b64_tr_b16 a[144:145], v10 offset:4352
  ds_read_b128 v[92:95], v28 offset:512
  v_mfma_f32_16x16x32_bf16 a[68:71], a[180:183], v[56:59], a[68:71]
  ds_read_b64_tr_b16 a[146:147], v10 offset:4864
  v_mfma_f32_16x16x32_bf16 a[68:71], a[164:167], v[52:55], a[68:71]
  ds_read_b64_tr_b16 a[148:149], v11 offset:4384
  v_mfma_f32_16x16x32_bf16 a[72:75], a[168:171], v[52:55], a[72:75]
  ds_read_b64_tr_b16 a[150:151], v11 offset:4896
  v_mfma_f32_16x16x32_bf16 a[72:75], a[184:187], v[56:59], a[72:75]
  ds_read_b64_tr_b16 a[152:153], v10 offset:4416
L_it1:
  v_add_u32 v252, L_it1-standalone__self_sup_conv_stem_hubert__speech_kernel+3072, v253
  v_mfma_f32_16x16x32_bf16 a[76:79], a[188:191], v[56:59], a[76:79]
  ds_read_b64_tr_b16 a[154:155], v10 offset:4928
  ds_read_b128 v[88:91], v28 offset:640
  v_mfma_f32_16x16x32_bf16 a[76:79], a[172:175], v[52:55], a[76:79]
  ds_read_b64_tr_b16 a[156:157], v11 offset:4448
  v_min_u32 v252, L_end-standalone__self_sup_conv_stem_hubert__speech_kernel-8, v252
  v_mfma_f32_16x16x32_bf16 a[92:95], a[172:175], v[56:59], a[92:95]
  ds_read_b64_tr_b16 a[158:159], v11 offset:4960
  global_load_dword v255, v252, s[84:85]
  v_mfma_f32_16x16x32_bf16 a[92:95], a[188:191], v[60:63], a[92:95]
  v_mfma_f32_16x16x32_bf16 a[88:91], a[184:187], v[60:63], a[88:91]
  v_mfma_f32_16x16x32_bf16 a[88:91], a[168:171], v[56:59], a[88:91]
  v_mfma_f32_16x16x32_bf16 a[84:87], a[164:167], v[56:59], a[84:87]
  ds_read_b128 v[96:99], v28 offset:768
  v_mfma_f32_16x16x32_bf16 a[84:87], a[180:183], v[60:63], a[84:87]
  v_mfma_f32_16x16x32_bf16 a[80:83], a[176:179], v[60:63], a[80:83]
  v_mfma_f32_16x16x32_bf16 a[80:83], a[160:163], v[56:59], a[80:83]
  v_mfma_f32_16x16x32_bf16 a[96:99], a[160:163], v[60:63], a[96:99]
  v_mfma_f32_16x16x32_bf16 a[96:99], a[176:179], v[64:67], a[96:99]
  v_mfma_f32_16x16x32_bf16 a[100:103], a[180:183], v[64:67], a[100:103]
  ds_read_b128 v[104:107], v28 offset:896
  v_mfma_f32_16x16x32_bf16 a[100:103], a[164:167], v[60:63], a[100:103]
  v_mfma_f32_16x16x32_bf16 a[104:107], a[168:171], v[60:63], a[104:107]
  v_mfma_f32_16x16x32_bf16 a[104:107], a[184:187], v[64:67], a[104:107]
  v_mfma_f32_16x16x32_bf16 a[108:111], a[188:191], v[64:67], a[108:111]
  v_mfma_f32_16x16x32_bf16 a[108:111], a[172:175], v[60:63], a[108:111]
  v_mfma_f32_16x16x32_bf16 a[124:127], a[172:175], v[64:67], a[124:127]
  v_mfma_f32_16x16x32_bf16 a[124:127], a[188:191], v[68:71], a[124:127]
  v_mfma_f32_16x16x32_bf16 a[120:123], a[184:187], v[68:71], a[120:123]
  v_mfma_f32_16x16x32_bf16 a[120:123], a[168:171], v[64:67], a[120:123]
  v_mfma_f32_16x16x32_bf16 a[116:119], a[164:167], v[64:67], a[116:119]
  v_mfma_f32_16x16x32_bf16 a[116:119], a[180:183], v[68:71], a[116:119]
  v_mfma_f32_16x16x32_bf16 a[112:115], a[176:179], v[68:71], a[112:115]
  v_mfma_f32_16x16x32_bf16 a[112:115], a[160:163], v[64:67], a[112:115]
  s_waitcnt lgkmcnt(15)
  v_mfma_f32_16x16x32_bf16 a[0:3], a[128:131], v[72:75], a[0:3]
  s_waitcnt lgkmcnt(2)
  s_barrier
  v_mfma_f32_16x16x32_bf16 a[0:3], a[144:147], v[80:83], a[0:3]
  ds_read_b64_tr_b16 a[160:161], v10 offset:8704
  s_add_u32 m0, s29, 35904
  v_mfma_f32_16x16x32_bf16 a[4:7], a[148:151], v[80:83], a[4:7]
  ds_read_b64_tr_b16 a[162:163], v10 offset:9216
  s_add_u32 s51, s38, 0
  v_mfma_f32_16x16x32_bf16 a[4:7], a[132:135], v[72:75], a[4:7]
  ds_read_b64_tr_b16 a[164:165], v11 offset:8736
  buffer_load_dwordx4 v1, s[4:7], s51 offen  lds
  v_mfma_f32_16x16x32_bf16 a[8:11], a[136:139], v[72:75], a[8:11]
  ds_read_b64_tr_b16 a[166:167], v11 offset:9248
  v_mfma_f32_16x16x32_bf16 a[8:11], a[152:155], v[80:83], a[8:11]
  ds_read_b64_tr_b16 a[168:169], v10 offset:8768
  v_mfma_f32_16x16x32_bf16 a[12:15], a[156:159], v[80:83], a[12:15]
  ds_read_b64_tr_b16 a[170:171], v10 offset:9280
  s_add_u32 m0, s32, 0
  v_mfma_f32_16x16x32_bf16 a[12:15], a[140:143], v[72:75], a[12:15]
  ds_read_b64_tr_b16 a[172:173], v11 offset:8800
  s_add_u32 s50, s46, 0
  v_mfma_f32_16x16x32_bf16 a[28:31], a[140:143], v[80:83], a[28:31]
  ds_read_b64_tr_b16 a[174:175], v11 offset:9312
  buffer_load_dwordx4 v29, s[8:11], s50 offen  lds
  v_mfma_f32_16x16x32_bf16 a[28:31], a[156:159], v[76:79], a[28:31]
  ds_read_b128 v[100:103], v28 offset:1056
  v_mfma_f32_16x16x32_bf16 a[24:27], a[152:155], v[76:79], a[24:27]
  v_mfma_f32_16x16x32_bf16 a[24:27], a[136:139], v[80:83], a[24:27]
  v_mfma_f32_16x16x32_bf16 a[20:23], a[132:135], v[80:83], a[20:23]
  s_add_u32 m0, s32, 1088
  v_mfma_f32_16x16x32_bf16 a[20:23], a[148:151], v[76:79], a[20:23]
  buffer_load_dwordx4 v30, s[8:11], s50 offen  lds
  v_mfma_f32_16x16x32_bf16 a[16:19], a[144:147], v[76:79], a[16:19]
  v_mfma_f32_16x16x32_bf16 a[16:19], a[128:131], v[80:83], a[16:19]
  v_mfma_f32_16x16x32_bf16 a[32:35], a[128:131], v[76:79], a[32:35]
  s_add_u32 m0, s29, 40128
  v_mfma_f32_16x16x32_bf16 a[32:35], a[144:147], v[84:87], a[32:35]
  s_add_u32 s51, s38, 131072
  v_mfma_f32_16x16x32_bf16 a[36:39], a[148:151], v[84:87], a[36:39]
  buffer_load_dwordx4 v1, s[4:7], s51 offen  lds
  v_mfma_f32_16x16x32_bf16 a[36:39], a[132:135], v[76:79], a[36:39]
  v_mfma_f32_16x16x32_bf16 a[40:43], a[136:139], v[76:79], a[40:43]
  v_mfma_f32_16x16x32_bf16 a[40:43], a[152:155], v[84:87], a[40:43]
  s_add_u32 m0, s32, 4352
  v_mfma_f32_16x16x32_bf16 a[44:47], a[156:159], v[84:87], a[44:47]
  s_add_u32 s50, s46, 2097152
  v_mfma_f32_16x16x32_bf16 a[44:47], a[140:143], v[76:79], a[44:47]
  buffer_load_dwordx4 v29, s[8:11], s50 offen  lds
  v_mfma_f32_16x16x32_bf16 a[60:63], a[140:143], v[84:87], a[60:63]
  v_mfma_f32_16x16x32_bf16 a[60:63], a[156:159], v[92:95], a[60:63]
  v_mfma_f32_16x16x32_bf16 a[56:59], a[152:155], v[92:95], a[56:59]
  v_mfma_f32_16x16x32_bf16 a[56:59], a[136:139], v[84:87], a[56:59]
  s_add_u32 m0, s32, 5440
  v_mfma_f32_16x16x32_bf16 a[52:55], a[132:135], v[84:87], a[52:55]
  buffer_load_dwordx4 v30, s[8:11], s50 offen  lds
  v_mfma_f32_16x16x32_bf16 a[52:55], a[148:151], v[92:95], a[52:55]
  v_mfma_f32_16x16x32_bf16 a[48:51], a[144:147], v[92:95], a[48:51]
  v_mfma_f32_16x16x32_bf16 a[48:51], a[128:131], v[84:87], a[48:51]
  s_add_u32 m0, s29, 44352
  v_mfma_f32_16x16x32_bf16 a[64:67], a[128:131], v[92:95], a[64:67]
  s_add_u32 s51, s38, 262144
  v_mfma_f32_16x16x32_bf16 a[64:67], a[144:147], v[88:91], a[64:67]
  ds_read_b64_tr_b16 a[176:177], v10 offset:13056
  buffer_load_dwordx4 v1, s[4:7], s51 offen  lds
  v_mfma_f32_16x16x32_bf16 a[68:71], a[148:151], v[88:91], a[68:71]
  ds_read_b64_tr_b16 a[178:179], v10 offset:13568
  ds_read_b128 v[108:111], v28 offset:1184
  v_mfma_f32_16x16x32_bf16 a[68:71], a[132:135], v[92:95], a[68:71]
  ds_read_b64_tr_b16 a[180:181], v11 offset:13088
  v_mfma_f32_16x16x32_bf16 a[72:75], a[136:139], v[92:95], a[72:75]
  ds_read_b64_tr_b16 a[182:183], v11 offset:13600
  v_mfma_f32_16x16x32_bf16 a[72:75], a[152:155], v[88:91], a[72:75]
  ds_read_b64_tr_b16 a[184:185], v10 offset:13120
  v_mfma_f32_16x16x32_bf16 a[76:79], a[156:159], v[88:91], a[76:79]
  ds_read_b64_tr_b16 a[186:187], v10 offset:13632
  v_mfma_f32_16x16x32_bf16 a[76:79], a[140:143], v[92:95], a[76:79]
  ds_read_b64_tr_b16 a[188:189], v11 offset:13152
  v_mfma_f32_16x16x32_bf16 a[92:95], a[140:143], v[88:91], a[92:95]
  ds_read_b64_tr_b16 a[190:191], v11 offset:13664
  s_waitcnt lgkmcnt(15)
  v_mfma_f32_16x16x32_bf16 a[92:95], a[156:159], v[96:99], a[92:95]
  v_mfma_f32_16x16x32_bf16 a[88:91], a[152:155], v[96:99], a[88:91]
  v_mfma_f32_16x16x32_bf16 a[88:91], a[136:139], v[88:91], a[88:91]
  s_add_u32 m0, s29, 48576
  v_mfma_f32_16x16x32_bf16 a[84:87], a[132:135], v[88:91], a[84:87]
  s_add_u32 s51, s38, 393216
  v_mfma_f32_16x16x32_bf16 a[84:87], a[148:151], v[96:99], a[84:87]
  buffer_load_dwordx4 v1, s[4:7], s51 offen  lds
  v_mfma_f32_16x16x32_bf16 a[80:83], a[144:147], v[96:99], a[80:83]
  v_mfma_f32_16x16x32_bf16 a[80:83], a[128:131], v[88:91], a[80:83]
  v_mfma_f32_16x16x32_bf16 a[96:99], a[128:131], v[96:99], a[96:99]
  v_mfma_f32_16x16x32_bf16 a[96:99], a[144:147], v[104:107], a[96:99]
  v_mfma_f32_16x16x32_bf16 a[100:103], a[148:151], v[104:107], a[100:103]
  v_mfma_f32_16x16x32_bf16 a[100:103], a[132:135], v[96:99], a[100:103]
  v_mfma_f32_16x16x32_bf16 a[104:107], a[136:139], v[96:99], a[104:107]
  v_mfma_f32_16x16x32_bf16 a[104:107], a[152:155], v[104:107], a[104:107]
  v_mfma_f32_16x16x32_bf16 a[108:111], a[156:159], v[104:107], a[108:111]
  v_mfma_f32_16x16x32_bf16 a[108:111], a[140:143], v[96:99], a[108:111]
  v_mfma_f32_16x16x32_bf16 a[124:127], a[140:143], v[104:107], a[124:127]
  s_waitcnt lgkmcnt(9)
  v_mfma_f32_16x16x32_bf16 a[124:127], a[156:159], v[100:103], a[124:127]
  s_add_u32 m0, s29, 53856
  v_mfma_f32_16x16x32_bf16 a[120:123], a[152:155], v[100:103], a[120:123]
  s_add_u32 s51, s38, 0
  v_mfma_f32_16x16x32_bf16 a[120:123], a[136:139], v[104:107], a[120:123]
  buffer_load_dwordx4 v26, s[4:7], s51 offen  lds
  v_mfma_f32_16x16x32_bf16 a[116:119], a[132:135], v[104:107], a[116:119]
  ds_read_b128 v[112:115], v28 offset:1312
  v_mfma_f32_16x16x32_bf16 a[116:119], a[148:151], v[100:103], a[116:119]
  v_mfma_f32_16x16x32_bf16 a[112:115], a[144:147], v[100:103], a[112:115]
  v_mfma_f32_16x16x32_bf16 a[112:115], a[128:131], v[104:107], a[112:115]
  v_mfma_f32_16x16x32_bf16 a[0:3], a[160:163], v[76:79], a[0:3]
  s_waitcnt vmcnt(17) lgkmcnt(1)
  s_barrier
  v_mfma_f32_16x16x32_bf16 a[0:3], a[176:179], v[84:87], a[0:3]
  ds_read_b64_tr_b16 a[128:129], v10 offset:17408
  s_add_u32 m0, s32, 8704
  v_mfma_f32_16x16x32_bf16 a[4:7], a[180:183], v[84:87], a[4:7]
  ds_read_b64_tr_b16 a[130:131], v10 offset:17920
  s_add_u32 s50, s46, 4194304
  v_mfma_f32_16x16x32_bf16 a[4:7], a[164:167], v[76:79], a[4:7]
  ds_read_b64_tr_b16 a[132:133], v11 offset:17440
  buffer_load_dwordx4 v29, s[8:11], s50 offen  lds
  v_mfma_f32_16x16x32_bf16 a[8:11], a[168:171], v[76:79], a[8:11]
  ds_read_b64_tr_b16 a[134:135], v11 offset:17952
  v_mfma_f32_16x16x32_bf16 a[8:11], a[184:187], v[84:87], a[8:11]
  ds_read_b64_tr_b16 a[136:137], v10 offset:17472
  v_mfma_f32_16x16x32_bf16 a[12:15], a[188:191], v[84:87], a[12:15]
  ds_read_b64_tr_b16 a[138:139], v10 offset:17984
  v_mfma_f32_16x16x32_bf16 a[12:15], a[172:175], v[76:79], a[12:15]
  ds_read_b64_tr_b16 a[140:141], v11 offset:17504
  s_add_u32 m0, s32, 9792
  v_mfma_f32_16x16x32_bf16 a[28:31], a[172:175], v[84:87], a[28:31]
  ds_read_b64_tr_b16 a[142:143], v11 offset:18016
  buffer_load_dwordx4 v30, s[8:11], s50 offen  lds
  v_mfma_f32_16x16x32_bf16 a[28:31], a[188:191], v[92:95], a[28:31]
  v_mfma_f32_16x16x32_bf16 a[24:27], a[184:187], v[92:95], a[24:27]
  v_mfma_f32_16x16x32_bf16 a[24:27], a[168:171], v[84:87], a[24:27]
  s_add_u32 m0, s29, 58080
  v_mfma_f32_16x16x32_bf16 a[20:23], a[164:167], v[84:87], a[20:23]
  s_add_u32 s51, s38, 131072
  v_mfma_f32_16x16x32_bf16 a[20:23], a[180:183], v[92:95], a[20:23]
  buffer_load_dwordx4 v26, s[4:7], s51 offen  lds
  v_mfma_f32_16x16x32_bf16 a[16:19], a[176:179], v[92:95], a[16:19]
  v_mfma_f32_16x16x32_bf16 a[16:19], a[160:163], v[84:87], a[16:19]
  v_mfma_f32_16x16x32_bf16 a[32:35], a[160:163], v[92:95], a[32:35]
  s_add_u32 m0, s32, 13056
  v_mfma_f32_16x16x32_bf16 a[32:35], a[176:179], v[88:91], a[32:35]
  s_add_u32 s50, s46, 6291456
  v_mfma_f32_16x16x32_bf16 a[36:39], a[180:183], v[88:91], a[36:39]
  buffer_load_dwordx4 v29, s[8:11], s50 offen  lds
  v_mfma_f32_16x16x32_bf16 a[36:39], a[164:167], v[92:95], a[36:39]
  v_mfma_f32_16x16x32_bf16 a[40:43], a[168:171], v[92:95], a[40:43]
  v_mfma_f32_16x16x32_bf16 a[40:43], a[184:187], v[88:91], a[40:43]
  s_add_u32 m0, s29, 62304
  v_mfma_f32_16x16x32_bf16 a[44:47], a[188:191], v[88:91], a[44:47]
  ds_read_b128 v[116:119], v28 offset:1440
  s_add_u32 s51, s38, 262144
  v_mfma_f32_16x16x32_bf16 a[44:47], a[172:175], v[92:95], a[44:47]
  buffer_load_dwordx4 v26, s[4:7], s51 offen  lds
  v_mfma_f32_16x16x32_bf16 a[60:63], a[172:175], v[88:91], a[60:63]
  v_mfma_f32_16x16x32_bf16 a[60:63], a[188:191], v[96:99], a[60:63]
  v_mfma_f32_16x16x32_bf16 a[56:59], a[184:187], v[96:99], a[56:59]
  v_mfma_f32_16x16x32_bf16 a[56:59], a[168:171], v[88:91], a[56:59]
  s_add_u32 m0, s32, 14144
  v_mfma_f32_16x16x32_bf16 a[52:55], a[164:167], v[88:91], a[52:55]
  buffer_load_dwordx4 v30, s[8:11], s50 offen  lds
  v_mfma_f32_16x16x32_bf16 a[52:55], a[180:183], v[96:99], a[52:55]
  v_mfma_f32_16x16x32_bf16 a[48:51], a[176:179], v[96:99], a[48:51]
  v_mfma_f32_16x16x32_bf16 a[48:51], a[160:163], v[88:91], a[48:51]
  v_mfma_f32_16x16x32_bf16 a[64:67], a[160:163], v[96:99], a[64:67]
  v_mfma_f32_16x16x32_bf16 a[64:67], a[176:179], v[104:107], a[64:67]
  ds_read_b64_tr_b16 a[144:145], v10 offset:21760
  v_mfma_f32_16x16x32_bf16 a[68:71], a[180:183], v[104:107], a[68:71]
  ds_read_b64_tr_b16 a[146:147], v10 offset:22272
  v_mfma_f32_16x16x32_bf16 a[68:71], a[164:167], v[96:99], a[68:71]
  ds_read_b64_tr_b16 a[148:149], v11 offset:21792
  s_add_u32 m0, s29, 66528
  v_mfma_f32_16x16x32_bf16 a[72:75], a[168:171], v[96:99], a[72:75]
  ds_read_b64_tr_b16 a[150:151], v11 offset:22304
  s_add_u32 s51, s38, 393216
  v_mfma_f32_16x16x32_bf16 a[72:75], a[184:187], v[104:107], a[72:75]
  ds_read_b64_tr_b16 a[152:153], v10 offset:21824
  buffer_load_dwordx4 v26, s[4:7], s51 offen  lds
  v_mfma_f32_16x16x32_bf16 a[76:79], a[188:191], v[104:107], a[76:79]
  ds_read_b64_tr_b16 a[154:155], v10 offset:22336
  v_mfma_f32_16x16x32_bf16 a[76:79], a[172:175], v[96:99], a[76:79]
  ds_read_b64_tr_b16 a[156:157], v11 offset:21856
  v_mfma_f32_16x16x32_bf16 a[92:95], a[172:175], v[104:107], a[92:95]
  ds_read_b64_tr_b16 a[158:159], v11 offset:22368
  v_mfma_f32_16x16x32_bf16 a[92:95], a[188:191], v[100:103], a[92:95]
  v_mfma_f32_16x16x32_bf16 a[88:91], a[184:187], v[100:103], a[88:91]
  v_mfma_f32_16x16x32_bf16 a[88:91], a[168:171], v[104:107], a[88:91]
  v_mfma_f32_16x16x32_bf16 a[84:87], a[164:167], v[104:107], a[84:87]
  v_mfma_f32_16x16x32_bf16 a[84:87], a[180:183], v[100:103], a[84:87]
  v_mfma_f32_16x16x32_bf16 a[80:83], a[176:179], v[100:103], a[80:83]
  v_mfma_f32_16x16x32_bf16 a[80:83], a[160:163], v[104:107], a[80:83]
  ds_read_b128 v[48:51], v28 offset:1568
  v_mfma_f32_16x16x32_bf16 a[96:99], a[160:163], v[100:103], a[96:99]
  v_mfma_f32_16x16x32_bf16 a[96:99], a[176:179], v[108:111], a[96:99]
  s_mov_b32 m0, s31
  v_mfma_f32_16x16x32_bf16 a[100:103], a[180:183], v[108:111], a[100:103]
  s_add_u32 s51, s38, 524288
  v_mfma_f32_16x16x32_bf16 a[100:103], a[164:167], v[100:103], a[100:103]
  buffer_load_dwordx4 v2, s[4:7], s51 offen  lds
  v_mfma_f32_16x16x32_bf16 a[104:107], a[168:171], v[100:103], a[104:107]
  v_mfma_f32_16x16x32_bf16 a[104:107], a[184:187], v[108:111], a[104:107]
  v_mfma_f32_16x16x32_bf16 a[108:111], a[188:191], v[108:111], a[108:111]
  v_mfma_f32_16x16x32_bf16 a[108:111], a[172:175], v[100:103], a[108:111]
  v_mfma_f32_16x16x32_bf16 a[124:127], a[172:175], v[108:111], a[124:127]
  s_waitcnt lgkmcnt(15)
  v_mfma_f32_16x16x32_bf16 a[124:127], a[188:191], v[112:115], a[124:127]
  v_mfma_f32_16x16x32_bf16 a[120:123], a[184:187], v[112:115], a[120:123]
  v_mfma_f32_16x16x32_bf16 a[120:123], a[168:171], v[108:111], a[120:123]
  v_mfma_f32_16x16x32_bf16 a[116:119], a[164:167], v[108:111], a[116:119]
  v_mfma_f32_16x16x32_bf16 a[116:119], a[180:183], v[112:115], a[116:119]
  v_mfma_f32_16x16x32_bf16 a[112:115], a[176:179], v[112:115], a[112:115]
  v_mfma_f32_16x16x32_bf16 a[112:115], a[160:163], v[108:111], a[112:115]
  v_mfma_f32_16x16x32_bf16 a[0:3], a[128:131], v[92:95], a[0:3]
  s_waitcnt vmcnt(18) lgkmcnt(1)
  s_barrier
  v_mfma_f32_16x16x32_bf16 a[0:3], a[144:147], v[88:91], a[0:3]
  ds_read_b64_tr_b16 a[160:161], v10 offset:26112
  s_add_u32 m0, s32, 17408
  v_mfma_f32_16x16x32_bf16 a[4:7], a[148:151], v[88:91], a[4:7]
  ds_read_b64_tr_b16 a[162:163], v10 offset:26624
  s_add_u32 s50, s46, 8388608
  v_mfma_f32_16x16x32_bf16 a[4:7], a[132:135], v[92:95], a[4:7]
  ds_read_b64_tr_b16 a[164:165], v11 offset:26144
  buffer_load_dwordx4 v29, s[8:11], s50 offen  lds
  v_mfma_f32_16x16x32_bf16 a[8:11], a[136:139], v[92:95], a[8:11]
  ds_read_b64_tr_b16 a[166:167], v11 offset:26656
  v_mfma_f32_16x16x32_bf16 a[8:11], a[152:155], v[88:91], a[8:11]
  ds_read_b64_tr_b16 a[168:169], v10 offset:26176
  v_mfma_f32_16x16x32_bf16 a[12:15], a[156:159], v[88:91], a[12:15]
  ds_read_b64_tr_b16 a[170:171], v10 offset:26688
  v_mfma_f32_16x16x32_bf16 a[12:15], a[140:143], v[92:95], a[12:15]
  ds_read_b64_tr_b16 a[172:173], v11 offset:26208
  s_add_u32 m0, s32, 18496
  v_mfma_f32_16x16x32_bf16 a[28:31], a[140:143], v[88:91], a[28:31]
  ds_read_b64_tr_b16 a[174:175], v11 offset:26720
  buffer_load_dwordx4 v30, s[8:11], s50 offen  lds
  v_mfma_f32_16x16x32_bf16 a[28:31], a[156:159], v[96:99], a[28:31]
  ds_read_b128 v[52:55], v28 offset:1696
  v_mfma_f32_16x16x32_bf16 a[24:27], a[152:155], v[96:99], a[24:27]
  v_mfma_f32_16x16x32_bf16 a[24:27], a[136:139], v[88:91], a[24:27]
  s_add_u32 m0, s32, 21760
  v_mfma_f32_16x16x32_bf16 a[20:23], a[132:135], v[88:91], a[20:23]
  s_add_u32 s50, s46, 10485760
  v_mfma_f32_16x16x32_bf16 a[20:23], a[148:151], v[96:99], a[20:23]
  buffer_load_dwordx4 v29, s[8:11], s50 offen  lds
  v_mfma_f32_16x16x32_bf16 a[16:19], a[144:147], v[96:99], a[16:19]
  v_mfma_f32_16x16x32_bf16 a[16:19], a[128:131], v[88:91], a[16:19]
  v_mfma_f32_16x16x32_bf16 a[32:35], a[128:131], v[96:99], a[32:35]
  v_mfma_f32_16x16x32_bf16 a[32:35], a[144:147], v[104:107], a[32:35]
  s_add_u32 m0, s32, 22848
  v_mfma_f32_16x16x32_bf16 a[36:39], a[148:151], v[104:107], a[36:39]
  buffer_load_dwordx4 v30, s[8:11], s50 offen  lds
  v_mfma_f32_16x16x32_bf16 a[36:39], a[132:135], v[96:99], a[36:39]
  v_mfma_f32_16x16x32_bf16 a[40:43], a[136:139], v[96:99], a[40:43]
  v_mfma_f32_16x16x32_bf16 a[40:43], a[152:155], v[104:107], a[40:43]
  v_mfma_f32_16x16x32_bf16 a[44:47], a[156:159], v[104:107], a[44:47]
  v_mfma_f32_16x16x32_bf16 a[44:47], a[140:143], v[96:99], a[44:47]
  v_mfma_f32_16x16x32_bf16 a[60:63], a[140:143], v[104:107], a[60:63]
  v_mfma_f32_16x16x32_bf16 a[60:63], a[156:159], v[100:103], a[60:63]
  v_mfma_f32_16x16x32_bf16 a[56:59], a[152:155], v[100:103], a[56:59]
  v_mfma_f32_16x16x32_bf16 a[56:59], a[136:139], v[104:107], a[56:59]
  v_mfma_f32_16x16x32_bf16 a[52:55], a[132:135], v[104:107], a[52:55]
  v_mfma_f32_16x16x32_bf16 a[52:55], a[148:151], v[100:103], a[52:55]
  v_mfma_f32_16x16x32_bf16 a[48:51], a[144:147], v[100:103], a[48:51]
  v_mfma_f32_16x16x32_bf16 a[48:51], a[128:131], v[104:107], a[48:51]
  v_mfma_f32_16x16x32_bf16 a[64:67], a[128:131], v[100:103], a[64:67]
  v_mfma_f32_16x16x32_bf16 a[64:67], a[144:147], v[108:111], a[64:67]
  ds_read_b64_tr_b16 a[176:177], v10 offset:30464
  v_mfma_f32_16x16x32_bf16 a[68:71], a[148:151], v[108:111], a[68:71]
  ds_read_b64_tr_b16 a[178:179], v10 offset:30976
  v_mfma_f32_16x16x32_bf16 a[68:71], a[132:135], v[100:103], a[68:71]
  ds_read_b64_tr_b16 a[180:181], v11 offset:30496
  ds_read_b128 v[56:59], v28 offset:1824
  v_mfma_f32_16x16x32_bf16 a[72:75], a[136:139], v[100:103], a[72:75]
  ds_read_b64_tr_b16 a[182:183], v11 offset:31008
  v_mfma_f32_16x16x32_bf16 a[72:75], a[152:155], v[108:111], a[72:75]
  ds_read_b64_tr_b16 a[184:185], v10 offset:30528
  v_mfma_f32_16x16x32_bf16 a[76:79], a[156:159], v[108:111], a[76:79]
  ds_read_b64_tr_b16 a[186:187], v10 offset:31040
  v_mfma_f32_16x16x32_bf16 a[76:79], a[140:143], v[100:103], a[76:79]
  ds_read_b64_tr_b16 a[188:189], v11 offset:30560
  v_mfma_f32_16x16x32_bf16 a[92:95], a[140:143], v[108:111], a[92:95]
  ds_read_b64_tr_b16 a[190:191], v11 offset:31072
  v_mfma_f32_16x16x32_bf16 a[92:95], a[156:159], v[112:115], a[92:95]
  v_mfma_f32_16x16x32_bf16 a[88:91], a[152:155], v[112:115], a[88:91]
  v_mfma_f32_16x16x32_bf16 a[88:91], a[136:139], v[108:111], a[88:91]
  v_mfma_f32_16x16x32_bf16 a[84:87], a[132:135], v[108:111], a[84:87]
  v_mfma_f32_16x16x32_bf16 a[84:87], a[148:151], v[112:115], a[84:87]
  v_mfma_f32_16x16x32_bf16 a[80:83], a[144:147], v[112:115], a[80:83]
  buffer_load_dword v255, v234, s[8:11], s47 offen offset:0
  v_mfma_f32_16x16x32_bf16 a[80:83], a[128:131], v[108:111], a[80:83]
  v_mfma_f32_16x16x32_bf16 a[96:99], a[128:131], v[112:115], a[96:99]
  v_mfma_f32_16x16x32_bf16 a[96:99], a[144:147], v[116:119], a[96:99]
  v_mfma_f32_16x16x32_bf16 a[100:103], a[148:151], v[116:119], a[100:103]
  v_mfma_f32_16x16x32_bf16 a[100:103], a[132:135], v[112:115], a[100:103]
  buffer_load_dword v255, v233, s[4:7], s40 offen offset:0
  v_mfma_f32_16x16x32_bf16 a[104:107], a[136:139], v[112:115], a[104:107]
  v_mfma_f32_16x16x32_bf16 a[104:107], a[152:155], v[116:119], a[104:107]
  v_mfma_f32_16x16x32_bf16 a[108:111], a[156:159], v[116:119], a[108:111]
  v_mfma_f32_16x16x32_bf16 a[108:111], a[140:143], v[112:115], a[108:111]
  v_mfma_f32_16x16x32_bf16 a[124:127], a[140:143], v[116:119], a[124:127]
  s_waitcnt lgkmcnt(15)
  v_mfma_f32_16x16x32_bf16 a[124:127], a[156:159], v[48:51], a[124:127]
  v_mfma_f32_16x16x32_bf16 a[120:123], a[152:155], v[48:51], a[120:123]
  v_mfma_f32_16x16x32_bf16 a[120:123], a[136:139], v[116:119], a[120:123]
  v_mfma_f32_16x16x32_bf16 a[116:119], a[132:135], v[116:119], a[116:119]
  v_mfma_f32_16x16x32_bf16 a[116:119], a[148:151], v[48:51], a[116:119]
  v_mfma_f32_16x16x32_bf16 a[112:115], a[144:147], v[48:51], a[112:115]
  v_mfma_f32_16x16x32_bf16 a[112:115], a[128:131], v[116:119], a[112:115]
  v_mfma_f32_16x16x32_bf16 a[0:3], a[160:163], v[96:99], a[0:3]
  s_waitcnt vmcnt(6) lgkmcnt(0)
  s_barrier
  v_mfma_f32_16x16x32_bf16 a[0:3], a[176:179], v[104:107], a[0:3]
  ds_read_b64_tr_b16 a[128:129], v10 offset:0
  s_add_u32 m0, s32, 26112
  v_mfma_f32_16x16x32_bf16 a[4:7], a[180:183], v[104:107], a[4:7]
  ds_read_b64_tr_b16 a[130:131], v10 offset:512
  s_add_u32 s50, s46, 12582912
  v_mfma_f32_16x16x32_bf16 a[4:7], a[164:167], v[96:99], a[4:7]
  ds_read_b64_tr_b16 a[132:133], v11 offset:32
  buffer_load_dwordx4 v29, s[8:11], s50 offen  lds
  v_mfma_f32_16x16x32_bf16 a[8:11], a[168:171], v[96:99], a[8:11]
  ds_read_b64_tr_b16 a[134:135], v11 offset:544
  v_mfma_f32_16x16x32_bf16 a[8:11], a[184:187], v[104:107], a[8:11]
  ds_read_b64_tr_b16 a[136:137], v10 offset:64
  v_mfma_f32_16x16x32_bf16 a[12:15], a[188:191], v[104:107], a[12:15]
  ds_read_b64_tr_b16 a[138:139], v10 offset:576
  v_mfma_f32_16x16x32_bf16 a[12:15], a[172:175], v[96:99], a[12:15]
  ds_read_b64_tr_b16 a[140:141], v11 offset:96
  s_add_u32 m0, s32, 27200
  v_mfma_f32_16x16x32_bf16 a[28:31], a[172:175], v[104:107], a[28:31]
  ds_read_b64_tr_b16 a[142:143], v11 offset:608
  buffer_load_dwordx4 v30, s[8:11], s50 offen  lds
  v_mfma_f32_16x16x32_bf16 a[28:31], a[188:191], v[100:103], a[28:31]
  v_mfma_f32_16x16x32_bf16 a[24:27], a[184:187], v[100:103], a[24:27]
  ds_read_b128 v[60:63], v28 offset:35904
  v_mfma_f32_16x16x32_bf16 a[24:27], a[168:171], v[104:107], a[24:27]
  s_add_u32 m0, s32, 30464
  v_mfma_f32_16x16x32_bf16 a[20:23], a[164:167], v[104:107], a[20:23]
  s_add_u32 s50, s46, 14680064
  v_mfma_f32_16x16x32_bf16 a[20:23], a[180:183], v[100:103], a[20:23]
  buffer_load_dwordx4 v29, s[8:11], s50 offen  lds
  v_mfma_f32_16x16x32_bf16 a[16:19], a[176:179], v[100:103], a[16:19]
  v_mfma_f32_16x16x32_bf16 a[16:19], a[160:163], v[104:107], a[16:19]
  ds_read_b128 v[68:71], v28 offset:36032
  v_mfma_f32_16x16x32_bf16 a[32:35], a[160:163], v[100:103], a[32:35]
  v_mfma_f32_16x16x32_bf16 a[32:35], a[176:179], v[108:111], a[32:35]
  s_add_u32 m0, s32, 31552
  v_mfma_f32_16x16x32_bf16 a[36:39], a[180:183], v[108:111], a[36:39]
  buffer_load_dwordx4 v30, s[8:11], s50 offen  lds
  v_mfma_f32_16x16x32_bf16 a[36:39], a[164:167], v[100:103], a[36:39]
  v_mfma_f32_16x16x32_bf16 a[40:43], a[168:171], v[100:103], a[40:43]
  v_mfma_f32_16x16x32_bf16 a[40:43], a[184:187], v[108:111], a[40:43]
  ds_read_b128 v[64:67], v28 offset:36160
  v_mfma_f32_16x16x32_bf16 a[44:47], a[188:191], v[108:111], a[44:47]
  v_mfma_f32_16x16x32_bf16 a[44:47], a[172:175], v[100:103], a[44:47]
  v_mfma_f32_16x16x32_bf16 a[60:63], a[172:175], v[108:111], a[60:63]
  v_mfma_f32_16x16x32_bf16 a[60:63], a[188:191], v[112:115], a[60:63]
  v_mfma_f32_16x16x32_bf16 a[56:59], a[184:187], v[112:115], a[56:59]
  v_mfma_f32_16x16x32_bf16 a[56:59], a[168:171], v[108:111], a[56:59]
  ds_read_b128 v[72:75], v28 offset:36288
  v_mfma_f32_16x16x32_bf16 a[52:55], a[164:167], v[108:111], a[52:55]
  v_mfma_f32_16x16x32_bf16 a[52:55], a[180:183], v[112:115], a[52:55]
  v_mfma_f32_16x16x32_bf16 a[48:51], a[176:179], v[112:115], a[48:51]
  v_mfma_f32_16x16x32_bf16 a[48:51], a[160:163], v[108:111], a[48:51]
  v_mfma_f32_16x16x32_bf16 a[64:67], a[160:163], v[112:115], a[64:67]
  v_mfma_f32_16x16x32_bf16 a[64:67], a[176:179], v[116:119], a[64:67]
  ds_read_b64_tr_b16 a[144:145], v10 offset:4352
  ds_read_b128 v[80:83], v28 offset:36416
  v_mfma_f32_16x16x32_bf16 a[68:71], a[180:183], v[116:119], a[68:71]
  ds_read_b64_tr_b16 a[146:147], v10 offset:4864
  v_mfma_f32_16x16x32_bf16 a[68:71], a[164:167], v[112:115], a[68:71]
  ds_read_b64_tr_b16 a[148:149], v11 offset:4384
  v_mfma_f32_16x16x32_bf16 a[72:75], a[168:171], v[112:115], a[72:75]
  ds_read_b64_tr_b16 a[150:151], v11 offset:4896
  v_mfma_f32_16x16x32_bf16 a[72:75], a[184:187], v[116:119], a[72:75]
  ds_read_b64_tr_b16 a[152:153], v10 offset:4416
  v_mfma_f32_16x16x32_bf16 a[76:79], a[188:191], v[116:119], a[76:79]
  ds_read_b64_tr_b16 a[154:155], v10 offset:4928
  ds_read_b128 v[76:79], v28 offset:36544
  v_mfma_f32_16x16x32_bf16 a[76:79], a[172:175], v[112:115], a[76:79]
  ds_read_b64_tr_b16 a[156:157], v11 offset:4448
  v_mfma_f32_16x16x32_bf16 a[92:95], a[172:175], v[116:119], a[92:95]
  ds_read_b64_tr_b16 a[158:159], v11 offset:4960
  v_mfma_f32_16x16x32_bf16 a[92:95], a[188:191], v[48:51], a[92:95]
  v_mfma_f32_16x16x32_bf16 a[88:91], a[184:187], v[48:51], a[88:91]
  v_mfma_f32_16x16x32_bf16 a[88:91], a[168:171], v[116:119], a[88:91]
  v_mfma_f32_16x16x32_bf16 a[84:87], a[164:167], v[116:119], a[84:87]
  ds_read_b128 v[84:87], v28 offset:36672
  v_mfma_f32_16x16x32_bf16 a[84:87], a[180:183], v[48:51], a[84:87]
  v_mfma_f32_16x16x32_bf16 a[80:83], a[176:179], v[48:51], a[80:83]
  v_mfma_f32_16x16x32_bf16 a[80:83], a[160:163], v[116:119], a[80:83]
  v_mfma_f32_16x16x32_bf16 a[96:99], a[160:163], v[48:51], a[96:99]
  v_mfma_f32_16x16x32_bf16 a[96:99], a[176:179], v[52:55], a[96:99]
  v_mfma_f32_16x16x32_bf16 a[100:103], a[180:183], v[52:55], a[100:103]
  ds_read_b128 v[92:95], v28 offset:36800
  v_mfma_f32_16x16x32_bf16 a[100:103], a[164:167], v[48:51], a[100:103]
  v_mfma_f32_16x16x32_bf16 a[104:107], a[168:171], v[48:51], a[104:107]
  v_mfma_f32_16x16x32_bf16 a[104:107], a[184:187], v[52:55], a[104:107]
  v_mfma_f32_16x16x32_bf16 a[108:111], a[188:191], v[52:55], a[108:111]
  v_mfma_f32_16x16x32_bf16 a[108:111], a[172:175], v[48:51], a[108:111]
  v_mfma_f32_16x16x32_bf16 a[124:127], a[172:175], v[52:55], a[124:127]
  v_mfma_f32_16x16x32_bf16 a[124:127], a[188:191], v[56:59], a[124:127]
  v_mfma_f32_16x16x32_bf16 a[120:123], a[184:187], v[56:59], a[120:123]
  v_mfma_f32_16x16x32_bf16 a[120:123], a[168:171], v[52:55], a[120:123]
  v_mfma_f32_16x16x32_bf16 a[116:119], a[164:167], v[52:55], a[116:119]
  v_mfma_f32_16x16x32_bf16 a[116:119], a[180:183], v[56:59], a[116:119]
  v_mfma_f32_16x16x32_bf16 a[112:115], a[176:179], v[56:59], a[112:115]
  v_mfma_f32_16x16x32_bf16 a[112:115], a[160:163], v[52:55], a[112:115]
  s_waitcnt lgkmcnt(15)
  v_mfma_f32_16x16x32_bf16 a[0:3], a[128:131], v[60:63], a[0:3]
  s_waitcnt lgkmcnt(2)
  s_barrier
  v_mfma_f32_16x16x32_bf16 a[0:3], a[144:147], v[68:71], a[0:3]
  ds_read_b64_tr_b16 a[160:161], v10 offset:8704
  s_add_u32 m0, s25, 0
  v_mfma_f32_16x16x32_bf16 a[4:7], a[148:151], v[68:71], a[4:7]
  ds_read_b64_tr_b16 a[162:163], v10 offset:9216
  buffer_load_dwordx4 v5, s[8:11], s55 offen  lds
  v_mfma_f32_16x16x32_bf16 a[4:7], a[132:135], v[60:63], a[4:7]
  ds_read_b64_tr_b16 a[164:165], v11 offset:8736
  v_mfma_f32_16x16x32_bf16 a[8:11], a[136:139], v[60:63], a[8:11]
  ds_read_b64_tr_b16 a[166:167], v11 offset:9248
  v_mfma_f32_16x16x32_bf16 a[8:11], a[152:155], v[68:71], a[8:11]
  ds_read_b64_tr_b16 a[168:169], v10 offset:8768
  s_add_u32 m0, s29, 0
  v_mfma_f32_16x16x32_bf16 a[12:15], a[156:159], v[68:71], a[12:15]
  ds_read_b64_tr_b16 a[170:171], v10 offset:9280
  s_add_u32 s51, s39, 0
  v_mfma_f32_16x16x32_bf16 a[12:15], a[140:143], v[60:63], a[12:15]
  ds_read_b64_tr_b16 a[172:173], v11 offset:8800
  buffer_load_dwordx4 v1, s[4:7], s51 offen  lds
  v_mfma_f32_16x16x32_bf16 a[28:31], a[140:143], v[68:71], a[28:31]
  ds_read_b64_tr_b16 a[174:175], v11 offset:9312
  v_mfma_f32_16x16x32_bf16 a[28:31], a[156:159], v[64:67], a[28:31]
  ds_read_b128 v[88:91], v28 offset:36960
  v_mfma_f32_16x16x32_bf16 a[24:27], a[152:155], v[64:67], a[24:27]
  v_mfma_f32_16x16x32_bf16 a[24:27], a[136:139], v[68:71], a[24:27]
  s_add_u32 m0, s25, 1088
  v_mfma_f32_16x16x32_bf16 a[20:23], a[132:135], v[68:71], a[20:23]
  buffer_load_dwordx4 v6, s[8:11], s55 offen  lds
  v_mfma_f32_16x16x32_bf16 a[20:23], a[148:151], v[64:67], a[20:23]
  v_mfma_f32_16x16x32_bf16 a[16:19], a[144:147], v[64:67], a[16:19]
  v_mfma_f32_16x16x32_bf16 a[16:19], a[128:131], v[68:71], a[16:19]
  s_add_u32 m0, s29, 4224
  v_mfma_f32_16x16x32_bf16 a[32:35], a[128:131], v[64:67], a[32:35]
  s_add_u32 s51, s39, 131072
  v_mfma_f32_16x16x32_bf16 a[32:35], a[144:147], v[72:75], a[32:35]
  buffer_load_dwordx4 v1, s[4:7], s51 offen  lds
  v_mfma_f32_16x16x32_bf16 a[36:39], a[148:151], v[72:75], a[36:39]
  v_mfma_f32_16x16x32_bf16 a[36:39], a[132:135], v[64:67], a[36:39]
  v_mfma_f32_16x16x32_bf16 a[40:43], a[136:139], v[64:67], a[40:43]
  v_mfma_f32_16x16x32_bf16 a[40:43], a[152:155], v[72:75], a[40:43]
  s_add_u32 m0, s25, 2176
  v_mfma_f32_16x16x32_bf16 a[44:47], a[156:159], v[72:75], a[44:47]
  buffer_load_dwordx4 v7, s[8:11], s55 offen  lds
  v_mfma_f32_16x16x32_bf16 a[44:47], a[140:143], v[64:67], a[44:47]
  v_mfma_f32_16x16x32_bf16 a[60:63], a[140:143], v[72:75], a[60:63]
  v_mfma_f32_16x16x32_bf16 a[60:63], a[156:159], v[80:83], a[60:63]
  v_mfma_f32_16x16x32_bf16 a[56:59], a[152:155], v[80:83], a[56:59]
  s_add_u32 m0, s25, 3264
  v_mfma_f32_16x16x32_bf16 a[56:59], a[136:139], v[72:75], a[56:59]
  buffer_load_dwordx4 v8, s[8:11], s55 offen  lds
  v_mfma_f32_16x16x32_bf16 a[52:55], a[132:135], v[72:75], a[52:55]
  v_mfma_f32_16x16x32_bf16 a[52:55], a[148:151], v[80:83], a[52:55]
  v_mfma_f32_16x16x32_bf16 a[48:51], a[144:147], v[80:83], a[48:51]
  s_add_u32 m0, s29, 8448
  v_mfma_f32_16x16x32_bf16 a[48:51], a[128:131], v[72:75], a[48:51]
  s_add_u32 s51, s39, 262144
  v_mfma_f32_16x16x32_bf16 a[64:67], a[128:131], v[80:83], a[64:67]
  buffer_load_dwordx4 v1, s[4:7], s51 offen  lds
  v_mfma_f32_16x16x32_bf16 a[64:67], a[144:147], v[76:79], a[64:67]
  ds_read_b64_tr_b16 a[176:177], v10 offset:13056
  v_mfma_f32_16x16x32_bf16 a[68:71], a[148:151], v[76:79], a[68:71]
  ds_read_b64_tr_b16 a[178:179], v10 offset:13568
  ds_read_b128 v[96:99], v28 offset:37088
  v_mfma_f32_16x16x32_bf16 a[68:71], a[132:135], v[80:83], a[68:71]
  ds_read_b64_tr_b16 a[180:181], v11 offset:13088
  s_add_u32 m0, s32, 0
  v_mfma_f32_16x16x32_bf16 a[72:75], a[136:139], v[80:83], a[72:75]
  ds_read_b64_tr_b16 a[182:183], v11 offset:13600
  s_add_u32 s50, s47, 0
  v_mfma_f32_16x16x32_bf16 a[72:75], a[152:155], v[76:79], a[72:75]
  ds_read_b64_tr_b16 a[184:185], v10 offset:13120
  buffer_load_dwordx4 v29, s[8:11], s50 offen  lds
  v_mfma_f32_16x16x32_bf16 a[76:79], a[156:159], v[76:79], a[76:79]
  ds_read_b64_tr_b16 a[186:187], v10 offset:13632
  v_mfma_f32_16x16x32_bf16 a[76:79], a[140:143], v[80:83], a[76:79]
  ds_read_b64_tr_b16 a[188:189], v11 offset:13152
  v_mfma_f32_16x16x32_bf16 a[92:95], a[140:143], v[76:79], a[92:95]
  ds_read_b64_tr_b16 a[190:191], v11 offset:13664
  s_waitcnt lgkmcnt(15)
  v_mfma_f32_16x16x32_bf16 a[92:95], a[156:159], v[84:87], a[92:95]
  s_add_u32 m0, s32, 1088
  v_mfma_f32_16x16x32_bf16 a[88:91], a[152:155], v[84:87], a[88:91]
  buffer_load_dwordx4 v30, s[8:11], s50 offen  lds
  v_mfma_f32_16x16x32_bf16 a[88:91], a[136:139], v[76:79], a[88:91]
  v_mfma_f32_16x16x32_bf16 a[84:87], a[132:135], v[76:79], a[84:87]
  v_mfma_f32_16x16x32_bf16 a[84:87], a[148:151], v[84:87], a[84:87]
  s_add_u32 m0, s29, 12672
  v_mfma_f32_16x16x32_bf16 a[80:83], a[144:147], v[84:87], a[80:83]
  s_add_u32 s51, s39, 393216
  v_mfma_f32_16x16x32_bf16 a[80:83], a[128:131], v[76:79], a[80:83]
  buffer_load_dwordx4 v1, s[4:7], s51 offen  lds
  v_mfma_f32_16x16x32_bf16 a[96:99], a[128:131], v[84:87], a[96:99]
  v_mfma_f32_16x16x32_bf16 a[96:99], a[144:147], v[92:95], a[96:99]
  v_mfma_f32_16x16x32_bf16 a[100:103], a[148:151], v[92:95], a[100:103]
  s_add_u32 m0, s32, 4352
  v_mfma_f32_16x16x32_bf16 a[100:103], a[132:135], v[84:87], a[100:103]
  s_add_u32 s50, s47, 2097152
  v_mfma_f32_16x16x32_bf16 a[104:107], a[136:139], v[84:87], a[104:107]
  buffer_load_dwordx4 v29, s[8:11], s50 offen  lds
  v_mfma_f32_16x16x32_bf16 a[104:107], a[152:155], v[92:95], a[104:107]
  v_mfma_f32_16x16x32_bf16 a[108:111], a[156:159], v[92:95], a[108:111]
  v_mfma_f32_16x16x32_bf16 a[108:111], a[140:143], v[84:87], a[108:111]
  v_mfma_f32_16x16x32_bf16 a[124:127], a[140:143], v[92:95], a[124:127]
  s_add_u32 m0, s32, 5440
  s_waitcnt lgkmcnt(9)
  v_mfma_f32_16x16x32_bf16 a[124:127], a[156:159], v[88:91], a[124:127]
  buffer_load_dwordx4 v30, s[8:11], s50 offen  lds
  v_mfma_f32_16x16x32_bf16 a[120:123], a[152:155], v[88:91], a[120:123]
  v_mfma_f32_16x16x32_bf16 a[120:123], a[136:139], v[92:95], a[120:123]
  v_mfma_f32_16x16x32_bf16 a[116:119], a[132:135], v[92:95], a[116:119]
  ds_read_b128 v[104:107], v28 offset:37216
  s_add_u32 m0, s29, 17952
  v_mfma_f32_16x16x32_bf16 a[116:119], a[148:151], v[88:91], a[116:119]
  s_add_u32 s51, s39, 0
  v_mfma_f32_16x16x32_bf16 a[112:115], a[144:147], v[88:91], a[112:115]
  buffer_load_dwordx4 v26, s[4:7], s51 offen  lds
  v_mfma_f32_16x16x32_bf16 a[112:115], a[128:131], v[92:95], a[112:115]
  v_mfma_f32_16x16x32_bf16 a[0:3], a[160:163], v[64:67], a[0:3]
  s_waitcnt vmcnt(19) lgkmcnt(1)
  s_barrier
  v_mfma_f32_16x16x32_bf16 a[0:3], a[176:179], v[72:75], a[0:3]
  ds_read_b64_tr_b16 a[128:129], v10 offset:17408
  s_add_u32 m0, s32, 8704
  v_mfma_f32_16x16x32_bf16 a[4:7], a[180:183], v[72:75], a[4:7]
  ds_read_b64_tr_b16 a[130:131], v10 offset:17920
  s_add_u32 s50, s47, 4194304
  v_mfma_f32_16x16x32_bf16 a[4:7], a[164:167], v[64:67], a[4:7]
  ds_read_b64_tr_b16 a[132:133], v11 offset:17440
  buffer_load_dwordx4 v29, s[8:11], s50 offen  lds
  v_mfma_f32_16x16x32_bf16 a[8:11], a[168:171], v[64:67], a[8:11]
  ds_read_b64_tr_b16 a[134:135], v11 offset:17952
  v_mfma_f32_16x16x32_bf16 a[8:11], a[184:187], v[72:75], a[8:11]
  ds_read_b64_tr_b16 a[136:137], v10 offset:17472
  v_mfma_f32_16x16x32_bf16 a[12:15], a[188:191], v[72:75], a[12:15]
  ds_read_b64_tr_b16 a[138:139], v10 offset:17984
  v_mfma_f32_16x16x32_bf16 a[12:15], a[172:175], v[64:67], a[12:15]
  ds_read_b64_tr_b16 a[140:141], v11 offset:17504
  s_add_u32 m0, s32, 9792
  v_mfma_f32_16x16x32_bf16 a[28:31], a[172:175], v[72:75], a[28:31]
  ds_read_b64_tr_b16 a[142:143], v11 offset:18016
  buffer_load_dwordx4 v30, s[8:11], s50 offen  lds
  v_mfma_f32_16x16x32_bf16 a[28:31], a[188:191], v[80:83], a[28:31]
  v_mfma_f32_16x16x32_bf16 a[24:27], a[184:187], v[80:83], a[24:27]
  v_mfma_f32_16x16x32_bf16 a[24:27], a[168:171], v[72:75], a[24:27]
  s_add_u32 m0, s29, 22176
  v_mfma_f32_16x16x32_bf16 a[20:23], a[164:167], v[72:75], a[20:23]
  s_add_u32 s51, s39, 131072
  v_mfma_f32_16x16x32_bf16 a[20:23], a[180:183], v[80:83], a[20:23]
  buffer_load_dwordx4 v26, s[4:7], s51 offen  lds
  v_mfma_f32_16x16x32_bf16 a[16:19], a[176:179], v[80:83], a[16:19]
  v_mfma_f32_16x16x32_bf16 a[16:19], a[160:163], v[72:75], a[16:19]
  v_mfma_f32_16x16x32_bf16 a[32:35], a[160:163], v[80:83], a[32:35]
  s_add_u32 m0, s32, 13056
  v_mfma_f32_16x16x32_bf16 a[32:35], a[176:179], v[76:79], a[32:35]
  s_add_u32 s50, s47, 6291456
  v_mfma_f32_16x16x32_bf16 a[36:39], a[180:183], v[76:79], a[36:39]
  buffer_load_dwordx4 v29, s[8:11], s50 offen  lds
  v_mfma_f32_16x16x32_bf16 a[36:39], a[164:167], v[80:83], a[36:39]
  v_mfma_f32_16x16x32_bf16 a[40:43], a[168:171], v[80:83], a[40:43]
  v_mfma_f32_16x16x32_bf16 a[40:43], a[184:187], v[76:79], a[40:43]
  v_mfma_f32_16x16x32_bf16 a[44:47], a[188:191], v[76:79], a[44:47]
  ds_read_b128 v[100:103], v28 offset:37344
  v_mfma_f32_16x16x32_bf16 a[44:47], a[172:175], v[80:83], a[44:47]
  buffer_load_dwordx2 v[250:251], v20, s[12:15], 0 offen offset:0 sc1
  v_mfma_f32_16x16x32_bf16 a[60:63], a[172:175], v[76:79], a[60:63]
  v_mfma_f32_16x16x32_bf16 a[60:63], a[188:191], v[84:87], a[60:63]
  v_mfma_f32_16x16x32_bf16 a[56:59], a[184:187], v[84:87], a[56:59]
  s_add_u32 m0, s29, 26400
  v_mfma_f32_16x16x32_bf16 a[56:59], a[168:171], v[76:79], a[56:59]
  s_add_u32 s51, s39, 262144
  v_mfma_f32_16x16x32_bf16 a[52:55], a[164:167], v[76:79], a[52:55]
  buffer_load_dwordx4 v26, s[4:7], s51 offen  lds
  v_mfma_f32_16x16x32_bf16 a[52:55], a[180:183], v[84:87], a[52:55]
  v_mfma_f32_16x16x32_bf16 a[48:51], a[176:179], v[84:87], a[48:51]
  v_mfma_f32_16x16x32_bf16 a[48:51], a[160:163], v[76:79], a[48:51]
  v_mfma_f32_16x16x32_bf16 a[64:67], a[160:163], v[84:87], a[64:67]
  s_add_u32 m0, s32, 14144
  v_mfma_f32_16x16x32_bf16 a[64:67], a[176:179], v[92:95], a[64:67]
  ds_read_b64_tr_b16 a[144:145], v10 offset:21760
  buffer_load_dwordx4 v30, s[8:11], s50 offen  lds
  v_mfma_f32_16x16x32_bf16 a[68:71], a[180:183], v[92:95], a[68:71]
  ds_read_b64_tr_b16 a[146:147], v10 offset:22272
  v_mfma_f32_16x16x32_bf16 a[68:71], a[164:167], v[84:87], a[68:71]
  ds_read_b64_tr_b16 a[148:149], v11 offset:21792
  v_mfma_f32_16x16x32_bf16 a[72:75], a[168:171], v[84:87], a[72:75]
  ds_read_b64_tr_b16 a[150:151], v11 offset:22304
  s_add_u32 m0, s29, 30624
  v_mfma_f32_16x16x32_bf16 a[72:75], a[184:187], v[92:95], a[72:75]
  ds_read_b64_tr_b16 a[152:153], v10 offset:21824
  s_add_u32 s51, s39, 393216
  v_mfma_f32_16x16x32_bf16 a[76:79], a[188:191], v[92:95], a[76:79]
  ds_read_b64_tr_b16 a[154:155], v10 offset:22336
  buffer_load_dwordx4 v26, s[4:7], s51 offen  lds
  v_mfma_f32_16x16x32_bf16 a[76:79], a[172:175], v[84:87], a[76:79]
  ds_read_b64_tr_b16 a[156:157], v11 offset:21856
  v_mfma_f32_16x16x32_bf16 a[92:95], a[172:175], v[92:95], a[92:95]
  ds_read_b64_tr_b16 a[158:159], v11 offset:22368
  v_mfma_f32_16x16x32_bf16 a[92:95], a[188:191], v[88:91], a[92:95]
  v_mfma_f32_16x16x32_bf16 a[88:91], a[184:187], v[88:91], a[88:91]
  v_mfma_f32_16x16x32_bf16 a[88:91], a[168:171], v[92:95], a[88:91]
  v_mfma_f32_16x16x32_bf16 a[84:87], a[164:167], v[92:95], a[84:87]
  v_mfma_f32_16x16x32_bf16 a[84:87], a[180:183], v[88:91], a[84:87]
  v_mfma_f32_16x16x32_bf16 a[80:83], a[176:179], v[88:91], a[80:83]
  v_mfma_f32_16x16x32_bf16 a[80:83], a[160:163], v[92:95], a[80:83]
  ds_read_b128 v[108:111], v28 offset:37472
  v_mfma_f32_16x16x32_bf16 a[96:99], a[160:163], v[88:91], a[96:99]
  v_mfma_f32_16x16x32_bf16 a[96:99], a[176:179], v[96:99], a[96:99]
  s_mov_b32 m0, s30
  v_mfma_f32_16x16x32_bf16 a[100:103], a[180:183], v[96:99], a[100:103]
  s_add_u32 s51, s39, 524288
  v_mfma_f32_16x16x32_bf16 a[100:103], a[164:167], v[88:91], a[100:103]
  buffer_load_dwordx4 v2, s[4:7], s51 offen  lds
  v_mfma_f32_16x16x32_bf16 a[104:107], a[168:171], v[88:91], a[104:107]
  v_mfma_f32_16x16x32_bf16 a[104:107], a[184:187], v[96:99], a[104:107]
  v_mfma_f32_16x16x32_bf16 a[108:111], a[188:191], v[96:99], a[108:111]
  v_mfma_f32_16x16x32_bf16 a[108:111], a[172:175], v[88:91], a[108:111]
  v_mfma_f32_16x16x32_bf16 a[124:127], a[172:175], v[96:99], a[124:127]
  s_waitcnt lgkmcnt(15)
  v_mfma_f32_16x16x32_bf16 a[124:127], a[188:191], v[104:107], a[124:127]
  v_mfma_f32_16x16x32_bf16 a[120:123], a[184:187], v[104:107], a[120:123]
  v_mfma_f32_16x16x32_bf16 a[120:123], a[168:171], v[96:99], a[120:123]
  v_mfma_f32_16x16x32_bf16 a[116:119], a[164:167], v[96:99], a[116:119]
  v_mfma_f32_16x16x32_bf16 a[116:119], a[180:183], v[104:107], a[116:119]
  v_mfma_f32_16x16x32_bf16 a[112:115], a[176:179], v[104:107], a[112:115]
  v_mfma_f32_16x16x32_bf16 a[112:115], a[160:163], v[96:99], a[112:115]
  v_mfma_f32_16x16x32_bf16 a[0:3], a[128:131], v[80:83], a[0:3]
  s_waitcnt vmcnt(22) lgkmcnt(1)
  s_barrier
  v_mfma_f32_16x16x32_bf16 a[0:3], a[144:147], v[76:79], a[0:3]
  ds_read_b64_tr_b16 a[160:161], v10 offset:26112
  s_add_u32 m0, s32, 17408
  v_mfma_f32_16x16x32_bf16 a[4:7], a[148:151], v[76:79], a[4:7]
  ds_read_b64_tr_b16 a[162:163], v10 offset:26624
  s_add_u32 s50, s47, 8388608
  v_mfma_f32_16x16x32_bf16 a[4:7], a[132:135], v[80:83], a[4:7]
  ds_read_b64_tr_b16 a[164:165], v11 offset:26144
  buffer_load_dwordx4 v29, s[8:11], s50 offen  lds
  v_mfma_f32_16x16x32_bf16 a[8:11], a[136:139], v[80:83], a[8:11]
  ds_read_b64_tr_b16 a[166:167], v11 offset:26656
  v_mfma_f32_16x16x32_bf16 a[8:11], a[152:155], v[76:79], a[8:11]
  ds_read_b64_tr_b16 a[168:169], v10 offset:26176
  v_mfma_f32_16x16x32_bf16 a[12:15], a[156:159], v[76:79], a[12:15]
  ds_read_b64_tr_b16 a[170:171], v10 offset:26688
  v_mfma_f32_16x16x32_bf16 a[12:15], a[140:143], v[80:83], a[12:15]
  ds_read_b64_tr_b16 a[172:173], v11 offset:26208
  s_add_u32 m0, s32, 18496
  v_mfma_f32_16x16x32_bf16 a[28:31], a[140:143], v[76:79], a[28:31]
  ds_read_b64_tr_b16 a[174:175], v11 offset:26720
  buffer_load_dwordx4 v30, s[8:11], s50 offen  lds
  v_mfma_f32_16x16x32_bf16 a[28:31], a[156:159], v[84:87], a[28:31]
  ds_read_b128 v[112:115], v28 offset:37600
  v_mfma_f32_16x16x32_bf16 a[24:27], a[152:155], v[84:87], a[24:27]
  v_mfma_f32_16x16x32_bf16 a[24:27], a[136:139], v[76:79], a[24:27]
  s_add_u32 m0, s32, 21760
  v_mfma_f32_16x16x32_bf16 a[20:23], a[132:135], v[76:79], a[20:23]
  s_add_u32 s50, s47, 10485760
  v_mfma_f32_16x16x32_bf16 a[20:23], a[148:151], v[84:87], a[20:23]
  buffer_load_dwordx4 v29, s[8:11], s50 offen  lds
  v_mfma_f32_16x16x32_bf16 a[16:19], a[144:147], v[84:87], a[16:19]
  v_mfma_f32_16x16x32_bf16 a[16:19], a[128:131], v[76:79], a[16:19]
  v_mfma_f32_16x16x32_bf16 a[32:35], a[128:131], v[84:87], a[32:35]
  v_mfma_f32_16x16x32_bf16 a[32:35], a[144:147], v[92:95], a[32:35]
  s_add_u32 m0, s32, 22848
  v_mfma_f32_16x16x32_bf16 a[36:39], a[148:151], v[92:95], a[36:39]
  buffer_load_dwordx4 v30, s[8:11], s50 offen  lds
  v_mfma_f32_16x16x32_bf16 a[36:39], a[132:135], v[84:87], a[36:39]
  v_mfma_f32_16x16x32_bf16 a[40:43], a[136:139], v[84:87], a[40:43]
  v_mfma_f32_16x16x32_bf16 a[40:43], a[152:155], v[92:95], a[40:43]
  v_mfma_f32_16x16x32_bf16 a[44:47], a[156:159], v[92:95], a[44:47]
  v_mfma_f32_16x16x32_bf16 a[44:47], a[140:143], v[84:87], a[44:47]
  v_mfma_f32_16x16x32_bf16 a[60:63], a[140:143], v[92:95], a[60:63]
  v_mfma_f32_16x16x32_bf16 a[60:63], a[156:159], v[88:91], a[60:63]
  v_mfma_f32_16x16x32_bf16 a[56:59], a[152:155], v[88:91], a[56:59]
  v_mfma_f32_16x16x32_bf16 a[56:59], a[136:139], v[92:95], a[56:59]
  v_mfma_f32_16x16x32_bf16 a[52:55], a[132:135], v[92:95], a[52:55]
  v_mfma_f32_16x16x32_bf16 a[52:55], a[148:151], v[88:91], a[52:55]
  v_mfma_f32_16x16x32_bf16 a[48:51], a[144:147], v[88:91], a[48:51]
  v_mfma_f32_16x16x32_bf16 a[48:51], a[128:131], v[92:95], a[48:51]
  v_mfma_f32_16x16x32_bf16 a[64:67], a[128:131], v[88:91], a[64:67]
  v_mfma_f32_16x16x32_bf16 a[64:67], a[144:147], v[96:99], a[64:67]
  ds_read_b64_tr_b16 a[176:177], v10 offset:30464
  v_mfma_f32_16x16x32_bf16 a[68:71], a[148:151], v[96:99], a[68:71]
  ds_read_b64_tr_b16 a[178:179], v10 offset:30976
  v_mfma_f32_16x16x32_bf16 a[68:71], a[132:135], v[88:91], a[68:71]
  ds_read_b64_tr_b16 a[180:181], v11 offset:30496
  ds_read_b128 v[116:119], v28 offset:37728
  v_mfma_f32_16x16x32_bf16 a[72:75], a[136:139], v[88:91], a[72:75]
  ds_read_b64_tr_b16 a[182:183], v11 offset:31008
  v_mfma_f32_16x16x32_bf16 a[72:75], a[152:155], v[96:99], a[72:75]
  ds_read_b64_tr_b16 a[184:185], v10 offset:30528
  v_mfma_f32_16x16x32_bf16 a[76:79], a[156:159], v[96:99], a[76:79]
  ds_read_b64_tr_b16 a[186:187], v10 offset:31040
  v_mfma_f32_16x16x32_bf16 a[76:79], a[140:143], v[88:91], a[76:79]
  ds_read_b64_tr_b16 a[188:189], v11 offset:30560
  v_mfma_f32_16x16x32_bf16 a[92:95], a[140:143], v[96:99], a[92:95]
  ds_read_b64_tr_b16 a[190:191], v11 offset:31072
  v_mfma_f32_16x16x32_bf16 a[92:95], a[156:159], v[104:107], a[92:95]
  v_mfma_f32_16x16x32_bf16 a[88:91], a[152:155], v[104:107], a[88:91]
  v_mfma_f32_16x16x32_bf16 a[88:91], a[136:139], v[96:99], a[88:91]
  v_mfma_f32_16x16x32_bf16 a[84:87], a[132:135], v[96:99], a[84:87]
  v_mfma_f32_16x16x32_bf16 a[84:87], a[148:151], v[104:107], a[84:87]
  v_mfma_f32_16x16x32_bf16 a[80:83], a[144:147], v[104:107], a[80:83]
  s_waitcnt vmcnt(20)
  buffer_load_dword v255, v234, s[8:11], s48 offen offset:0
  v_mfma_f32_16x16x32_bf16 a[80:83], a[128:131], v[96:99], a[80:83]
  ds_read_b64_tr_b16 v[152:153], v12 offset:0
  v_mfma_f32_16x16x32_bf16 a[96:99], a[128:131], v[104:107], a[96:99]
  ds_read_b64_tr_b16 v[154:155], v12 offset:512
  v_mfma_f32_16x16x32_bf16 a[96:99], a[144:147], v[100:103], a[96:99]
  ds_read_b64_tr_b16 v[156:157], v12 offset:8
  v_mfma_f32_16x16x32_bf16 a[100:103], a[148:151], v[100:103], a[100:103]
  ds_read_b64_tr_b16 v[158:159], v12 offset:520
  v_mfma_f32_16x16x32_bf16 a[100:103], a[132:135], v[104:107], a[100:103]
  ds_read_b64_tr_b16 v[160:161], v12 offset:64
  v_mfma_f32_16x16x32_bf16 a[104:107], a[136:139], v[104:107], a[104:107]
  ds_read_b64_tr_b16 v[162:163], v12 offset:576
  v_mfma_f32_16x16x32_bf16 a[104:107], a[152:155], v[100:103], a[104:107]
  ds_read_b64_tr_b16 v[164:165], v12 offset:72
  v_mfma_f32_16x16x32_bf16 a[108:111], a[156:159], v[100:103], a[108:111]
  s_waitcnt vmcnt(9)
  ds_read_b64_tr_b16 v[166:167], v12 offset:584
  v_cmp_ne_u64 vcc, s[26:27], v[250:251]
  v_mfma_f32_16x16x32_bf16 a[108:111], a[140:143], v[104:107], a[108:111]
  v_mfma_f32_16x16x32_bf16 a[124:127], a[140:143], v[100:103], a[124:127]
  s_cbranch_vccnz L_slow_p1
L_back_p1:
  s_waitcnt lgkmcnt(15)
  v_mfma_f32_16x16x32_bf16 a[124:127], a[156:159], v[108:111], a[124:127]
  v_mfma_f32_16x16x32_bf16 a[120:123], a[152:155], v[108:111], a[120:123]
  s_mov_b32 s52, 0
  v_mfma_f32_16x16x32_bf16 a[120:123], a[136:139], v[100:103], a[120:123]
  buffer_load_dwordx4 v[120:123], v13, s[12:15], s52 offen offset:0 sc1
  v_mfma_f32_16x16x32_bf16 a[116:119], a[132:135], v[100:103], a[116:119]
  s_waitcnt lgkmcnt(0)
  v_mfma_f32_16x16x32_bf16 a[116:119], a[148:151], v[108:111], a[116:119]
  v_mfma_f32_16x16x32_bf16 a[112:115], a[144:147], v[108:111], a[112:115]
  v_mfma_f32_16x16x32_bf16 a[112:115], a[128:131], v[100:103], a[112:115]
  v_mfma_f32_16x16x32_bf16 a[0:3], a[160:163], v[84:87], a[0:3]
  s_waitcnt vmcnt(6)
  s_barrier
  v_mfma_f32_16x16x32_bf16 a[0:3], a[176:179], v[92:95], a[0:3]
  buffer_load_dwordx4 v[124:127], v13, s[12:15], s52 offen offset:1024 sc1
  ds_read_b64_tr_b16 a[128:129], v10 offset:0
  v_mfma_f32_16x16x32_bf16 a[4:7], a[180:183], v[92:95], a[4:7]
  ds_read_b64_tr_b16 a[130:131], v10 offset:512
  v_mfma_f32_16x16x32_bf16 a[4:7], a[164:167], v[84:87], a[4:7]
  ds_read_b64_tr_b16 a[132:133], v11 offset:32
  s_add_u32 m0, s29, 35904
  v_mfma_f32_16x16x32_bf16 a[8:11], a[168:171], v[84:87], a[8:11]
  ds_read_b64_tr_b16 a[134:135], v11 offset:544
  s_add_u32 s51, s40, 0
  v_mfma_f32_16x16x32_bf16 a[8:11], a[184:187], v[92:95], a[8:11]
  ds_read_b64_tr_b16 a[136:137], v10 offset:64
  buffer_load_dwordx4 v1, s[4:7], s51 offen  lds
  v_mfma_f32_16x16x32_bf16 a[12:15], a[188:191], v[92:95], a[12:15]
  ds_read_b64_tr_b16 a[138:139], v10 offset:576
  v_mfma_f32_16x16x32_bf16 a[12:15], a[172:175], v[84:87], a[12:15]
  ds_read_b64_tr_b16 a[140:141], v11 offset:96
  v_mfma_f32_16x16x32_bf16 a[28:31], a[172:175], v[92:95], a[28:31]
  ds_read_b64_tr_b16 a[142:143], v11 offset:608
  v_mfma_f32_16x16x32_bf16 a[28:31], a[188:191], v[88:91], a[28:31]
  s_add_u32 m0, s25, 0
  v_mfma_f32_16x16x32_bf16 a[24:27], a[184:187], v[88:91], a[24:27]
  ds_read_b128 v[48:51], v28 offset:0
  buffer_load_dwordx4 v5, s[8:11], s56 offen  lds
  v_mfma_f32_16x16x32_bf16 a[24:27], a[168:171], v[92:95], a[24:27]
  v_mfma_f32_16x16x32_bf16 a[20:23], a[164:167], v[92:95], a[20:23]
  v_mfma_f32_16x16x32_bf16 a[20:23], a[180:183], v[88:91], a[20:23]
  v_mfma_f32_16x16x32_bf16 a[16:19], a[176:179], v[88:91], a[16:19]
  s_add_u32 m0, s25, 1088
  v_mfma_f32_16x16x32_bf16 a[16:19], a[160:163], v[92:95], a[16:19]
  ds_read_b128 v[56:59], v28 offset:128
  buffer_load_dwordx4 v6, s[8:11], s56 offen  lds
  v_mfma_f32_16x16x32_bf16 a[32:35], a[160:163], v[88:91], a[32:35]
  v_mfma_f32_16x16x32_bf16 a[32:35], a[176:179], v[96:99], a[32:35]
  v_mfma_f32_16x16x32_bf16 a[36:39], a[180:183], v[96:99], a[36:39]
  s_add_u32 m0, s29, 40128
  v_mfma_f32_16x16x32_bf16 a[36:39], a[164:167], v[88:91], a[36:39]
  s_add_u32 s51, s40, 131072
  v_mfma_f32_16x16x32_bf16 a[40:43], a[168:171], v[88:91], a[40:43]
  buffer_load_dwordx4 v1, s[4:7], s51 offen  lds
  v_mfma_f32_16x16x32_bf16 a[40:43], a[184:187], v[96:99], a[40:43]
  ds_read_b128 v[52:55], v28 offset:256
  v_mfma_f32_16x16x32_bf16 a[44:47], a[188:191], v[96:99], a[44:47]
  v_mfma_f32_16x16x32_bf16 a[44:47], a[172:175], v[88:91], a[44:47]
  v_mfma_f32_16x16x32_bf16 a[60:63], a[172:175], v[96:99], a[60:63]
  s_add_u32 m0, s25, 2176
  v_mfma_f32_16x16x32_bf16 a[60:63], a[188:191], v[104:107], a[60:63]
  buffer_load_dwordx4 v7, s[8:11], s56 offen  lds
  v_mfma_f32_16x16x32_bf16 a[56:59], a[184:187], v[104:107], a[56:59]
  v_mfma_f32_16x16x32_bf16 a[56:59], a[168:171], v[96:99], a[56:59]
  ds_read_b128 v[60:63], v28 offset:384
  v_mfma_f32_16x16x32_bf16 a[52:55], a[164:167], v[96:99], a[52:55]
  v_mfma_f32_16x16x32_bf16 a[52:55], a[180:183], v[104:107], a[52:55]
  s_add_u32 m0, s25, 3264
  v_mfma_f32_16x16x32_bf16 a[48:51], a[176:179], v[104:107], a[48:51]
  buffer_load_dwordx4 v8, s[8:11], s56 offen  lds
  v_mfma_f32_16x16x32_bf16 a[48:51], a[160:163], v[96:99], a[48:51]
  v_mfma_f32_16x16x32_bf16 a[64:67], a[160:163], v[104:107], a[64:67]
  v_mfma_f32_16x16x32_bf16 a[64:67], a[176:179], v[100:103], a[64:67]
  s_add_u32 m0, s29, 44352
  ds_read_b64_tr_b16 a[144:145], v10 offset:4352
  ds_read_b128 v[68:71], v28 offset:512
  v_mfma_f32_16x16x32_bf16 a[68:71], a[180:183], v[100:103], a[68:71]
  ds_read_b64_tr_b16 a[146:147], v10 offset:4864
  s_add_u32 s51, s40, 262144
  v_mfma_f32_16x16x32_bf16 a[68:71], a[164:167], v[104:107], a[68:71]
  ds_read_b64_tr_b16 a[148:149], v11 offset:4384
  buffer_load_dwordx4 v1, s[4:7], s51 offen  lds
  v_mfma_f32_16x16x32_bf16 a[72:75], a[168:171], v[104:107], a[72:75]
  ds_read_b64_tr_b16 a[150:151], v11 offset:4896
  v_mfma_f32_16x16x32_bf16 a[72:75], a[184:187], v[100:103], a[72:75]
  ds_read_b64_tr_b16 a[152:153], v10 offset:4416
  v_mfma_f32_16x16x32_bf16 a[76:79], a[188:191], v[100:103], a[76:79]
  ds_read_b64_tr_b16 a[154:155], v10 offset:4928
  ds_read_b128 v[64:67], v28 offset:640
  v_mfma_f32_16x16x32_bf16 a[76:79], a[172:175], v[104:107], a[76:79]
  ds_read_b64_tr_b16 a[156:157], v11 offset:4448
  s_add_u32 s63, s24, 0
  v_mfma_f32_16x16x32_bf16 a[92:95], a[172:175], v[100:103], a[92:95]
  ds_read_b64_tr_b16 a[158:159], v11 offset:4960
  buffer_load_dwordx4 v[184:187], v15, s[4:7], s63 offen offset:0
  v_mfma_f32_16x16x32_bf16 a[92:95], a[188:191], v[108:111], a[92:95]
  v_mfma_f32_16x16x32_bf16 a[88:91], a[184:187], v[108:111], a[88:91]
  v_mfma_f32_16x16x32_bf16 a[88:91], a[168:171], v[100:103], a[88:91]
  s_add_u32 m0, s29, 48576
  v_mfma_f32_16x16x32_bf16 a[84:87], a[164:167], v[100:103], a[84:87]
  ds_read_b128 v[72:75], v28 offset:768
  s_add_u32 s51, s40, 393216
  v_mfma_f32_16x16x32_bf16 a[84:87], a[180:183], v[108:111], a[84:87]
  buffer_load_dwordx4 v1, s[4:7], s51 offen  lds
  v_mfma_f32_16x16x32_bf16 a[80:83], a[176:179], v[108:111], a[80:83]
  v_mfma_f32_16x16x32_bf16 a[80:83], a[160:163], v[100:103], a[80:83]
  v_mfma_f32_16x16x32_bf16 a[96:99], a[160:163], v[108:111], a[96:99]
  v_mfma_f32_16x16x32_bf16 a[96:99], a[176:179], v[112:115], a[96:99]
  v_mfma_f32_16x16x32_bf16 a[100:103], a[180:183], v[112:115], a[100:103]
  ds_read_b128 v[80:83], v28 offset:896
  buffer_load_dwordx4 v[188:191], v15, s[4:7], s63 offen offset:2048
  v_mfma_f32_16x16x32_bf16 a[100:103], a[164:167], v[108:111], a[100:103]
  v_mfma_f32_16x16x32_bf16 a[104:107], a[168:171], v[108:111], a[104:107]
  v_mfma_f32_16x16x32_bf16 a[104:107], a[184:187], v[112:115], a[104:107]
  v_mfma_f32_16x16x32_bf16 a[108:111], a[188:191], v[112:115], a[108:111]
  s_add_u32 s63, s24, 131072
  v_mfma_f32_16x16x32_bf16 a[108:111], a[172:175], v[108:111], a[108:111]
  buffer_load_dwordx4 v[192:195], v15, s[4:7], s63 offen offset:0
  v_mfma_f32_16x16x32_bf16 a[124:127], a[172:175], v[112:115], a[124:127]
  v_mfma_f32_16x16x32_bf16 a[124:127], a[188:191], v[116:119], a[124:127]
  v_mfma_f32_16x16x32_bf16 a[120:123], a[184:187], v[116:119], a[120:123]
  s_add_u32 m0, s29, 53856
  v_mfma_f32_16x16x32_bf16 a[120:123], a[168:171], v[112:115], a[120:123]
  s_add_u32 s51, s40, 0
  v_mfma_f32_16x16x32_bf16 a[116:119], a[164:167], v[112:115], a[116:119]
  buffer_load_dwordx4 v26, s[4:7], s51 offen  lds
  v_mfma_f32_16x16x32_bf16 a[116:119], a[180:183], v[116:119], a[116:119]
  v_mfma_f32_16x16x32_bf16 a[112:115], a[176:179], v[116:119], a[112:115]
  v_mfma_f32_16x16x32_bf16 a[112:115], a[160:163], v[112:115], a[112:115]
  s_waitcnt lgkmcnt(15)
  v_mfma_f32_16x16x32_bf16 a[0:3], a[128:131], v[48:51], a[0:3]
  s_waitcnt lgkmcnt(2)
  s_barrier
  v_mfma_f32_16x16x32_bf16 a[0:3], a[144:147], v[56:59], a[0:3]
  ds_read_b64_tr_b16 a[160:161], v10 offset:8704
  buffer_load_dwordx4 v[196:199], v15, s[4:7], s63 offen offset:2048
  v_mfma_f32_16x16x32_bf16 a[4:7], a[148:151], v[56:59], a[4:7]
  ds_read_b64_tr_b16 a[162:163], v10 offset:9216
  v_mfma_f32_16x16x32_bf16 a[4:7], a[132:135], v[48:51], a[4:7]
  ds_read_b64_tr_b16 a[164:165], v11 offset:8736
  v_mfma_f32_16x16x32_bf16 a[8:11], a[136:139], v[48:51], a[8:11]
  ds_read_b64_tr_b16 a[166:167], v11 offset:9248
  v_mfma_f32_16x16x32_bf16 a[8:11], a[152:155], v[56:59], a[8:11]
  ds_read_b64_tr_b16 a[168:169], v10 offset:8768
  s_add_u32 s63, s24, 262144
  v_mfma_f32_16x16x32_bf16 a[12:15], a[156:159], v[56:59], a[12:15]
  ds_read_b64_tr_b16 a[170:171], v10 offset:9280
  buffer_load_dwordx4 v[200:203], v16, s[4:7], s63 offen offset:0
  v_mfma_f32_16x16x32_bf16 a[12:15], a[140:143], v[48:51], a[12:15]
  ds_read_b64_tr_b16 a[172:173], v11 offset:8800
  v_mfma_f32_16x16x32_bf16 a[28:31], a[140:143], v[56:59], a[28:31]
  ds_read_b64_tr_b16 a[174:175], v11 offset:9312
  v_mfma_f32_16x16x32_bf16 a[28:31], a[156:159], v[52:55], a[28:31]
  ds_read_b128 v[76:79], v28 offset:1056
  s_add_u32 m0, s29, 58080
  v_mfma_f32_16x16x32_bf16 a[24:27], a[152:155], v[52:55], a[24:27]
  s_add_u32 s51, s40, 131072
  v_mfma_f32_16x16x32_bf16 a[24:27], a[136:139], v[56:59], a[24:27]
  buffer_load_dwordx4 v26, s[4:7], s51 offen  lds
  v_mfma_f32_16x16x32_bf16 a[20:23], a[132:135], v[56:59], a[20:23]
  v_mfma_f32_16x16x32_bf16 a[20:23], a[148:151], v[52:55], a[20:23]
  v_mfma_f32_16x16x32_bf16 a[16:19], a[144:147], v[52:55], a[16:19]
  v_mfma_f32_16x16x32_bf16 a[16:19], a[128:131], v[56:59], a[16:19]
  v_mfma_f32_16x16x32_bf16 a[32:35], a[128:131], v[52:55], a[32:35]
  buffer_load_dwordx4 v[204:207], v16, s[4:7], s63 offen offset:2048
  v_mfma_f32_16x16x32_bf16 a[32:35], a[144:147], v[60:63], a[32:35]
  v_mfma_f32_16x16x32_bf16 a[36:39], a[148:151], v[60:63], a[36:39]
  v_mfma_f32_16x16x32_bf16 a[36:39], a[132:135], v[52:55], a[36:39]
  s_add_u32 m0, s32, 26112
  v_mfma_f32_16x16x32_bf16 a[40:43], a[136:139], v[52:55], a[40:43]
  s_add_u32 s50, s47, 12582912
  v_mfma_f32_16x16x32_bf16 a[40:43], a[152:155], v[60:63], a[40:43]
  buffer_load_dwordx4 v29, s[8:11], s50 offen  lds
  v_mfma_f32_16x16x32_bf16 a[44:47], a[156:159], v[60:63], a[44:47]
  v_mfma_f32_16x16x32_bf16 a[44:47], a[140:143], v[52:55], a[44:47]
  v_mfma_f32_16x16x32_bf16 a[60:63], a[140:143], v[60:63], a[60:63]
  s_add_u32 m0, s29, 62304
  v_mfma_f32_16x16x32_bf16 a[60:63], a[156:159], v[68:71], a[60:63]
  s_add_u32 s51, s40, 262144
  v_mfma_f32_16x16x32_bf16 a[56:59], a[152:155], v[68:71], a[56:59]
  buffer_load_dwordx4 v26, s[4:7], s51 offen  lds
  v_mfma_f32_16x16x32_bf16 a[56:59], a[136:139], v[60:63], a[56:59]
  v_mfma_f32_16x16x32_bf16 a[52:55], a[132:135], v[60:63], a[52:55]
  ds_read_b128 v[84:87], v28 offset:1184
  v_mfma_f32_16x16x32_bf16 a[52:55], a[148:151], v[68:71], a[52:55]
  v_mfma_f32_16x16x32_bf16 a[48:51], a[144:147], v[68:71], a[48:51]
  s_add_u32 m0, s32, 27200
  v_mfma_f32_16x16x32_bf16 a[48:51], a[128:131], v[60:63], a[48:51]
  buffer_load_dwordx4 v30, s[8:11], s50 offen  lds
  v_mfma_f32_16x16x32_bf16 a[64:67], a[128:131], v[68:71], a[64:67]
  s_waitcnt vmcnt(11)
  s_waitcnt vmcnt(9)
  v_lshlrev_b32 v224, 16, v184
  v_mfma_f32_16x16x32_bf16 a[64:67], a[144:147], v[64:67], a[64:67]
  ds_read_b64_tr_b16 a[176:177], v10 offset:13056
  v_lshlrev_b32 v225, 16, v188
  v_mfma_f32_16x16x32_bf16 a[68:71], a[148:151], v[64:67], a[68:71]
  s_add_u32 m0, s32, 30464
  ds_read_b64_tr_b16 a[178:179], v10 offset:13568
  v_and_b32 v226, 0xffff0000, v184
  v_mfma_f32_16x16x32_bf16 a[68:71], a[132:135], v[68:71], a[68:71]
  s_add_u32 s50, s48, 0
  ds_read_b64_tr_b16 a[180:181], v11 offset:13088
  v_and_b32 v227, 0xffff0000, v188
  v_mfma_f32_16x16x32_bf16 a[72:75], a[136:139], v[68:71], a[72:75]
  ds_read_b64_tr_b16 a[182:183], v11 offset:13600
  buffer_load_dwordx4 v29, s[8:11], s50 offen  lds
  v_mfma_f32_16x16x32_bf16 a[72:75], a[152:155], v[64:67], a[72:75]
  ds_read_b64_tr_b16 a[184:185], v10 offset:13120
  v_add_f32 v224, v224, v225
  v_mfma_f32_16x16x32_bf16 a[76:79], a[156:159], v[64:67], a[76:79]
  ds_read_b64_tr_b16 a[186:187], v10 offset:13632
  v_add_f32 v226, v226, v227
  v_mfma_f32_16x16x32_bf16 a[76:79], a[140:143], v[68:71], a[76:79]
  s_add_u32 m0, s29, 66528
  ds_read_b64_tr_b16 a[188:189], v11 offset:13152
  v_cvt_pk_bf16_f32 v184, v224, v226
  v_mfma_f32_16x16x32_bf16 a[92:95], a[140:143], v[64:67], a[92:95]
  s_add_u32 s51, s40, 393216
  ds_read_b64_tr_b16 a[190:191], v11 offset:13664
  s_waitcnt lgkmcnt(15)
  v_mfma_f32_16x16x32_bf16 a[92:95], a[156:159], v[72:75], a[92:95]
  buffer_load_dwordx4 v26, s[4:7], s51 offen  lds
  v_lshlrev_b32 v228, 16, v185
  v_mfma_f32_16x16x32_bf16 a[88:91], a[152:155], v[72:75], a[88:91]
  v_lshlrev_b32 v229, 16, v189
  v_and_b32 v230, 0xffff0000, v185
  v_mfma_f32_16x16x32_bf16 a[88:91], a[136:139], v[64:67], a[88:91]
  v_and_b32 v231, 0xffff0000, v189
  v_add_f32 v228, v228, v229
  v_mfma_f32_16x16x32_bf16 a[84:87], a[132:135], v[64:67], a[84:87]
  v_add_f32 v230, v230, v231
  v_cvt_pk_bf16_f32 v185, v228, v230
  v_mfma_f32_16x16x32_bf16 a[84:87], a[148:151], v[72:75], a[84:87]
  s_add_u32 m0, s32, 31552
  v_lshlrev_b32 v224, 16, v186
  v_lshlrev_b32 v225, 16, v190
  v_mfma_f32_16x16x32_bf16 a[80:83], a[144:147], v[72:75], a[80:83]
  buffer_load_dwordx4 v30, s[8:11], s50 offen  lds
  v_and_b32 v226, 0xffff0000, v186
  v_mfma_f32_16x16x32_bf16 a[80:83], a[128:131], v[64:67], a[80:83]
  ds_read_b128 v[92:95], v28 offset:1312
  v_and_b32 v227, 0xffff0000, v190
  v_mfma_f32_16x16x32_bf16 a[96:99], a[128:131], v[72:75], a[96:99]
  v_add_f32 v224, v224, v225
  v_add_f32 v226, v226, v227
  v_mfma_f32_16x16x32_bf16 a[96:99], a[144:147], v[80:83], a[96:99]
  s_mov_b32 m0, s31
  v_cvt_pk_bf16_f32 v186, v224, v226
  v_lshlrev_b32 v228, 16, v187
  v_mfma_f32_16x16x32_bf16 a[100:103], a[148:151], v[80:83], a[100:103]
  s_add_u32 s51, s40, 524288
  v_lshlrev_b32 v229, 16, v191
  v_and_b32 v230, 0xffff0000, v187
  v_mfma_f32_16x16x32_bf16 a[100:103], a[132:135], v[72:75], a[100:103]
  buffer_load_dwordx4 v2, s[4:7], s51 offen  lds
  v_and_b32 v231, 0xffff0000, v191
  v_mfma_f32_16x16x32_bf16 a[104:107], a[136:139], v[72:75], a[104:107]
  v_add_f32 v228, v228, v229
  v_add_f32 v230, v230, v231
  v_mfma_f32_16x16x32_bf16 a[104:107], a[152:155], v[80:83], a[104:107]
  v_cvt_pk_bf16_f32 v187, v228, v230
  v_mfma_f32_16x16x32_bf16 a[108:111], a[156:159], v[80:83], a[108:111]
  v_mfma_f32_16x16x32_bf16 a[108:111], a[140:143], v[72:75], a[108:111]
  s_add_u32 s74, s62, 139264
  v_mfma_f32_16x16x32_bf16 a[124:127], a[140:143], v[80:83], a[124:127]
  buffer_store_dwordx4 v[184:187], v17, s[12:15], s74 offen sc1
  s_waitcnt lgkmcnt(10)
  v_mfma_f32_16x16x32_bf16 a[124:127], a[156:159], v[76:79], a[124:127]
  v_mfma_f32_16x16x32_bf16 a[120:123], a[152:155], v[76:79], a[120:123]
  v_mfma_f32_16x16x32_bf16 a[120:123], a[136:139], v[80:83], a[120:123]
  s_add_u32 m0, s32, 0
  v_mfma_f32_16x16x32_bf16 a[116:119], a[132:135], v[80:83], a[116:119]
  s_add_u32 s50, s48, 2097152
  v_mfma_f32_16x16x32_bf16 a[116:119], a[148:151], v[76:79], a[116:119]
  buffer_load_dwordx4 v29, s[8:11], s50 offen  lds
  v_mfma_f32_16x16x32_bf16 a[112:115], a[144:147], v[76:79], a[112:115]
  v_mfma_f32_16x16x32_bf16 a[112:115], a[128:131], v[80:83], a[112:115]
  v_mfma_f32_16x16x32_bf16 a[0:3], a[160:163], v[52:55], a[0:3]
  s_waitcnt lgkmcnt(1)
  s_barrier
  v_mfma_f32_16x16x32_bf16 a[0:3], a[176:179], v[60:63], a[0:3]
  ds_read_b64_tr_b16 a[128:129], v10 offset:17408
  s_add_u32 m0, s32, 1088
  v_mfma_f32_16x16x32_bf16 a[4:7], a[180:183], v[60:63], a[4:7]
  ds_read_b64_tr_b16 a[130:131], v10 offset:17920
  buffer_load_dwordx4 v30, s[8:11], s50 offen  lds
  v_mfma_f32_16x16x32_bf16 a[4:7], a[164:167], v[52:55], a[4:7]
  ds_read_b64_tr_b16 a[132:133], v11 offset:17440
  ds_read_b128 v[88:91], v28 offset:1440
  v_mfma_f32_16x16x32_bf16 a[8:11], a[168:171], v[52:55], a[8:11]
  ds_read_b64_tr_b16 a[134:135], v11 offset:17952
  v_mfma_f32_16x16x32_bf16 a[8:11], a[184:187], v[60:63], a[8:11]
  ds_read_b64_tr_b16 a[136:137], v10 offset:17472
  s_add_u32 m0, s32, 4352
  v_mfma_f32_16x16x32_bf16 a[12:15], a[188:191], v[60:63], a[12:15]
  ds_read_b64_tr_b16 a[138:139], v10 offset:17984
  s_add_u32 s50, s48, 4194304
  v_mfma_f32_16x16x32_bf16 a[12:15], a[172:175], v[52:55], a[12:15]
  ds_read_b64_tr_b16 a[140:141], v11 offset:17504
  buffer_load_dwordx4 v29, s[8:11], s50 offen  lds
  v_mfma_f32_16x16x32_bf16 a[28:31], a[172:175], v[60:63], a[28:31]
  ds_read_b64_tr_b16 a[142:143], v11 offset:18016
  v_mfma_f32_16x16x32_bf16 a[28:31], a[188:191], v[68:71], a[28:31]
  v_mfma_f32_16x16x32_bf16 a[24:27], a[184:187], v[68:71], a[24:27]
  v_mfma_f32_16x16x32_bf16 a[24:27], a[168:171], v[60:63], a[24:27]
  s_add_u32 m0, s32, 5440
  v_mfma_f32_16x16x32_bf16 a[20:23], a[164:167], v[60:63], a[20:23]
  buffer_load_dwordx4 v30, s[8:11], s50 offen  lds
  v_mfma_f32_16x16x32_bf16 a[20:23], a[180:183], v[68:71], a[20:23]
  v_mfma_f32_16x16x32_bf16 a[16:19], a[176:179], v[68:71], a[16:19]
  s_waitcnt vmcnt(17)
  s_waitcnt vmcnt(15)
  v_lshlrev_b32 v224, 16, v192
  v_mfma_f32_16x16x32_bf16 a[16:19], a[160:163], v[60:63], a[16:19]
  s_add_u32 m0, s32, 8704
  v_lshlrev_b32 v225, 16, v196
  v_and_b32 v226, 0xffff0000, v192
  v_mfma_f32_16x16x32_bf16 a[32:35], a[160:163], v[68:71], a[32:35]
  s_add_u32 s50, s48, 6291456
  v_and_b32 v227, 0xffff0000, v196
  v_add_f32 v224, v224, v225
  v_mfma_f32_16x16x32_bf16 a[32:35], a[176:179], v[64:67], a[32:35]
  buffer_load_dwordx4 v29, s[8:11], s50 offen  lds
  v_add_f32 v226, v226, v227
  v_mfma_f32_16x16x32_bf16 a[36:39], a[180:183], v[64:67], a[36:39]
  v_cvt_pk_bf16_f32 v192, v224, v226
  v_lshlrev_b32 v228, 16, v193
  v_mfma_f32_16x16x32_bf16 a[36:39], a[164:167], v[68:71], a[36:39]
  v_lshlrev_b32 v229, 16, v197
  v_and_b32 v230, 0xffff0000, v193
  v_mfma_f32_16x16x32_bf16 a[40:43], a[168:171], v[68:71], a[40:43]
  v_and_b32 v231, 0xffff0000, v197
  v_add_f32 v228, v228, v229
  v_mfma_f32_16x16x32_bf16 a[40:43], a[184:187], v[64:67], a[40:43]
  s_add_u32 m0, s32, 9792
  v_add_f32 v230, v230, v231
  v_cvt_pk_bf16_f32 v193, v228, v230
  v_mfma_f32_16x16x32_bf16 a[44:47], a[188:191], v[64:67], a[44:47]
  ds_read_b128 v[96:99], v28 offset:1568
  buffer_load_dwordx4 v30, s[8:11], s50 offen  lds
  v_mfma_f32_16x16x32_bf16 a[44:47], a[172:175], v[68:71], a[44:47]
  v_lshlrev_b32 v224, 16, v194
  v_lshlrev_b32 v225, 16, v198
  v_mfma_f32_16x16x32_bf16 a[60:63], a[172:175], v[64:67], a[60:63]
  v_and_b32 v226, 0xffff0000, v194
  v_and_b32 v227, 0xffff0000, v198
  v_mfma_f32_16x16x32_bf16 a[60:63], a[188:191], v[72:75], a[60:63]
  s_add_u32 m0, s32, 13056
  v_add_f32 v224, v224, v225
  v_add_f32 v226, v226, v227
  v_mfma_f32_16x16x32_bf16 a[56:59], a[184:187], v[72:75], a[56:59]
  s_add_u32 s50, s48, 8388608
  v_cvt_pk_bf16_f32 v194, v224, v226
  v_lshlrev_b32 v228, 16, v195
  v_mfma_f32_16x16x32_bf16 a[56:59], a[168:171], v[64:67], a[56:59]
  buffer_load_dwordx4 v29, s[8:11], s50 offen  lds
  v_lshlrev_b32 v229, 16, v199
  v_mfma_f32_16x16x32_bf16 a[52:55], a[164:167], v[64:67], a[52:55]
  v_and_b32 v230, 0xffff0000, v195
  v_and_b32 v231, 0xffff0000, v199
  v_mfma_f32_16x16x32_bf16 a[52:55], a[180:183], v[72:75], a[52:55]
  v_add_f32 v228, v228, v229
  v_add_f32 v230, v230, v231
  v_mfma_f32_16x16x32_bf16 a[48:51], a[176:179], v[72:75], a[48:51]
  v_cvt_pk_bf16_f32 v195, v228, v230
  v_mfma_f32_16x16x32_bf16 a[48:51], a[160:163], v[64:67], a[48:51]
  s_add_u32 s74, s62, 147456
  v_mfma_f32_16x16x32_bf16 a[64:67], a[160:163], v[72:75], a[64:67]
  buffer_store_dwordx4 v[192:195], v17, s[12:15], s74 offen sc1
  v_mfma_f32_16x16x32_bf16 a[64:67], a[176:179], v[80:83], a[64:67]
  ds_read_b64_tr_b16 a[144:145], v10 offset:21760
  v_mfma_f32_16x16x32_bf16 a[68:71], a[180:183], v[80:83], a[68:71]
  ds_read_b64_tr_b16 a[146:147], v10 offset:22272
  v_mfma_f32_16x16x32_bf16 a[68:71], a[164:167], v[72:75], a[68:71]
  ds_read_b64_tr_b16 a[148:149], v11 offset:21792
  v_mfma_f32_16x16x32_bf16 a[72:75], a[168:171], v[72:75], a[72:75]
  ds_read_b64_tr_b16 a[150:151], v11 offset:22304
  s_add_u32 m0, s32, 14144
  v_mfma_f32_16x16x32_bf16 a[72:75], a[184:187], v[80:83], a[72:75]
  ds_read_b64_tr_b16 a[152:153], v10 offset:21824
  buffer_load_dwordx4 v30, s[8:11], s50 offen  lds
  v_mfma_f32_16x16x32_bf16 a[76:79], a[188:191], v[80:83], a[76:79]
  ds_read_b64_tr_b16 a[154:155], v10 offset:22336
  v_mfma_f32_16x16x32_bf16 a[76:79], a[172:175], v[72:75], a[76:79]
  ds_read_b64_tr_b16 a[156:157], v11 offset:21856
  v_mfma_f32_16x16x32_bf16 a[92:95], a[172:175], v[80:83], a[92:95]
  ds_read_b64_tr_b16 a[158:159], v11 offset:22368
  v_mfma_f32_16x16x32_bf16 a[92:95], a[188:191], v[76:79], a[92:95]
  ds_read_b128 v[104:107], v28 offset:1696
  s_mov_b32 s52, 8192
  v_mfma_f32_16x16x32_bf16 a[88:91], a[184:187], v[76:79], a[88:91]
  buffer_load_dwordx4 v[128:131], v13, s[12:15], s52 offen offset:0 sc1
  v_mfma_f32_16x16x32_bf16 a[88:91], a[168:171], v[80:83], a[88:91]
  v_mfma_f32_16x16x32_bf16 a[84:87], a[164:167], v[80:83], a[84:87]
  v_mfma_f32_16x16x32_bf16 a[84:87], a[180:183], v[76:79], a[84:87]
  v_mfma_f32_16x16x32_bf16 a[80:83], a[176:179], v[76:79], a[80:83]
  v_mfma_f32_16x16x32_bf16 a[80:83], a[160:163], v[80:83], a[80:83]
  ds_read_b64_tr_b16 v[168:169], v12 offset:0
  buffer_load_dwordx4 v[132:135], v13, s[12:15], s52 offen offset:1024 sc1
  v_mfma_f32_16x16x32_bf16 a[96:99], a[160:163], v[76:79], a[96:99]
  ds_read_b64_tr_b16 v[170:171], v12 offset:512
  v_mfma_f32_16x16x32_bf16 a[96:99], a[176:179], v[84:87], a[96:99]
  ds_read_b64_tr_b16 v[172:173], v12 offset:8
  v_mfma_f32_16x16x32_bf16 a[100:103], a[180:183], v[84:87], a[100:103]
  ds_read_b64_tr_b16 v[174:175], v12 offset:520
  v_mfma_f32_16x16x32_bf16 a[100:103], a[164:167], v[76:79], a[100:103]
  ds_read_b64_tr_b16 v[176:177], v12 offset:64
  s_mov_b32 s52, 122880
  v_mfma_f32_16x16x32_bf16 a[104:107], a[168:171], v[76:79], a[104:107]
  s_mul_i32 s29, s28, 2080
  ds_read_b64_tr_b16 v[178:179], v12 offset:576
  s_lshl_b32 s3, s28, 10
  s_add_u32 s30, s3, 33280
  s_add_u32 s31, s3, 69184
  v_mfma_f32_16x16x32_bf16 a[104:107], a[184:187], v[84:87], a[104:107]
  buffer_load_dwordx4 a[192:195], v13, s[12:15], s52 offen offset:0 sc1
  ds_read_b64_tr_b16 v[180:181], v12 offset:72
  v_mfma_f32_16x16x32_bf16 a[108:111], a[188:191], v[84:87], a[108:111]
  s_cmp_gt_u32 s28, 1
  ds_read_b64_tr_b16 v[182:183], v12 offset:584
  s_cselect_b32 s30, 158848, s30
  v_mfma_f32_16x16x32_bf16 a[108:111], a[172:175], v[76:79], a[108:111]
  s_cselect_b32 s31, 158848, s31
  v_mfma_f32_16x16x32_bf16 a[124:127], a[172:175], v[84:87], a[124:127]
  s_waitcnt vmcnt(22)
  s_waitcnt vmcnt(20)
  s_waitcnt lgkmcnt(15)
  v_mfma_f32_16x16x32_bf16 a[124:127], a[188:191], v[92:95], a[124:127]
  buffer_load_dwordx4 a[196:199], v13, s[12:15], s52 offen offset:1024 sc1
  v_lshlrev_b32 v224, 16, v200
  v_mfma_f32_16x16x32_bf16 a[120:123], a[184:187], v[92:95], a[120:123]
  v_lshlrev_b32 v225, 16, v204
  v_and_b32 v226, 0xffff0000, v200
  v_mfma_f32_16x16x32_bf16 a[120:123], a[168:171], v[84:87], a[120:123]
  v_and_b32 v227, 0xffff0000, v204
  v_add_f32 v224, v224, v225
  v_mfma_f32_16x16x32_bf16 a[116:119], a[164:167], v[84:87], a[116:119]
  s_waitcnt lgkmcnt(0)
  v_add_f32 v226, v226, v227
  v_cvt_pk_bf16_f32 v200, v224, v226
  v_mfma_f32_16x16x32_bf16 a[116:119], a[180:183], v[92:95], a[116:119]
  s_mov_b32 s52, 131072
  v_lshlrev_b32 v228, 16, v201
  v_lshlrev_b32 v229, 16, v205
  v_mfma_f32_16x16x32_bf16 a[112:115], a[176:179], v[92:95], a[112:115]
  buffer_load_dwordx4 a[200:203], v13, s[12:15], s52 offen offset:0 sc1
  v_and_b32 v230, 0xffff0000, v201
  v_mfma_f32_16x16x32_bf16 a[112:115], a[160:163], v[84:87], a[112:115]
  v_and_b32 v231, 0xffff0000, v205
  v_add_f32 v228, v228, v229
  v_mfma_f32_16x16x32_bf16 a[0:3], a[128:131], v[68:71], a[0:3]
  s_waitcnt vmcnt(15)
  s_barrier
  v_mfma_f32_16x16x32_bf16 a[0:3], a[144:147], v[64:67], a[0:3]
  s_add_u32 m0, s29, 0
  ds_read_b64_tr_b16 a[160:161], v10 offset:26112
  v_add_f32 v230, v230, v231
  v_mfma_f32_16x16x32_bf16 a[4:7], a[148:151], v[64:67], a[4:7]
  s_add_u32 s51, s49, 0
  ds_read_b64_tr_b16 a[162:163], v10 offset:26624
  v_cvt_pk_bf16_f32 v201, v228, v230
  v_mfma_f32_16x16x32_bf16 a[4:7], a[132:135], v[68:71], a[4:7]
  ds_read_b64_tr_b16 a[164:165], v11 offset:26144
  buffer_load_dwordx4 v3, s[12:15], s51 offen sc1 lds
  v_mfma_f32_16x16x32_bf16 a[8:11], a[136:139], v[68:71], a[8:11]
  ds_read_b64_tr_b16 a[166:167], v11 offset:26656
  v_lshlrev_b32 v224, 16, v202
  v_mfma_f32_16x16x32_bf16 a[8:11], a[152:155], v[64:67], a[8:11]
  ds_read_b64_tr_b16 a[168:169], v10 offset:26176
  v_lshlrev_b32 v225, 16, v206
  v_mfma_f32_16x16x32_bf16 a[12:15], a[156:159], v[64:67], a[12:15]
  s_add_u32 m0, s29, 8320
  ds_read_b64_tr_b16 a[170:171], v10 offset:26688
  v_and_b32 v226, 0xffff0000, v202
  v_mfma_f32_16x16x32_bf16 a[12:15], a[140:143], v[68:71], a[12:15]
  s_add_u32 s51, s49, 8192
  ds_read_b64_tr_b16 a[172:173], v11 offset:26208
  v_and_b32 v227, 0xffff0000, v206
  v_mfma_f32_16x16x32_bf16 a[28:31], a[140:143], v[64:67], a[28:31]
  ds_read_b64_tr_b16 a[174:175], v11 offset:26720
  buffer_load_dwordx4 v3, s[12:15], s51 offen sc1 lds
  v_mfma_f32_16x16x32_bf16 a[28:31], a[156:159], v[72:75], a[28:31]
  v_add_f32 v224, v224, v225
  v_add_f32 v226, v226, v227
  v_mfma_f32_16x16x32_bf16 a[24:27], a[152:155], v[72:75], a[24:27]
  ds_read_b128 v[100:103], v28 offset:35904
  v_cvt_pk_bf16_f32 v202, v224, v226
  v_mfma_f32_16x16x32_bf16 a[24:27], a[136:139], v[64:67], a[24:27]
  s_add_u32 m0, s29, 16640
  v_lshlrev_b32 v228, 16, v203
  v_lshlrev_b32 v229, 16, v207
  v_mfma_f32_16x16x32_bf16 a[20:23], a[132:135], v[64:67], a[20:23]
  s_add_u32 s51, s49, 16384
  v_and_b32 v230, 0xffff0000, v203
  v_and_b32 v231, 0xffff0000, v207
  v_mfma_f32_16x16x32_bf16 a[20:23], a[148:151], v[72:75], a[20:23]
  buffer_load_dwordx4 v3, s[12:15], s51 offen sc1 lds
  v_add_f32 v228, v228, v229
  v_mfma_f32_16x16x32_bf16 a[16:19], a[144:147], v[72:75], a[16:19]
  v_add_f32 v230, v230, v231
  v_cvt_pk_bf16_f32 v203, v228, v230
  v_mfma_f32_16x16x32_bf16 a[16:19], a[128:131], v[64:67], a[16:19]
  ds_read_b128 v[108:111], v28 offset:36032
  v_mfma_f32_16x16x32_bf16 a[32:35], a[128:131], v[72:75], a[32:35]
  s_add_u32 m0, s29, 24960
  v_mfma_f32_16x16x32_bf16 a[32:35], a[144:147], v[80:83], a[32:35]
  s_add_u32 s51, s49, 24576
  v_mfma_f32_16x16x32_bf16 a[36:39], a[148:151], v[80:83], a[36:39]
  buffer_load_dwordx4 v3, s[12:15], s51 offen sc1 lds
  v_mfma_f32_16x16x32_bf16 a[36:39], a[132:135], v[72:75], a[36:39]
  v_mfma_f32_16x16x32_bf16 a[40:43], a[136:139], v[72:75], a[40:43]
  v_mfma_f32_16x16x32_bf16 a[40:43], a[152:155], v[80:83], a[40:43]
  ds_read_b128 v[116:119], v28 offset:36160
  s_add_u32 m0, s29, 1024
  v_mfma_f32_16x16x32_bf16 a[44:47], a[156:159], v[80:83], a[44:47]
  s_add_u32 s51, s49, 1024
  v_mfma_f32_16x16x32_bf16 a[44:47], a[140:143], v[72:75], a[44:47]
  buffer_load_dwordx4 v3, s[12:15], s51 offen sc1 lds
  v_mfma_f32_16x16x32_bf16 a[60:63], a[140:143], v[80:83], a[60:63]
  v_mfma_f32_16x16x32_bf16 a[60:63], a[156:159], v[76:79], a[60:63]
  v_mfma_f32_16x16x32_bf16 a[56:59], a[152:155], v[76:79], a[56:59]
  s_add_u32 m0, s29, 9344
  v_mfma_f32_16x16x32_bf16 a[56:59], a[136:139], v[80:83], a[56:59]
  ds_read_b128 v[112:115], v28 offset:36288
  s_add_u32 s51, s49, 9216
  v_mfma_f32_16x16x32_bf16 a[52:55], a[132:135], v[80:83], a[52:55]
  buffer_load_dwordx4 v3, s[12:15], s51 offen sc1 lds
  v_mfma_f32_16x16x32_bf16 a[52:55], a[148:151], v[76:79], a[52:55]
  v_mfma_f32_16x16x32_bf16 a[48:51], a[144:147], v[76:79], a[48:51]
  v_mfma_f32_16x16x32_bf16 a[48:51], a[128:131], v[80:83], a[48:51]
  s_add_u32 m0, s29, 17664
  v_mfma_f32_16x16x32_bf16 a[64:67], a[128:131], v[76:79], a[64:67]
  s_add_u32 s51, s49, 17408
  v_mfma_f32_16x16x32_bf16 a[64:67], a[144:147], v[84:87], a[64:67]
  ds_read_b64_tr_b16 a[176:177], v10 offset:30464
  ds_read_b128 v[48:51], v28 offset:36416
  v_mfma_f32_16x16x32_bf16 a[68:71], a[148:151], v[84:87], a[68:71]
  buffer_load_dwordx4 v3, s[12:15], s51 offen sc1 lds
  ds_read_b64_tr_b16 a[178:179], v10 offset:30976
  v_mfma_f32_16x16x32_bf16 a[68:71], a[132:135], v[76:79], a[68:71]
  ds_read_b64_tr_b16 a[180:181], v11 offset:30496
  v_mfma_f32_16x16x32_bf16 a[72:75], a[136:139], v[76:79], a[72:75]
  ds_read_b64_tr_b16 a[182:183], v11 offset:31008
  s_add_u32 m0, s29, 25984
  v_mfma_f32_16x16x32_bf16 a[72:75], a[152:155], v[84:87], a[72:75]
  ds_read_b64_tr_b16 a[184:185], v10 offset:30528
  s_add_u32 s51, s49, 25600
  v_mfma_f32_16x16x32_bf16 a[76:79], a[156:159], v[84:87], a[76:79]
  ds_read_b64_tr_b16 a[186:187], v10 offset:31040
  ds_read_b128 v[56:59], v28 offset:36544
  v_mfma_f32_16x16x32_bf16 a[76:79], a[140:143], v[76:79], a[76:79]
  buffer_load_dwordx4 v3, s[12:15], s51 offen sc1 lds
  ds_read_b64_tr_b16 a[188:189], v11 offset:30560
  v_mfma_f32_16x16x32_bf16 a[92:95], a[140:143], v[84:87], a[92:95]
  ds_read_b64_tr_b16 a[190:191], v11 offset:31072
  v_lshlrev_b32 v224, 16, v152
  v_mfma_f32_16x16x32_bf16 a[92:95], a[156:159], v[92:95], a[92:95]
  s_mov_b32 m0, s30
  v_lshlrev_b32 v225, 16, v168
  v_and_b32 v226, 0xffff0000, v152
  v_mfma_f32_16x16x32_bf16 a[88:91], a[152:155], v[92:95], a[88:91]
  s_add_u32 s51, s49, 32768
  v_and_b32 v227, 0xffff0000, v168
  v_add_f32 v224, v224, v225
  v_mfma_f32_16x16x32_bf16 a[88:91], a[136:139], v[84:87], a[88:91]
  buffer_load_dwordx4 v4, s[12:15], s51 offen sc1 lds
  v_add_f32 v226, v226, v227
  v_mfma_f32_16x16x32_bf16 a[84:87], a[132:135], v[84:87], a[84:87]
  ds_read_b128 v[52:55], v28 offset:36672
  v_cvt_pk_bf16_f32 v152, v224, v226
  v_mfma_f32_16x16x32_bf16 a[84:87], a[148:151], v[92:95], a[84:87]
  v_lshlrev_b32 v228, 16, v153
  v_lshlrev_b32 v229, 16, v169
  v_mfma_f32_16x16x32_bf16 a[80:83], a[144:147], v[92:95], a[80:83]
  v_and_b32 v230, 0xffff0000, v153
  v_and_b32 v231, 0xffff0000, v169
  v_mfma_f32_16x16x32_bf16 a[80:83], a[128:131], v[84:87], a[80:83]
  s_add_u32 s74, s62, 155648
  v_add_f32 v228, v228, v229
  v_add_f32 v230, v230, v231
  v_mfma_f32_16x16x32_bf16 a[96:99], a[128:131], v[92:95], a[96:99]
  buffer_store_dwordx4 v[200:203], v18, s[12:15], s74 offen sc1
  v_cvt_pk_bf16_f32 v153, v228, v230
  v_lshlrev_b32 v224, 16, v154
  v_lshlrev_b32 v225, 16, v170
  v_and_b32 v226, 0xffff0000, v154
  v_mfma_f32_16x16x32_bf16 a[96:99], a[144:147], v[88:91], a[96:99]
  v_and_b32 v227, 0xffff0000, v170
  v_add_f32 v224, v224, v225
  v_mfma_f32_16x16x32_bf16 a[100:103], a[148:151], v[88:91], a[100:103]
  ds_read_b128 v[60:63], v28 offset:36800
  v_add_f32 v226, v226, v227
L_it2:
  v_add_u32 v252, L_it2-standalone__self_sup_conv_stem_hubert__speech_kernel+3072, v253
  v_mfma_f32_16x16x32_bf16 a[100:103], a[132:135], v[92:95], a[100:103]
  v_cvt_pk_bf16_f32 v154, v224, v226
  v_lshlrev_b32 v228, 16, v155
  v_mfma_f32_16x16x32_bf16 a[104:107], a[136:139], v[92:95], a[104:107]
  v_min_u32 v252, L_end-standalone__self_sup_conv_stem_hubert__speech_kernel-8, v252
  v_lshlrev_b32 v229, 16, v171
  v_mfma_f32_16x16x32_bf16 a[104:107], a[152:155], v[88:91], a[104:107]
  global_load_dword v255, v252, s[84:85]
  v_and_b32 v230, 0xffff0000, v155
  v_mfma_f32_16x16x32_bf16 a[108:111], a[156:159], v[88:91], a[108:111]
  v_and_b32 v231, 0xffff0000, v171
  v_add_f32 v228, v228, v229
  v_mfma_f32_16x16x32_bf16 a[108:111], a[140:143], v[92:95], a[108:111]
  v_add_f32 v230, v230, v231
  v_cvt_pk_bf16_f32 v155, v228, v230
  v_mfma_f32_16x16x32_bf16 a[124:127], a[140:143], v[88:91], a[124:127]
  v_mfma_f32_16x16x32_bf16 a[124:127], a[156:159], v[96:99], a[124:127]
  v_mfma_f32_16x16x32_bf16 a[120:123], a[152:155], v[96:99], a[120:123]
  buffer_store_dwordx4 v[152:155], v14, s[12:15], s59 offen offset:0 sc1
  v_mfma_f32_16x16x32_bf16 a[120:123], a[136:139], v[88:91], a[120:123]
  v_mfma_f32_16x16x32_bf16 a[116:119], a[132:135], v[88:91], a[116:119]
  v_mfma_f32_16x16x32_bf16 a[116:119], a[148:151], v[96:99], a[116:119]
  s_add_u32 m0, s32, 17408
  v_mfma_f32_16x16x32_bf16 a[112:115], a[144:147], v[96:99], a[112:115]
  s_add_u32 s50, s48, 10485760
  v_mfma_f32_16x16x32_bf16 a[112:115], a[128:131], v[88:91], a[112:115]
  buffer_load_dwordx4 v29, s[8:11], s50 offen  lds
  s_waitcnt lgkmcnt(15)
  v_mfma_f32_16x16x32_bf16 a[0:3], a[160:163], v[72:75], a[0:3]
  s_waitcnt vmcnt(23) lgkmcnt(2)
  s_barrier
  v_mfma_f32_16x16x32_bf16 a[0:3], a[176:179], v[100:103], a[0:3]
  ds_read_b64_tr_b16 a[128:129], v10 offset:0
  v_mfma_f32_16x16x32_bf16 a[4:7], a[180:183], v[100:103], a[4:7]
  ds_read_b64_tr_b16 a[130:131], v10 offset:512
  v_mfma_f32_16x16x32_bf16 a[4:7], a[164:167], v[72:75], a[4:7]
  ds_read_b64_tr_b16 a[132:133], v11 offset:32
  s_add_u32 m0, s32, 18496
  v_mfma_f32_16x16x32_bf16 a[8:11], a[168:171], v[72:75], a[8:11]
  ds_read_b64_tr_b16 a[134:135], v11 offset:544
  buffer_load_dwordx4 v30, s[8:11], s50 offen  lds
  v_mfma_f32_16x16x32_bf16 a[8:11], a[184:187], v[100:103], a[8:11]
  ds_read_b64_tr_b16 a[136:137], v10 offset:64
  v_mfma_f32_16x16x32_bf16 a[12:15], a[188:191], v[100:103], a[12:15]
  ds_read_b64_tr_b16 a[138:139], v10 offset:576
  v_mfma_f32_16x16x32_bf16 a[12:15], a[172:175], v[72:75], a[12:15]
  ds_read_b64_tr_b16 a[140:141], v11 offset:96
  s_add_u32 m0, s32, 21760
  v_mfma_f32_16x16x32_bf16 a[28:31], a[172:175], v[80:83], a[28:31]
  ds_read_b64_tr_b16 a[142:143], v11 offset:608
  s_add_u32 s50, s48, 12582912
  v_mfma_f32_16x16x32_bf16 a[28:31], a[188:191], v[108:111], a[28:31]
  buffer_load_dwordx4 v29, s[8:11], s50 offen  lds
  v_mfma_f32_16x16x32_bf16 a[24:27], a[184:187], v[108:111], a[24:27]
  v_mfma_f32_16x16x32_bf16 a[24:27], a[168:171], v[80:83], a[24:27]
  v_mfma_f32_16x16x32_bf16 a[20:23], a[164:167], v[80:83], a[20:23]
  v_mfma_f32_16x16x32_bf16 a[20:23], a[180:183], v[108:111], a[20:23]
  s_add_u32 m0, s32, 22848
  v_mfma_f32_16x16x32_bf16 a[16:19], a[176:179], v[108:111], a[16:19]
  buffer_load_dwordx4 v30, s[8:11], s50 offen  lds
  v_mfma_f32_16x16x32_bf16 a[16:19], a[160:163], v[80:83], a[16:19]
  v_mfma_f32_16x16x32_bf16 a[32:35], a[160:163], v[76:79], a[32:35]
  v_mfma_f32_16x16x32_bf16 a[32:35], a[176:179], v[116:119], a[32:35]
  v_mfma_f32_16x16x32_bf16 a[36:39], a[180:183], v[116:119], a[36:39]
  v_mfma_f32_16x16x32_bf16 a[36:39], a[164:167], v[76:79], a[36:39]
  buffer_load_dwordx4 a[204:207], v13, s[12:15], s52 offen offset:1024 sc1
  v_mfma_f32_16x16x32_bf16 a[40:43], a[168:171], v[76:79], a[40:43]
  v_mfma_f32_16x16x32_bf16 a[40:43], a[184:187], v[116:119], a[40:43]
  v_mfma_f32_16x16x32_bf16 a[44:47], a[188:191], v[116:119], a[44:47]
  v_mfma_f32_16x16x32_bf16 a[44:47], a[172:175], v[76:79], a[44:47]
  s_mov_b32 s52, 139264
  v_mfma_f32_16x16x32_bf16 a[60:63], a[172:175], v[84:87], a[60:63]
  buffer_load_dwordx4 a[208:211], v13, s[12:15], s52 offen offset:0 sc1
  v_lshlrev_b32 v224, 16, v156
  v_mfma_f32_16x16x32_bf16 a[60:63], a[188:191], v[112:115], a[60:63]
  v_lshlrev_b32 v225, 16, v172
  v_and_b32 v226, 0xffff0000, v156
  v_mfma_f32_16x16x32_bf16 a[56:59], a[184:187], v[112:115], a[56:59]
  v_and_b32 v227, 0xffff0000, v172
  v_add_f32 v224, v224, v225
  v_mfma_f32_16x16x32_bf16 a[56:59], a[168:171], v[84:87], a[56:59]
  v_add_f32 v226, v226, v227
  v_cvt_pk_bf16_f32 v156, v224, v226
  v_mfma_f32_16x16x32_bf16 a[52:55], a[164:167], v[84:87], a[52:55]
  v_lshlrev_b32 v228, 16, v157
  v_lshlrev_b32 v229, 16, v173
  v_mfma_f32_16x16x32_bf16 a[52:55], a[180:183], v[112:115], a[52:55]
  buffer_load_dwordx4 a[212:215], v13, s[12:15], s52 offen offset:1024 sc1
  v_and_b32 v230, 0xffff0000, v157
  v_mfma_f32_16x16x32_bf16 a[48:51], a[176:179], v[112:115], a[48:51]
  v_and_b32 v231, 0xffff0000, v173
  v_add_f32 v228, v228, v229
  v_mfma_f32_16x16x32_bf16 a[48:51], a[160:163], v[84:87], a[48:51]
  v_add_f32 v230, v230, v231
  v_cvt_pk_bf16_f32 v157, v228, v230
  v_mfma_f32_16x16x32_bf16 a[64:67], a[160:163], v[92:95], a[64:67]
  v_lshlrev_b32 v224, 16, v158
  v_lshlrev_b32 v225, 16, v174
  v_mfma_f32_16x16x32_bf16 a[64:67], a[176:179], v[48:51], a[64:67]
  s_mov_b32 s52, 147456
  ds_read_b64_tr_b16 a[144:145], v10 offset:4352
  v_and_b32 v226, 0xffff0000, v158
  v_mfma_f32_16x16x32_bf16 a[68:71], a[180:183], v[48:51], a[68:71]
  ds_read_b64_tr_b16 a[146:147], v10 offset:4864
  buffer_load_dwordx4 a[216:219], v13, s[12:15], s52 offen offset:0 sc1
  v_mfma_f32_16x16x32_bf16 a[68:71], a[164:167], v[92:95], a[68:71]
  ds_read_b64_tr_b16 a[148:149], v11 offset:4384
  v_and_b32 v227, 0xffff0000, v174
  v_mfma_f32_16x16x32_bf16 a[72:75], a[168:171], v[92:95], a[72:75]
  ds_read_b64_tr_b16 a[150:151], v11 offset:4896
  v_add_f32 v224, v224, v225
  v_mfma_f32_16x16x32_bf16 a[72:75], a[184:187], v[48:51], a[72:75]
  ds_read_b64_tr_b16 a[152:153], v10 offset:4416
  v_add_f32 v226, v226, v227
  v_mfma_f32_16x16x32_bf16 a[76:79], a[188:191], v[48:51], a[76:79]
  ds_read_b64_tr_b16 a[154:155], v10 offset:4928
  v_cvt_pk_bf16_f32 v158, v224, v226
  v_mfma_f32_16x16x32_bf16 a[76:79], a[172:175], v[92:95], a[76:79]
  ds_read_b64_tr_b16 a[156:157], v11 offset:4448
  buffer_load_dwordx4 a[220:223], v13, s[12:15], s52 offen offset:1024 sc1
  v_mfma_f32_16x16x32_bf16 a[92:95], a[172:175], v[88:91], a[92:95]
  ds_read_b64_tr_b16 a[158:159], v11 offset:4960
  v_lshlrev_b32 v228, 16, v159
  v_mfma_f32_16x16x32_bf16 a[92:95], a[188:191], v[56:59], a[92:95]
  ds_read_b128 v[68:71], v28 offset:36960
  v_lshlrev_b32 v229, 16, v175
  v_mfma_f32_16x16x32_bf16 a[88:91], a[184:187], v[56:59], a[88:91]
  v_and_b32 v230, 0xffff0000, v159
  v_and_b32 v231, 0xffff0000, v175
  v_mfma_f32_16x16x32_bf16 a[88:91], a[168:171], v[88:91], a[88:91]
  v_add_f32 v228, v228, v229
  v_add_f32 v230, v230, v231
  v_cvt_pk_bf16_f32 v159, v228, v230
  v_mfma_f32_16x16x32_bf16 a[84:87], a[164:167], v[88:91], a[84:87]
  buffer_store_dwordx4 v[156:159], v14, s[12:15], s59 offen offset:1024 sc1
  v_mfma_f32_16x16x32_bf16 a[84:87], a[180:183], v[56:59], a[84:87]
  v_mfma_f32_16x16x32_bf16 a[80:83], a[176:179], v[56:59], a[80:83]
  v_mfma_f32_16x16x32_bf16 a[80:83], a[160:163], v[88:91], a[80:83]
  v_mfma_f32_16x16x32_bf16 a[96:99], a[160:163], v[96:99], a[96:99]
  s_mov_b32 s52, 155648
  s_waitcnt lgkmcnt(15)
  v_mfma_f32_16x16x32_bf16 a[96:99], a[176:179], v[52:55], a[96:99]
  buffer_load_dwordx4 a[224:227], v13, s[12:15], s52 offen offset:0 sc1
  v_mfma_f32_16x16x32_bf16 a[100:103], a[180:183], v[52:55], a[100:103]
  v_mfma_f32_16x16x32_bf16 a[100:103], a[164:167], v[96:99], a[100:103]
  v_mfma_f32_16x16x32_bf16 a[104:107], a[168:171], v[96:99], a[104:107]
  v_mfma_f32_16x16x32_bf16 a[104:107], a[184:187], v[52:55], a[104:107]
  v_mfma_f32_16x16x32_bf16 a[108:111], a[188:191], v[52:55], a[108:111]
  buffer_load_dwordx4 a[228:231], v13, s[12:15], s52 offen offset:1024 sc1
  v_mfma_f32_16x16x32_bf16 a[108:111], a[172:175], v[96:99], a[108:111]
  v_mfma_f32_16x16x32_bf16 a[124:127], a[172:175], v[104:107], a[124:127]
  v_mfma_f32_16x16x32_bf16 a[124:127], a[188:191], v[60:63], a[124:127]
  v_mfma_f32_16x16x32_bf16 a[120:123], a[184:187], v[60:63], a[120:123]
  s_mov_b32 s52, 163840
  v_mfma_f32_16x16x32_bf16 a[120:123], a[168:171], v[104:107], a[120:123]
  buffer_load_dwordx4 a[232:235], v13, s[12:15], s52 offen offset:0 sc1
  v_mfma_f32_16x16x32_bf16 a[116:119], a[164:167], v[104:107], a[116:119]
  v_mfma_f32_16x16x32_bf16 a[116:119], a[180:183], v[60:63], a[116:119]
  v_mfma_f32_16x16x32_bf16 a[112:115], a[176:179], v[60:63], a[112:115]
  v_mfma_f32_16x16x32_bf16 a[112:115], a[160:163], v[104:107], a[112:115]
  v_mfma_f32_16x16x32_bf16 a[0:3], a[128:131], v[108:111], a[0:3]
  s_waitcnt vmcnt(30) lgkmcnt(1)
  s_barrier
  v_mfma_f32_16x16x32_bf16 a[0:3], a[144:147], v[116:119], a[0:3]
  buffer_load_dwordx4 a[236:239], v13, s[12:15], s52 offen offset:1024 sc1
  ds_read_b64_tr_b16 a[160:161], v10 offset:8704
  v_mfma_f32_16x16x32_bf16 a[4:7], a[148:151], v[116:119], a[4:7]
  ds_read_b128 v[64:67], v28 offset:37088
  ds_read_b64_tr_b16 a[162:163], v10 offset:9216
  v_mfma_f32_16x16x32_bf16 a[4:7], a[132:135], v[108:111], a[4:7]
  ds_read_b64_tr_b16 a[164:165], v11 offset:8736
  v_mfma_f32_16x16x32_bf16 a[8:11], a[136:139], v[108:111], a[8:11]
  ds_read_b64_tr_b16 a[166:167], v11 offset:9248
  s_mov_b32 s52, 16384
  v_mfma_f32_16x16x32_bf16 a[8:11], a[152:155], v[116:119], a[8:11]
  ds_read_b64_tr_b16 a[168:169], v10 offset:8768
  buffer_load_dwordx4 v[136:139], v13, s[12:15], s52 offen offset:0 sc1
  v_mfma_f32_16x16x32_bf16 a[12:15], a[156:159], v[116:119], a[12:15]
  ds_read_b64_tr_b16 a[170:171], v10 offset:9280
  v_mfma_f32_16x16x32_bf16 a[12:15], a[140:143], v[108:111], a[12:15]
  ds_read_b64_tr_b16 a[172:173], v11 offset:8800
  v_mfma_f32_16x16x32_bf16 a[28:31], a[140:143], v[116:119], a[28:31]
  ds_read_b64_tr_b16 a[174:175], v11 offset:9312
  v_mfma_f32_16x16x32_bf16 a[28:31], a[156:159], v[112:115], a[28:31]
  v_mfma_f32_16x16x32_bf16 a[24:27], a[152:155], v[112:115], a[24:27]
  buffer_load_dwordx4 v[140:143], v13, s[12:15], s52 offen offset:1024 sc1
  v_mfma_f32_16x16x32_bf16 a[24:27], a[136:139], v[116:119], a[24:27]
  v_mfma_f32_16x16x32_bf16 a[20:23], a[132:135], v[116:119], a[20:23]
  v_lshlrev_b32 v224, 16, v160
  v_lshlrev_b32 v225, 16, v176
  v_mfma_f32_16x16x32_bf16 a[20:23], a[148:151], v[112:115], a[20:23]
  v_and_b32 v226, 0xffff0000, v160
  v_and_b32 v227, 0xffff0000, v176
  v_mfma_f32_16x16x32_bf16 a[16:19], a[144:147], v[112:115], a[16:19]
  s_mov_b32 s52, 172032
  v_add_f32 v224, v224, v225
  v_add_f32 v226, v226, v227
  v_mfma_f32_16x16x32_bf16 a[16:19], a[128:131], v[116:119], a[16:19]
  buffer_load_dwordx4 a[240:243], v13, s[12:15], s52 offen offset:0 sc1
  v_cvt_pk_bf16_f32 v160, v224, v226
  v_mfma_f32_16x16x32_bf16 a[32:35], a[128:131], v[112:115], a[32:35]
  v_lshlrev_b32 v228, 16, v161
  v_lshlrev_b32 v229, 16, v177
  v_mfma_f32_16x16x32_bf16 a[32:35], a[144:147], v[48:51], a[32:35]
  v_and_b32 v230, 0xffff0000, v161
  v_and_b32 v231, 0xffff0000, v177
  v_mfma_f32_16x16x32_bf16 a[36:39], a[148:151], v[48:51], a[36:39]
  v_add_f32 v228, v228, v229
  v_add_f32 v230, v230, v231
  v_mfma_f32_16x16x32_bf16 a[36:39], a[132:135], v[112:115], a[36:39]
  v_cvt_pk_bf16_f32 v161, v228, v230
  v_lshlrev_b32 v224, 16, v162
  v_mfma_f32_16x16x32_bf16 a[40:43], a[136:139], v[112:115], a[40:43]
  buffer_load_dwordx4 a[244:247], v13, s[12:15], s52 offen offset:1024 sc1
  v_lshlrev_b32 v225, 16, v178
  v_mfma_f32_16x16x32_bf16 a[40:43], a[152:155], v[48:51], a[40:43]
  v_and_b32 v226, 0xffff0000, v162
  v_and_b32 v227, 0xffff0000, v178
  v_mfma_f32_16x16x32_bf16 a[44:47], a[156:159], v[48:51], a[44:47]
  v_add_f32 v224, v224, v225
  v_add_f32 v226, v226, v227
  v_mfma_f32_16x16x32_bf16 a[44:47], a[140:143], v[112:115], a[44:47]
  v_cvt_pk_bf16_f32 v162, v224, v226
  v_lshlrev_b32 v228, 16, v163
  v_mfma_f32_16x16x32_bf16 a[60:63], a[140:143], v[48:51], a[60:63]
  s_mov_b32 s52, 180224
  v_lshlrev_b32 v229, 16, v179
  v_and_b32 v230, 0xffff0000, v163
  v_mfma_f32_16x16x32_bf16 a[60:63], a[156:159], v[56:59], a[60:63]
  buffer_load_dwordx4 a[248:251], v13, s[12:15], s52 offen offset:0 sc1
  v_and_b32 v231, 0xffff0000, v179
  v_mfma_f32_16x16x32_bf16 a[56:59], a[152:155], v[56:59], a[56:59]
  ds_read_b128 v[100:103], v28 offset:37216
  v_add_f32 v228, v228, v229
  v_mfma_f32_16x16x32_bf16 a[56:59], a[136:139], v[48:51], a[56:59]
  v_add_f32 v230, v230, v231
  v_cvt_pk_bf16_f32 v163, v228, v230
  v_mfma_f32_16x16x32_bf16 a[52:55], a[132:135], v[48:51], a[52:55]
  v_mfma_f32_16x16x32_bf16 a[52:55], a[148:151], v[56:59], a[52:55]
  v_mfma_f32_16x16x32_bf16 a[48:51], a[144:147], v[56:59], a[48:51]
  buffer_store_dwordx4 v[160:163], v14, s[12:15], s60 offen offset:0 sc1
  v_mfma_f32_16x16x32_bf16 a[48:51], a[128:131], v[48:51], a[48:51]
  v_mfma_f32_16x16x32_bf16 a[64:67], a[128:131], v[56:59], a[64:67]
  v_mfma_f32_16x16x32_bf16 a[64:67], a[144:147], v[52:55], a[64:67]
  ds_read_b64_tr_b16 a[176:177], v10 offset:13056
  v_mfma_f32_16x16x32_bf16 a[68:71], a[148:151], v[52:55], a[68:71]
  ds_read_b64_tr_b16 a[178:179], v10 offset:13568
  v_mfma_f32_16x16x32_bf16 a[68:71], a[132:135], v[56:59], a[68:71]
  ds_read_b64_tr_b16 a[180:181], v11 offset:13088
  buffer_load_dwordx4 a[252:255], v13, s[12:15], s52 offen offset:1024 sc1
  v_mfma_f32_16x16x32_bf16 a[72:75], a[136:139], v[56:59], a[72:75]
  ds_read_b64_tr_b16 a[182:183], v11 offset:13600
  v_mfma_f32_16x16x32_bf16 a[72:75], a[152:155], v[52:55], a[72:75]
  ds_read_b64_tr_b16 a[184:185], v10 offset:13120
  v_mfma_f32_16x16x32_bf16 a[76:79], a[156:159], v[52:55], a[76:79]
  ds_read_b64_tr_b16 a[186:187], v10 offset:13632
  v_mfma_f32_16x16x32_bf16 a[76:79], a[140:143], v[56:59], a[76:79]
  ds_read_b64_tr_b16 a[188:189], v11 offset:13152
  s_mov_b32 s52, 24576
  v_mfma_f32_16x16x32_bf16 a[92:95], a[140:143], v[52:55], a[92:95]
  ds_read_b64_tr_b16 a[190:191], v11 offset:13664
  buffer_load_dwordx4 v[144:147], v13, s[12:15], s52 offen offset:0 sc1
  v_mfma_f32_16x16x32_bf16 a[92:95], a[156:159], v[60:63], a[92:95]
  v_mfma_f32_16x16x32_bf16 a[88:91], a[152:155], v[60:63], a[88:91]
  v_mfma_f32_16x16x32_bf16 a[88:91], a[136:139], v[52:55], a[88:91]
  v_mfma_f32_16x16x32_bf16 a[84:87], a[132:135], v[52:55], a[84:87]
  v_mfma_f32_16x16x32_bf16 a[84:87], a[148:151], v[60:63], a[84:87]
  buffer_load_dwordx4 v[148:151], v13, s[12:15], s52 offen offset:1024 sc1
  v_mfma_f32_16x16x32_bf16 a[80:83], a[144:147], v[60:63], a[80:83]
  v_mfma_f32_16x16x32_bf16 a[80:83], a[128:131], v[52:55], a[80:83]
  v_mfma_f32_16x16x32_bf16 a[96:99], a[128:131], v[60:63], a[96:99]
  s_waitcnt lgkmcnt(15)
  v_mfma_f32_16x16x32_bf16 a[96:99], a[144:147], v[68:71], a[96:99]
  s_mov_b32 s52, 73728
  v_mfma_f32_16x16x32_bf16 a[100:103], a[148:151], v[68:71], a[100:103]
  buffer_load_dwordx4 v[208:211], v13, s[12:15], s52 offen offset:0 sc1
  v_mfma_f32_16x16x32_bf16 a[100:103], a[132:135], v[60:63], a[100:103]
  ds_read_b128 v[72:75], v28 offset:37344
  v_mfma_f32_16x16x32_bf16 a[104:107], a[136:139], v[60:63], a[104:107]
  v_mfma_f32_16x16x32_bf16 a[104:107], a[152:155], v[68:71], a[104:107]
  v_mfma_f32_16x16x32_bf16 a[108:111], a[156:159], v[68:71], a[108:111]
  v_mfma_f32_16x16x32_bf16 a[108:111], a[140:143], v[60:63], a[108:111]
  buffer_load_dwordx4 v[212:215], v13, s[12:15], s52 offen offset:1024 sc1
  v_mfma_f32_16x16x32_bf16 a[124:127], a[140:143], v[68:71], a[124:127]
  v_mfma_f32_16x16x32_bf16 a[124:127], a[156:159], v[64:67], a[124:127]
  v_mfma_f32_16x16x32_bf16 a[120:123], a[152:155], v[64:67], a[120:123]
  v_mfma_f32_16x16x32_bf16 a[120:123], a[136:139], v[68:71], a[120:123]
  s_mov_b32 s52, 81920
  v_lshlrev_b32 v224, 16, v164
  v_lshlrev_b32 v225, 16, v180
  v_mfma_f32_16x16x32_bf16 a[116:119], a[132:135], v[68:71], a[116:119]
  buffer_load_dwordx4 v[216:219], v13, s[12:15], s52 offen offset:0 sc1
  v_and_b32 v226, 0xffff0000, v164
  v_mfma_f32_16x16x32_bf16 a[116:119], a[148:151], v[64:67], a[116:119]
  v_and_b32 v227, 0xffff0000, v180
  v_add_f32 v224, v224, v225
  v_mfma_f32_16x16x32_bf16 a[112:115], a[144:147], v[64:67], a[112:115]
  v_add_f32 v226, v226, v227
  v_cvt_pk_bf16_f32 v164, v224, v226
  v_mfma_f32_16x16x32_bf16 a[112:115], a[128:131], v[68:71], a[112:115]
  v_lshlrev_b32 v228, 16, v165
  v_lshlrev_b32 v229, 16, v181
  v_mfma_f32_16x16x32_bf16 a[0:3], a[160:163], v[112:115], a[0:3]
  s_waitcnt vmcnt(22) lgkmcnt(1)
  s_barrier
  v_mfma_f32_16x16x32_bf16 a[0:3], a[176:179], v[48:51], a[0:3]
  ds_read_b64_tr_b16 a[128:129], v10 offset:17408
  buffer_load_dwordx4 v[220:223], v13, s[12:15], s52 offen offset:1024 sc1
  v_mfma_f32_16x16x32_bf16 a[4:7], a[180:183], v[48:51], a[4:7]
  ds_read_b64_tr_b16 a[130:131], v10 offset:17920
  v_and_b32 v230, 0xffff0000, v165
  v_mfma_f32_16x16x32_bf16 a[4:7], a[164:167], v[112:115], a[4:7]
  ds_read_b64_tr_b16 a[132:133], v11 offset:17440
  v_and_b32 v231, 0xffff0000, v181
  v_mfma_f32_16x16x32_bf16 a[8:11], a[168:171], v[112:115], a[8:11]
  ds_read_b64_tr_b16 a[134:135], v11 offset:17952
  v_add_f32 v228, v228, v229
  v_mfma_f32_16x16x32_bf16 a[8:11], a[184:187], v[48:51], a[8:11]
  s_mov_b32 s52, 114688
  ds_read_b64_tr_b16 a[136:137], v10 offset:17472
  v_add_f32 v230, v230, v231
  v_mfma_f32_16x16x32_bf16 a[12:15], a[188:191], v[48:51], a[12:15]
  ds_read_b64_tr_b16 a[138:139], v10 offset:17984
  buffer_load_dwordx4 v[232:235], v13, s[12:15], s52 offen offset:0 sc1
  v_mfma_f32_16x16x32_bf16 a[12:15], a[172:175], v[112:115], a[12:15]
  ds_read_b64_tr_b16 a[140:141], v11 offset:17504
  v_cvt_pk_bf16_f32 v165, v228, v230
  v_mfma_f32_16x16x32_bf16 a[28:31], a[172:175], v[48:51], a[28:31]
  ds_read_b64_tr_b16 a[142:143], v11 offset:18016
  v_lshlrev_b32 v224, 16, v166
  v_mfma_f32_16x16x32_bf16 a[28:31], a[188:191], v[56:59], a[28:31]
  v_lshlrev_b32 v225, 16, v182
  v_and_b32 v226, 0xffff0000, v166
  v_mfma_f32_16x16x32_bf16 a[24:27], a[184:187], v[56:59], a[24:27]
  v_and_b32 v227, 0xffff0000, v182
  v_add_f32 v224, v224, v225
  v_mfma_f32_16x16x32_bf16 a[24:27], a[168:171], v[48:51], a[24:27]
  ds_read_b128 v[80:83], v28 offset:37472
  buffer_load_dwordx4 v[236:239], v13, s[12:15], s52 offen offset:1024 sc1
  v_mfma_f32_16x16x32_bf16 a[20:23], a[164:167], v[48:51], a[20:23]
  v_add_f32 v226, v226, v227
  v_cvt_pk_bf16_f32 v166, v224, v226
  v_mfma_f32_16x16x32_bf16 a[20:23], a[180:183], v[56:59], a[20:23]
  v_lshlrev_b32 v228, 16, v167
  v_lshlrev_b32 v229, 16, v183
  v_mfma_f32_16x16x32_bf16 a[16:19], a[176:179], v[56:59], a[16:19]
  v_and_b32 v230, 0xffff0000, v167
  v_and_b32 v231, 0xffff0000, v183
  v_mfma_f32_16x16x32_bf16 a[16:19], a[160:163], v[48:51], a[16:19]
  v_add_f32 v228, v228, v229
  v_add_f32 v230, v230, v231
  v_cvt_pk_bf16_f32 v167, v228, v230
  v_mfma_f32_16x16x32_bf16 a[32:35], a[160:163], v[56:59], a[32:35]
  buffer_store_dwordx4 v[164:167], v14, s[12:15], s60 offen offset:1024 sc1
  v_mfma_f32_16x16x32_bf16 a[32:35], a[176:179], v[52:55], a[32:35]
  v_mfma_f32_16x16x32_bf16 a[36:39], a[180:183], v[52:55], a[36:39]
  v_mfma_f32_16x16x32_bf16 a[36:39], a[164:167], v[56:59], a[36:39]
  v_mfma_f32_16x16x32_bf16 a[40:43], a[168:171], v[56:59], a[40:43]
  s_mov_b32 s52, 98304
  v_mfma_f32_16x16x32_bf16 a[40:43], a[184:187], v[52:55], a[40:43]
  buffer_load_dwordx4 v[184:187], v13, s[12:15], s52 offen offset:0 sc1
  v_mfma_f32_16x16x32_bf16 a[44:47], a[188:191], v[52:55], a[44:47]
  v_mfma_f32_16x16x32_bf16 a[44:47], a[172:175], v[56:59], a[44:47]
  v_mfma_f32_16x16x32_bf16 a[60:63], a[172:175], v[52:55], a[60:63]
  v_mfma_f32_16x16x32_bf16 a[60:63], a[188:191], v[60:63], a[60:63]
  v_mfma_f32_16x16x32_bf16 a[56:59], a[184:187], v[60:63], a[56:59]
  buffer_load_dwordx4 v[188:191], v13, s[12:15], s52 offen offset:1024 sc1
  v_mfma_f32_16x16x32_bf16 a[56:59], a[168:171], v[52:55], a[56:59]
  v_mfma_f32_16x16x32_bf16 a[52:55], a[164:167], v[52:55], a[52:55]
  v_mfma_f32_16x16x32_bf16 a[52:55], a[180:183], v[60:63], a[52:55]
  v_mfma_f32_16x16x32_bf16 a[48:51], a[176:179], v[60:63], a[48:51]
  s_mov_b32 s52, 106496
  v_mfma_f32_16x16x32_bf16 a[48:51], a[160:163], v[52:55], a[48:51]
  buffer_load_dwordx4 v[192:195], v13, s[12:15], s52 offen offset:0 sc1
  v_mfma_f32_16x16x32_bf16 a[64:67], a[160:163], v[60:63], a[64:67]
  v_mfma_f32_16x16x32_bf16 a[64:67], a[176:179], v[68:71], a[64:67]
  ds_read_b64_tr_b16 a[144:145], v10 offset:21760
  v_mfma_f32_16x16x32_bf16 a[68:71], a[180:183], v[68:71], a[68:71]
  ds_read_b64_tr_b16 a[146:147], v10 offset:22272
  v_mfma_f32_16x16x32_bf16 a[68:71], a[164:167], v[60:63], a[68:71]
  ds_read_b64_tr_b16 a[148:149], v11 offset:21792
  v_mfma_f32_16x16x32_bf16 a[72:75], a[168:171], v[60:63], a[72:75]
  ds_read_b64_tr_b16 a[150:151], v11 offset:22304
  ds_read_b128 v[76:79], v28 offset:37600
  v_mfma_f32_16x16x32_bf16 a[72:75], a[184:187], v[68:71], a[72:75]
  buffer_load_dwordx4 v[196:199], v13, s[12:15], s52 offen offset:1024 sc1
  ds_read_b64_tr_b16 a[152:153], v10 offset:21824
  v_mfma_f32_16x16x32_bf16 a[76:79], a[188:191], v[68:71], a[76:79]
  ds_read_b64_tr_b16 a[154:155], v10 offset:22336
  v_mfma_f32_16x16x32_bf16 a[76:79], a[172:175], v[60:63], a[76:79]
  ds_read_b64_tr_b16 a[156:157], v11 offset:21856
  v_mfma_f32_16x16x32_bf16 a[92:95], a[172:175], v[68:71], a[92:95]
  ds_read_b64_tr_b16 a[158:159], v11 offset:22368
  s_mov_b32 s52, 65536
  v_mfma_f32_16x16x32_bf16 a[92:95], a[188:191], v[64:67], a[92:95]
  buffer_load_dwordx4 v[200:203], v13, s[12:15], s52 offen offset:0 sc1
  v_mfma_f32_16x16x32_bf16 a[88:91], a[184:187], v[64:67], a[88:91]
  v_mfma_f32_16x16x32_bf16 a[88:91], a[168:171], v[68:71], a[88:91]
  v_mfma_f32_16x16x32_bf16 a[84:87], a[164:167], v[68:71], a[84:87]
  v_mfma_f32_16x16x32_bf16 a[84:87], a[180:183], v[64:67], a[84:87]
  v_mfma_f32_16x16x32_bf16 a[80:83], a[176:179], v[64:67], a[80:83]
  buffer_load_dwordx4 v[204:207], v13, s[12:15], s52 offen offset:1024 sc1
  v_mfma_f32_16x16x32_bf16 a[80:83], a[160:163], v[68:71], a[80:83]
  v_mfma_f32_16x16x32_bf16 a[96:99], a[160:163], v[64:67], a[96:99]
  v_mfma_f32_16x16x32_bf16 a[96:99], a[176:179], v[100:103], a[96:99]
  v_mfma_f32_16x16x32_bf16 a[100:103], a[180:183], v[100:103], a[100:103]
  s_mov_b32 s52, 32768
  v_mfma_f32_16x16x32_bf16 a[100:103], a[164:167], v[64:67], a[100:103]
  buffer_load_dwordx4 v[152:155], v13, s[12:15], s52 offen offset:0 sc1
  v_mfma_f32_16x16x32_bf16 a[104:107], a[168:171], v[64:67], a[104:107]
  v_mfma_f32_16x16x32_bf16 a[104:107], a[184:187], v[100:103], a[104:107]
  v_mfma_f32_16x16x32_bf16 a[108:111], a[188:191], v[100:103], a[108:111]
  v_mfma_f32_16x16x32_bf16 a[108:111], a[172:175], v[64:67], a[108:111]
  v_mfma_f32_16x16x32_bf16 a[124:127], a[172:175], v[100:103], a[124:127]
  buffer_load_dwordx4 v[156:159], v13, s[12:15], s52 offen offset:1024 sc1
  s_waitcnt lgkmcnt(15)
  v_mfma_f32_16x16x32_bf16 a[124:127], a[188:191], v[72:75], a[124:127]
  v_mfma_f32_16x16x32_bf16 a[120:123], a[184:187], v[72:75], a[120:123]
  v_mfma_f32_16x16x32_bf16 a[120:123], a[168:171], v[100:103], a[120:123]
  v_mfma_f32_16x16x32_bf16 a[116:119], a[164:167], v[100:103], a[116:119]
  s_mov_b32 s52, 40960
  v_mfma_f32_16x16x32_bf16 a[116:119], a[180:183], v[72:75], a[116:119]
  buffer_load_dwordx4 v[168:171], v13, s[12:15], s52 offen offset:0 sc1
  v_mfma_f32_16x16x32_bf16 a[112:115], a[176:179], v[72:75], a[112:115]
  v_mfma_f32_16x16x32_bf16 a[112:115], a[160:163], v[100:103], a[112:115]
  v_mfma_f32_16x16x32_bf16 a[0:3], a[128:131], v[56:59], a[0:3]
  s_waitcnt vmcnt(9) lgkmcnt(0)
  s_barrier
  v_mfma_f32_16x16x32_bf16 a[0:3], a[144:147], v[52:55], a[0:3]
  v_mfma_f32_16x16x32_bf16 a[4:7], a[148:151], v[52:55], a[4:7]
  buffer_store_dwordx2 v[240:241], v245, s[12:15], 0 offen offset:8 sc1
  v_mfma_f32_16x16x32_bf16 a[4:7], a[132:135], v[56:59], a[4:7]
  v_mfma_f32_16x16x32_bf16 a[8:11], a[136:139], v[56:59], a[8:11]
  v_mfma_f32_16x16x32_bf16 a[8:11], a[152:155], v[52:55], a[8:11]
  v_mfma_f32_16x16x32_bf16 a[12:15], a[156:159], v[52:55], a[12:15]
  v_mfma_f32_16x16x32_bf16 a[12:15], a[140:143], v[56:59], a[12:15]
  buffer_load_dwordx4 v[172:175], v13, s[12:15], s52 offen offset:1024 sc1
  v_mfma_f32_16x16x32_bf16 a[28:31], a[140:143], v[52:55], a[28:31]
  v_mfma_f32_16x16x32_bf16 a[28:31], a[156:159], v[60:63], a[28:31]
  v_mfma_f32_16x16x32_bf16 a[24:27], a[152:155], v[60:63], a[24:27]
  ds_read_b128 v[84:87], v9 offset:0
  v_mfma_f32_16x16x32_bf16 a[24:27], a[136:139], v[52:55], a[24:27]
  s_mov_b32 s52, 49152
  v_mfma_f32_16x16x32_bf16 a[20:23], a[132:135], v[52:55], a[20:23]
  buffer_load_dwordx4 v[160:163], v13, s[12:15], s52 offen offset:0 sc1
  v_mfma_f32_16x16x32_bf16 a[20:23], a[148:151], v[60:63], a[20:23]
  v_mfma_f32_16x16x32_bf16 a[16:19], a[144:147], v[60:63], a[16:19]
  ds_write_b128 v23, a[8:11] offset:0
  v_mfma_f32_16x16x32_bf16 a[16:19], a[128:131], v[52:55], a[16:19]
  ds_read_b128 v[92:95], v9 offset:256
  v_mfma_f32_16x16x32_bf16 a[32:35], a[128:131], v[60:63], a[32:35]
  v_mfma_f32_16x16x32_bf16 a[32:35], a[144:147], v[68:71], a[32:35]
  buffer_load_dwordx4 v[164:167], v13, s[12:15], s52 offen offset:1024 sc1
  v_mfma_f32_16x16x32_bf16 a[36:39], a[148:151], v[68:71], a[36:39]
  ds_write_b128 v23, a[12:15] offset:1024
  v_mfma_f32_16x16x32_bf16 a[36:39], a[132:135], v[60:63], a[36:39]
  v_mfma_f32_16x16x32_bf16 a[40:43], a[136:139], v[60:63], a[40:43]
  v_mfma_f32_16x16x32_bf16 a[40:43], a[152:155], v[68:71], a[40:43]
  ds_read_b128 v[88:91], v9 offset:512
  s_mov_b32 s52, 57344
  v_mfma_f32_16x16x32_bf16 a[44:47], a[156:159], v[68:71], a[44:47]
  ds_write_b128 v23, a[28:31] offset:3072
  v_mfma_f32_16x16x32_bf16 a[44:47], a[140:143], v[60:63], a[44:47]
  buffer_load_dwordx4 v[176:179], v13, s[12:15], s52 offen offset:0 sc1
  v_mfma_f32_16x16x32_bf16 a[60:63], a[140:143], v[68:71], a[60:63]
  v_mfma_f32_16x16x32_bf16 a[60:63], a[156:159], v[64:67], a[60:63]
  v_mfma_f32_16x16x32_bf16 a[56:59], a[152:155], v[64:67], a[56:59]
  ds_write_b128 v23, a[24:27] offset:2048
  v_mfma_f32_16x16x32_bf16 a[56:59], a[136:139], v[68:71], a[56:59]
  ds_read_b128 v[96:99], v9 offset:768
  buffer_load_dwordx4 v[180:183], v13, s[12:15], s52 offen offset:1024 sc1
  v_mfma_f32_16x16x32_bf16 a[52:55], a[132:135], v[68:71], a[52:55]
  v_mfma_f32_16x16x32_bf16 a[52:55], a[148:151], v[64:67], a[52:55]
  v_mfma_f32_16x16x32_bf16 a[48:51], a[144:147], v[64:67], a[48:51]
  s_add_u32 m0, s29, 35904
  ds_write_b128 v23, a[40:43] offset:4096
  v_mfma_f32_16x16x32_bf16 a[48:51], a[128:131], v[68:71], a[48:51]
  s_add_u32 s51, s49, 34816
  v_mfma_f32_16x16x32_bf16 a[64:67], a[128:131], v[64:67], a[64:67]
  buffer_load_dwordx4 v3, s[12:15], s51 offen sc1 lds
  v_mfma_f32_16x16x32_bf16 a[64:67], a[144:147], v[100:103], a[64:67]
  ds_read_b128 v[104:107], v9 offset:1024
  v_mfma_f32_16x16x32_bf16 a[68:71], a[148:151], v[100:103], a[68:71]
  ds_write_b128 v23, a[44:47] offset:5120
  v_mfma_f32_16x16x32_bf16 a[68:71], a[132:135], v[64:67], a[68:71]
  s_add_u32 m0, s29, 44224
  v_mfma_f32_16x16x32_bf16 a[72:75], a[136:139], v[64:67], a[72:75]
  s_add_u32 s51, s49, 43008
  v_mfma_f32_16x16x32_bf16 a[72:75], a[152:155], v[100:103], a[72:75]
  buffer_load_dwordx4 v3, s[12:15], s51 offen sc1 lds
  v_mfma_f32_16x16x32_bf16 a[76:79], a[156:159], v[100:103], a[76:79]
  ds_read_b128 v[108:111], v9 offset:1280
  ds_write_b128 v23, a[60:63] offset:7168
  v_mfma_f32_16x16x32_bf16 a[76:79], a[140:143], v[64:67], a[76:79]
  v_mfma_f32_16x16x32_bf16 a[92:95], a[140:143], v[100:103], a[92:95]
  s_add_u32 m0, s29, 52544
  v_mfma_f32_16x16x32_bf16 a[92:95], a[156:159], v[72:75], a[92:95]
  s_add_u32 s51, s49, 51200
  v_mfma_f32_16x16x32_bf16 a[88:91], a[152:155], v[72:75], a[88:91]
  ds_write_b128 v23, a[56:59] offset:6144
  v_mfma_f32_16x16x32_bf16 a[88:91], a[136:139], v[100:103], a[88:91]
  buffer_load_dwordx4 v3, s[12:15], s51 offen sc1 lds
  v_mfma_f32_16x16x32_bf16 a[84:87], a[132:135], v[100:103], a[84:87]
  ds_read_b128 v[116:119], v9 offset:1536
  v_mfma_f32_16x16x32_bf16 a[84:87], a[148:151], v[72:75], a[84:87]
  s_add_u32 m0, s29, 60864
  v_mfma_f32_16x16x32_bf16 a[80:83], a[144:147], v[72:75], a[80:83]
  s_add_u32 s51, s49, 59392
  ds_write_b128 v23, a[72:75] offset:8192
  v_mfma_f32_16x16x32_bf16 a[80:83], a[128:131], v[100:103], a[80:83]
  buffer_load_dwordx4 v3, s[12:15], s51 offen sc1 lds
  v_mfma_f32_16x16x32_bf16 a[96:99], a[128:131], v[72:75], a[96:99]
  ds_write_b32 v23, a76 offset:9216
  v_mfma_f32_16x16x32_bf16 a[96:99], a[144:147], v[80:83], a[96:99]
  v_mfma_f32_16x16x32_bf16 a[100:103], a[148:151], v[80:83], a[100:103]
  ds_read_b128 v[112:115], v9 offset:1792
  s_add_u32 m0, s29, 36928
  v_mfma_f32_16x16x32_bf16 a[100:103], a[132:135], v[72:75], a[100:103]
  s_add_u32 s51, s49, 35840
  v_mfma_f32_16x16x32_bf16 a[104:107], a[136:139], v[72:75], a[104:107]
  buffer_load_dwordx4 v3, s[12:15], s51 offen sc1 lds
  v_mfma_f32_16x16x32_bf16 a[104:107], a[152:155], v[80:83], a[104:107]
  ds_write_b32 v23, a77 offset:9220
  v_mfma_f32_16x16x32_bf16 a[108:111], a[156:159], v[80:83], a[108:111]
  v_mfma_f32_16x16x32_bf16 a[108:111], a[140:143], v[72:75], a[108:111]
  s_add_u32 m0, s29, 45248
  v_mfma_f32_16x16x32_bf16 a[124:127], a[140:143], v[80:83], a[124:127]
  s_add_u32 s51, s49, 44032
  v_mfma_f32_16x16x32_bf16 a[124:127], a[156:159], v[76:79], a[124:127]
  buffer_load_dwordx4 v3, s[12:15], s51 offen sc1 lds
  v_mfma_f32_16x16x32_bf16 a[120:123], a[152:155], v[76:79], a[120:123]
  ds_write_b32 v23, a78 offset:9224
  v_mfma_f32_16x16x32_bf16 a[120:123], a[136:139], v[80:83], a[120:123]
  v_mfma_f32_16x16x32_bf16 a[116:119], a[132:135], v[80:83], a[116:119]
  s_add_u32 m0, s29, 53568
  v_mfma_f32_16x16x32_bf16 a[116:119], a[148:151], v[76:79], a[116:119]
  s_add_u32 s51, s49, 52224
  v_mfma_f32_16x16x32_bf16 a[112:115], a[144:147], v[76:79], a[112:115]
  buffer_load_dwordx4 v3, s[12:15], s51 offen sc1 lds
  v_mfma_f32_16x16x32_bf16 a[112:115], a[128:131], v[80:83], a[112:115]
  s_waitcnt lgkmcnt(14)
  ds_write_b32 v23, a79 offset:9228
  v_mfma_f32_16x16x32_bf16 a[128:131], v[120:123], v[84:87], 0
  v_mfma_f32_16x16x32_bf16 a[128:131], v[128:131], v[92:95], a[128:131]
  ds_read_b128 v[48:51], v9 offset:2080
  s_add_u32 m0, s29, 61888
  v_mfma_f32_16x16x32_bf16 a[132:135], v[132:135], v[92:95], 0
  s_add_u32 s51, s49, 60416
  v_mfma_f32_16x16x32_bf16 a[132:135], v[124:127], v[84:87], a[132:135]
  buffer_load_dwordx4 v3, s[12:15], s51 offen sc1 lds
  v_mfma_f32_16x16x32_bf16 a[140:143], v[124:127], v[92:95], 0
  ds_write_b32 v23, a92 offset:11264
  v_mfma_f32_16x16x32_bf16 a[140:143], v[132:135], v[88:91], a[140:143]
  v_mfma_f32_16x16x32_bf16 a[136:139], v[128:131], v[88:91], 0
  s_mov_b32 m0, s31
  v_mfma_f32_16x16x32_bf16 a[136:139], v[120:123], v[92:95], a[136:139]
  s_add_u32 s51, s49, 67584
  v_mfma_f32_16x16x32_bf16 a[144:147], v[120:123], v[88:91], 0
  buffer_load_dwordx4 v4, s[12:15], s51 offen sc1 lds
  s_waitcnt lgkmcnt(15)
  v_mfma_f32_16x16x32_bf16 a[144:147], v[128:131], v[96:99], a[144:147]
  ds_write_b32 v23, a93 offset:11268
  v_mfma_f32_16x16x32_bf16 a[148:151], v[132:135], v[96:99], 0
  v_mfma_f32_16x16x32_bf16 a[148:151], v[124:127], v[88:91], a[148:151]
  ds_write_b32 v23, a94 offset:11272
  v_mfma_f32_16x16x32_bf16 a[156:159], v[124:127], v[96:99], 0
  s_mov_b32 s52, 90112
  s_waitcnt lgkmcnt(15)
  v_mfma_f32_16x16x32_bf16 a[156:159], v[132:135], v[104:107], a[156:159]
  ds_read_b128 v[56:59], v9 offset:2336
  buffer_load_dwordx4 v[224:227], v13, s[12:15], s52 offen offset:0 sc1
  v_mfma_f32_16x16x32_bf16 a[152:155], v[128:131], v[104:107], 0
  ds_write_b32 v23, a95 offset:11276
  v_mfma_f32_16x16x32_bf16 a[152:155], v[120:123], v[96:99], a[152:155]
  v_mfma_f32_16x16x32_bf16 a[160:163], v[120:123], v[104:107], 0
  s_waitcnt lgkmcnt(14)
  ds_write_b32 v23, a88 offset:10240
  v_mfma_f32_16x16x32_bf16 a[160:163], v[128:131], v[108:111], a[160:163]
  v_mfma_f32_16x16x32_bf16 a[164:167], v[132:135], v[108:111], 0
  buffer_load_dwordx4 v[228:231], v13, s[12:15], s52 offen offset:1024 sc1
  v_mfma_f32_16x16x32_bf16 a[164:167], v[124:127], v[104:107], a[164:167]
  ds_write_b32 v23, a89 offset:10244
  v_mfma_f32_16x16x32_bf16 a[172:175], v[124:127], v[108:111], 0
  s_waitcnt lgkmcnt(14)
  v_mfma_f32_16x16x32_bf16 a[172:175], v[132:135], v[116:119], a[172:175]
  ds_write_b32 v23, a90 offset:10248
  v_mfma_f32_16x16x32_bf16 a[168:171], v[128:131], v[116:119], 0
  v_mfma_f32_16x16x32_bf16 a[168:171], v[120:123], v[108:111], a[168:171]
  ds_write_b32 v23, a91 offset:10252
  v_mfma_f32_16x16x32_bf16 a[176:179], v[120:123], v[116:119], 0
  s_waitcnt lgkmcnt(13)
  v_mfma_f32_16x16x32_bf16 a[176:179], v[128:131], v[112:115], a[176:179]
  ds_read_b128 v[52:55], v9 offset:2592
  v_mfma_f32_16x16x32_bf16 a[180:183], v[132:135], v[112:115], 0
  ds_write_b32 v23, a104 offset:12288
  v_mfma_f32_16x16x32_bf16 a[180:183], v[124:127], v[116:119], a[180:183]
  v_mfma_f32_16x16x32_bf16 a[188:191], v[124:127], v[112:115], 0
  s_waitcnt lgkmcnt(11)
  ds_write_b32 v23, a105 offset:12292
  v_mfma_f32_16x16x32_bf16 a[188:191], v[132:135], v[48:51], a[188:191]
  v_mfma_f32_16x16x32_bf16 a[184:187], v[128:131], v[48:51], 0
  ds_write_b32 v23, a106 offset:12296
  v_mfma_f32_16x16x32_bf16 a[184:187], v[120:123], v[112:115], a[184:187]
  v_mfma_f32_16x16x32_bf16 a[128:131], v[136:139], v[88:91], a[128:131]
  ds_write_b32 v23, a107 offset:12300
  v_mfma_f32_16x16x32_bf16 a[128:131], v[144:147], v[96:99], a[128:131]
  v_mfma_f32_16x16x32_bf16 a[132:135], v[148:151], v[96:99], a[132:135]
  ds_write_b32 v23, a108 offset:13312
  v_mfma_f32_16x16x32_bf16 a[132:135], v[140:143], v[88:91], a[132:135]
  v_mfma_f32_16x16x32_bf16 a[140:143], v[140:143], v[96:99], a[140:143]
  ds_write_b32 v23, a109 offset:13316
  v_mfma_f32_16x16x32_bf16 a[140:143], v[148:151], v[104:107], a[140:143]
  ds_read_b128 v[60:63], v9 offset:2848
  v_mfma_f32_16x16x32_bf16 a[136:139], v[144:147], v[104:107], a[136:139]
  ds_write_b32 v23, a110 offset:13320
  v_mfma_f32_16x16x32_bf16 a[136:139], v[136:139], v[96:99], a[136:139]
  v_mfma_f32_16x16x32_bf16 a[144:147], v[136:139], v[104:107], a[144:147]
  ds_write_b32 v23, a111 offset:13324
  v_mfma_f32_16x16x32_bf16 a[144:147], v[144:147], v[108:111], a[144:147]
  v_mfma_f32_16x16x32_bf16 a[148:151], v[148:151], v[108:111], a[148:151]
  ds_write_b32 v23, a124 offset:15360
  v_mfma_f32_16x16x32_bf16 a[148:151], v[140:143], v[104:107], a[148:151]
  v_mfma_f32_16x16x32_bf16 a[156:159], v[140:143], v[108:111], a[156:159]
  ds_write_b32 v23, a125 offset:15364
  v_mfma_f32_16x16x32_bf16 a[156:159], v[148:151], v[116:119], a[156:159]
  v_mfma_f32_16x16x32_bf16 a[152:155], v[144:147], v[116:119], a[152:155]
  ds_write_b32 v23, a126 offset:15368
  v_mfma_f32_16x16x32_bf16 a[152:155], v[136:139], v[108:111], a[152:155]
  v_mfma_f32_16x16x32_bf16 a[160:163], v[136:139], v[116:119], a[160:163]
  ds_write_b32 v23, a127 offset:15372
  v_mfma_f32_16x16x32_bf16 a[160:163], v[144:147], v[112:115], a[160:163]
  ds_read_b128 v[68:71], v9 offset:3104
  v_mfma_f32_16x16x32_bf16 a[164:167], v[148:151], v[112:115], a[164:167]
  ds_write_b32 v23, a120 offset:14336
  v_mfma_f32_16x16x32_bf16 a[164:167], v[140:143], v[116:119], a[164:167]
  v_mfma_f32_16x16x32_bf16 a[172:175], v[140:143], v[112:115], a[172:175]
  ds_write_b32 v23, a121 offset:14340
  v_mfma_f32_16x16x32_bf16 a[172:175], v[148:151], v[48:51], a[172:175]
  v_mfma_f32_16x16x32_bf16 a[168:171], v[144:147], v[48:51], a[168:171]
  ds_write_b32 v23, a122 offset:14344
  v_mfma_f32_16x16x32_bf16 a[168:171], v[136:139], v[112:115], a[168:171]
  v_mfma_f32_16x16x32_bf16 a[176:179], v[136:139], v[48:51], a[176:179]
  s_waitcnt lgkmcnt(14)
  ds_write_b32 v23, a123 offset:14348
  v_mfma_f32_16x16x32_bf16 a[176:179], v[144:147], v[56:59], a[176:179]
  v_mfma_f32_16x16x32_bf16 a[180:183], v[148:151], v[56:59], a[180:183]
  v_mfma_f32_16x16x32_bf16 a[180:183], v[140:143], v[48:51], a[180:183]
  v_mfma_f32_16x16x32_bf16 a[188:191], v[140:143], v[56:59], a[188:191]
  v_mfma_f32_16x16x32_bf16 a[188:191], v[148:151], v[52:55], a[188:191]
  ds_read_b128 v[64:67], v9 offset:3360
  v_mfma_f32_16x16x32_bf16 a[184:187], v[144:147], v[52:55], a[184:187]
  v_mfma_f32_16x16x32_bf16 a[184:187], v[136:139], v[56:59], a[184:187]
  s_waitcnt vmcnt(19)
  v_mfma_f32_16x16x32_bf16 a[128:131], v[152:155], v[104:107], a[128:131]
  s_waitcnt vmcnt(17)
  v_mfma_f32_16x16x32_bf16 a[128:131], v[168:171], v[108:111], a[128:131]
  s_waitcnt vmcnt(15)
  v_mfma_f32_16x16x32_bf16 a[132:135], v[172:175], v[108:111], a[132:135]
  v_mfma_f32_16x16x32_bf16 a[132:135], v[156:159], v[104:107], a[132:135]
  v_mfma_f32_16x16x32_bf16 a[140:143], v[156:159], v[108:111], a[140:143]
  v_mfma_f32_16x16x32_bf16 a[140:143], v[172:175], v[116:119], a[140:143]
  v_mfma_f32_16x16x32_bf16 a[136:139], v[168:171], v[116:119], a[136:139]
  v_mfma_f32_16x16x32_bf16 a[136:139], v[152:155], v[108:111], a[136:139]
  v_mfma_f32_16x16x32_bf16 a[144:147], v[152:155], v[116:119], a[144:147]
  v_mfma_f32_16x16x32_bf16 a[144:147], v[168:171], v[112:115], a[144:147]
  ds_read_b128 v[100:103], v9 offset:3616
  v_mfma_f32_16x16x32_bf16 a[148:151], v[172:175], v[112:115], a[148:151]
  v_mfma_f32_16x16x32_bf16 a[148:151], v[156:159], v[116:119], a[148:151]
  v_mfma_f32_16x16x32_bf16 a[156:159], v[156:159], v[112:115], a[156:159]
  v_mfma_f32_16x16x32_bf16 a[156:159], v[172:175], v[48:51], a[156:159]
  v_mfma_f32_16x16x32_bf16 a[152:155], v[168:171], v[48:51], a[152:155]
  v_mfma_f32_16x16x32_bf16 a[152:155], v[152:155], v[112:115], a[152:155]
  v_mfma_f32_16x16x32_bf16 a[160:163], v[152:155], v[48:51], a[160:163]
  v_mfma_f32_16x16x32_bf16 a[160:163], v[168:171], v[56:59], a[160:163]
  v_mfma_f32_16x16x32_bf16 a[164:167], v[172:175], v[56:59], a[164:167]
  v_mfma_f32_16x16x32_bf16 a[164:167], v[156:159], v[48:51], a[164:167]
  v_mfma_f32_16x16x32_bf16 a[172:175], v[156:159], v[56:59], a[172:175]
  v_mfma_f32_16x16x32_bf16 a[172:175], v[172:175], v[52:55], a[172:175]
  v_mfma_f32_16x16x32_bf16 a[168:171], v[168:171], v[52:55], a[168:171]
  v_mfma_f32_16x16x32_bf16 a[168:171], v[152:155], v[56:59], a[168:171]
  v_mfma_f32_16x16x32_bf16 a[176:179], v[152:155], v[52:55], a[176:179]
  s_waitcnt lgkmcnt(13)
  v_mfma_f32_16x16x32_bf16 a[176:179], v[168:171], v[60:63], a[176:179]
  v_mfma_f32_16x16x32_bf16 a[180:183], v[172:175], v[60:63], a[180:183]
  v_mfma_f32_16x16x32_bf16 a[180:183], v[156:159], v[52:55], a[180:183]
  v_mfma_f32_16x16x32_bf16 a[188:191], v[156:159], v[60:63], a[188:191]
  s_waitcnt lgkmcnt(2)
  s_barrier
  v_mfma_f32_16x16x32_bf16 a[188:191], v[172:175], v[68:71], a[188:191]
  ds_read_b128 v[120:123], v21 offset:0
  s_mov_b32 s52, 188416
  v_mfma_f32_16x16x32_bf16 a[184:187], v[168:171], v[68:71], a[184:187]
  buffer_load_dwordx4 a[8:11], v13, s[12:15], s52 offen offset:0 sc1
  v_mfma_f32_16x16x32_bf16 a[184:187], v[152:155], v[60:63], a[184:187]
  s_waitcnt vmcnt(15)
  v_mfma_f32_16x16x32_bf16 a[128:131], v[160:163], v[116:119], a[128:131]
  s_waitcnt vmcnt(3) lgkmcnt(1)
  s_barrier
  ds_read_b128 v[136:139], v21 offset:21760
  v_mfma_f32_16x16x32_bf16 a[128:131], v[176:179], v[112:115], a[128:131]
  ds_read_b128 v[72:75], v9 offset:35904
  s_add_u32 m0, s29, 0
  v_mfma_f32_16x16x32_bf16 a[132:135], v[180:183], v[112:115], a[132:135]
  ds_read_b128 v[76:79], v9 offset:36160
  s_add_u32 s51, s49, 69632
  v_mfma_f32_16x16x32_bf16 a[132:135], v[164:167], v[116:119], a[132:135]
  ds_read_b128 v[124:127], v21 offset:1024
  buffer_load_dwordx4 v3, s[12:15], s51 offen sc1 lds
  v_mfma_f32_16x16x32_bf16 a[140:143], v[164:167], v[112:115], a[140:143]
  ds_read_b128 v[80:83], v9 offset:36416
  v_mfma_f32_16x16x32_bf16 a[140:143], v[180:183], v[48:51], a[140:143]
  v_mfma_f32_16x16x32_bf16 a[136:139], v[176:179], v[48:51], a[136:139]
  s_add_u32 m0, s29, 8320
  ds_read_b128 v[84:87], v9 offset:36672
  ds_read_b128 v[140:143], v21 offset:22784
  v_mfma_f32_16x16x32_bf16 a[136:139], v[160:163], v[112:115], a[136:139]
  s_add_u32 s51, s49, 77824
  v_mfma_f32_16x16x32_bf16 a[144:147], v[160:163], v[48:51], a[144:147]
  ds_read_b128 v[92:95], v9 offset:36928
  buffer_load_dwordx4 v3, s[12:15], s51 offen sc1 lds
  v_mfma_f32_16x16x32_bf16 a[144:147], v[176:179], v[56:59], a[144:147]
  ds_read_b128 v[88:91], v9 offset:37184
  ds_read_b128 v[128:131], v21 offset:2048
  v_mfma_f32_16x16x32_bf16 a[148:151], v[180:183], v[56:59], a[148:151]
  v_mfma_f32_16x16x32_bf16 a[148:151], v[164:167], v[48:51], a[148:151]
  ds_read_b128 v[96:99], v9 offset:37440
  s_add_u32 m0, s29, 16640
  v_mfma_f32_16x16x32_bf16 a[156:159], v[164:167], v[56:59], a[156:159]
  ds_read_b128 v[144:147], v21 offset:23808
  s_add_u32 s51, s49, 86016
  v_mfma_f32_16x16x32_bf16 a[156:159], v[180:183], v[52:55], a[156:159]
  ds_read_b128 v[104:107], v9 offset:37696
  buffer_load_dwordx4 v3, s[12:15], s51 offen sc1 lds
  v_mfma_f32_16x16x32_bf16 a[152:155], v[176:179], v[52:55], a[152:155]
  v_mfma_f32_16x16x32_bf16 a[152:155], v[160:163], v[56:59], a[152:155]
  ds_read_b128 v[132:135], v21 offset:3072
  v_mfma_f32_16x16x32_bf16 a[160:163], v[160:163], v[52:55], a[160:163]
  s_add_u32 m0, s29, 24960
  v_mfma_f32_16x16x32_bf16 a[160:163], v[176:179], v[60:63], a[160:163]
  s_add_u32 s51, s49, 94208
  v_mfma_f32_16x16x32_bf16 a[164:167], v[180:183], v[60:63], a[164:167]
  ds_read_b128 v[148:151], v21 offset:24832
  buffer_load_dwordx4 v3, s[12:15], s51 offen sc1 lds
  v_mfma_f32_16x16x32_bf16 a[164:167], v[164:167], v[52:55], a[164:167]
  v_mfma_f32_16x16x32_bf16 a[172:175], v[164:167], v[60:63], a[172:175]
  v_mfma_f32_16x16x32_bf16 a[172:175], v[180:183], v[68:71], a[172:175]
  ds_read_b128 v[152:155], v22 offset:0
  v_mfma_f32_16x16x32_bf16 a[168:171], v[176:179], v[68:71], a[168:171]
  v_mfma_f32_16x16x32_bf16 a[168:171], v[160:163], v[60:63], a[168:171]
  buffer_load_dwordx2 v[250:251], v20, s[12:15], 0 offen offset:8 sc1
  v_mfma_f32_16x16x32_bf16 a[176:179], v[160:163], v[68:71], a[176:179]
  ds_read_b128 v[168:171], v22 offset:21760
  v_mfma_f32_16x16x32_bf16 a[176:179], v[176:179], v[64:67], a[176:179]
  v_mfma_f32_16x16x32_bf16 a[180:183], v[180:183], v[64:67], a[180:183]
  s_add_u32 m0, s29, 1024
  v_mfma_f32_16x16x32_bf16 a[180:183], v[164:167], v[68:71], a[180:183]
  ds_read_b128 v[156:159], v22 offset:1024
  s_add_u32 s51, s49, 70656
  v_mfma_f32_16x16x32_bf16 a[188:191], v[164:167], v[64:67], a[188:191]
  s_waitcnt lgkmcnt(15)
  buffer_load_dwordx4 v3, s[12:15], s51 offen sc1 lds
  v_mfma_f32_16x16x32_bf16 a[188:191], v[180:183], v[100:103], a[188:191]
  v_add_f32 v120, v120, v136
  v_add_f32 v121, v121, v137
  v_mfma_f32_16x16x32_bf16 a[184:187], v[176:179], v[100:103], a[184:187]
  ds_read_b128 v[172:175], v22 offset:22784
  v_add_f32 v122, v122, v138
  v_mfma_f32_16x16x32_bf16 a[184:187], v[160:163], v[64:67], a[184:187]
  s_add_u32 m0, s29, 9344
  v_add_f32 v123, v123, v139
  v_mfma_f32_16x16x32_bf16 a[128:131], v[200:203], v[72:75], a[128:131]
  s_waitcnt lgkmcnt(15)
  s_waitcnt lgkmcnt(12)
  s_add_u32 s51, s49, 78848
  v_mfma_f32_16x16x32_bf16 a[128:131], v[208:211], v[76:79], a[128:131]
  ds_read_b128 v[108:111], v9 offset:37984
  ds_read_b128 v[160:163], v22 offset:2048
  v_mfma_f32_16x16x32_bf16 a[132:135], v[212:215], v[76:79], a[132:135]
  buffer_load_dwordx4 v3, s[12:15], s51 offen sc1 lds
  v_add_f32 v124, v124, v140
  v_mfma_f32_16x16x32_bf16 a[132:135], v[204:207], v[72:75], a[132:135]
  v_add_f32 v125, v125, v141
  v_add_f32 v126, v126, v142
  v_mfma_f32_16x16x32_bf16 a[140:143], v[204:207], v[76:79], a[140:143]
  s_add_u32 m0, s29, 17664
  ds_read_b128 v[176:179], v22 offset:23808
  v_add_f32 v127, v127, v143
  v_mfma_f32_16x16x32_bf16 a[140:143], v[212:215], v[80:83], a[140:143]
  s_add_u32 s51, s49, 87040
  v_cvt_pk_bf16_f32 v120, v120, v121
  v_mfma_f32_16x16x32_bf16 a[136:139], v[208:211], v[80:83], a[136:139]
  buffer_load_dwordx4 v3, s[12:15], s51 offen sc1 lds
  v_cvt_pk_bf16_f32 v121, v122, v123
  v_mfma_f32_16x16x32_bf16 a[136:139], v[200:203], v[76:79], a[136:139]
  ds_read_b128 v[164:167], v22 offset:3072
  v_cvt_pk_bf16_f32 v122, v124, v125
  v_mfma_f32_16x16x32_bf16 a[144:147], v[200:203], v[80:83], a[144:147]
  v_cvt_pk_bf16_f32 v123, v126, v127
  v_mfma_f32_16x16x32_bf16 a[144:147], v[208:211], v[84:87], a[144:147]
  s_waitcnt lgkmcnt(13)
  s_waitcnt lgkmcnt(11)
  v_add_f32 v128, v128, v144
  v_mfma_f32_16x16x32_bf16 a[148:151], v[212:215], v[84:87], a[148:151]
  s_mul_i32 s74, s2, 24576
  ds_read_b128 v[180:183], v22 offset:24832
  v_add_f32 v129, v129, v145
  v_mfma_f32_16x16x32_bf16 a[148:151], v[204:207], v[80:83], a[148:151]
  buffer_store_dwordx4 v[120:123], v24, s[12:15], s74 offen offset:0 sc1
  v_add_f32 v130, v130, v146
  v_mfma_f32_16x16x32_bf16 a[156:159], v[204:207], v[84:87], a[156:159]
  v_add_f32 v131, v131, v147
  v_mfma_f32_16x16x32_bf16 a[156:159], v[212:215], v[92:95], a[156:159]
  s_waitcnt lgkmcnt(10)
  ds_read_b128 v[116:119], v9 offset:38240
  s_waitcnt lgkmcnt(10)
  v_mfma_f32_16x16x32_bf16 a[152:155], v[208:211], v[92:95], a[152:155]
  s_add_u32 m0, s29, 25984
  v_add_f32 v132, v132, v148
  v_add_f32 v133, v133, v149
  v_mfma_f32_16x16x32_bf16 a[152:155], v[200:203], v[84:87], a[152:155]
  s_add_u32 s51, s49, 95232
  v_add_f32 v134, v134, v150
  v_mfma_f32_16x16x32_bf16 a[160:163], v[200:203], v[92:95], a[160:163]
  buffer_load_dwordx4 v3, s[12:15], s51 offen sc1 lds
  v_add_f32 v135, v135, v151
  v_mfma_f32_16x16x32_bf16 a[160:163], v[208:211], v[88:91], a[160:163]
  v_cvt_pk_bf16_f32 v128, v128, v129
  v_mfma_f32_16x16x32_bf16 a[164:167], v[212:215], v[88:91], a[164:167]
  s_waitcnt lgkmcnt(1)
  s_barrier
  v_mfma_f32_16x16x32_bf16 a[164:167], v[204:207], v[92:95], a[164:167]
  v_cvt_pk_bf16_f32 v129, v130, v131
  v_cvt_pk_bf16_f32 v130, v132, v133
  v_mfma_f32_16x16x32_bf16 a[172:175], v[204:207], v[88:91], a[172:175]
  ds_write_b128 v23, a[0:3] offset:0
  v_cvt_pk_bf16_f32 v131, v134, v135
  v_mfma_f32_16x16x32_bf16 a[172:175], v[212:215], v[96:99], a[172:175]
  buffer_store_dwordx4 v[128:131], v24, s[12:15], s74 offen offset:1024 sc1
  v_add_f32 v152, v152, v168
  v_mfma_f32_16x16x32_bf16 a[168:171], v[208:211], v[96:99], a[168:171]
  v_add_f32 v153, v153, v169
  v_mfma_f32_16x16x32_bf16 a[168:171], v[200:203], v[88:91], a[168:171]
  v_add_f32 v154, v154, v170
  v_mfma_f32_16x16x32_bf16 a[176:179], v[200:203], v[96:99], a[176:179]
  s_mov_b32 m0, s30
  ds_write_b128 v23, a[4:7] offset:1024
  v_mfma_f32_16x16x32_bf16 a[176:179], v[208:211], v[104:107], a[176:179]
  s_add_u32 s51, s49, 102400
  ds_read_b128 v[112:115], v9 offset:38496
  v_add_f32 v155, v155, v171
  v_mfma_f32_16x16x32_bf16 a[180:183], v[212:215], v[104:107], a[180:183]
  buffer_load_dwordx4 v4, s[12:15], s51 offen sc1 lds
  v_add_f32 v156, v156, v172
  v_mfma_f32_16x16x32_bf16 a[180:183], v[204:207], v[96:99], a[180:183]
  v_add_f32 v157, v157, v173
  v_add_f32 v158, v158, v174
  v_mfma_f32_16x16x32_bf16 a[188:191], v[204:207], v[104:107], a[188:191]
  ds_write_b128 v23, a[16:19] offset:2048
  v_mfma_f32_16x16x32_bf16 a[188:191], v[212:215], v[108:111], a[188:191]
  v_add_f32 v159, v159, v175
  v_cvt_pk_bf16_f32 v152, v152, v153
  v_mfma_f32_16x16x32_bf16 a[184:187], v[208:211], v[108:111], a[184:187]
  v_cvt_pk_bf16_f32 v153, v154, v155
  v_mfma_f32_16x16x32_bf16 a[184:187], v[200:203], v[104:107], a[184:187]
  buffer_load_dwordx4 a[12:15], v13, s[12:15], s52 offen offset:1024 sc1
  v_cvt_pk_bf16_f32 v154, v156, v157
  v_mfma_f32_16x16x32_bf16 a[128:131], v[216:219], v[80:83], a[128:131]
  s_waitcnt vmcnt(15)
  ds_write_b128 v23, a[20:23] offset:3072
  v_mfma_f32_16x16x32_bf16 a[128:131], v[224:227], v[84:87], a[128:131]
  s_waitcnt vmcnt(14)
  v_cvt_pk_bf16_f32 v155, v158, v159
  v_add_f32 v160, v160, v176
  v_mfma_f32_16x16x32_bf16 a[132:135], v[228:231], v[84:87], a[132:135]
  v_add_f32 v161, v161, v177
  v_mfma_f32_16x16x32_bf16 a[132:135], v[220:223], v[80:83], a[132:135]
  v_add_f32 v162, v162, v178
  v_mfma_f32_16x16x32_bf16 a[140:143], v[220:223], v[84:87], a[140:143]
  ds_write_b128 v23, a[32:35] offset:4096
  buffer_store_dwordx4 v[152:155], v24, s[12:15], s74 offen offset:2048 sc1
  v_add_f32 v163, v163, v179
  v_mfma_f32_16x16x32_bf16 a[140:143], v[228:231], v[92:95], a[140:143]
  ds_read_b128 v[48:51], v9 offset:38752
  v_add_f32 v164, v164, v180
  v_mfma_f32_16x16x32_bf16 a[136:139], v[224:227], v[92:95], a[136:139]
  v_add_f32 v165, v165, v181
  v_mfma_f32_16x16x32_bf16 a[136:139], v[216:219], v[84:87], a[136:139]
  v_add_f32 v166, v166, v182
  v_mfma_f32_16x16x32_bf16 a[144:147], v[216:219], v[92:95], a[144:147]
  s_mov_b32 s52, 196608
  ds_write_b128 v23, a[36:39] offset:5120
  v_mfma_f32_16x16x32_bf16 a[144:147], v[224:227], v[88:91], a[144:147]
  buffer_load_dwordx4 a[24:27], v13, s[12:15], s52 offen offset:0 sc1
  v_add_f32 v167, v167, v183
  v_mfma_f32_16x16x32_bf16 a[148:151], v[228:231], v[88:91], a[148:151]
  v_cvt_pk_bf16_f32 v160, v160, v161
  v_cvt_pk_bf16_f32 v161, v162, v163
  v_mfma_f32_16x16x32_bf16 a[148:151], v[220:223], v[92:95], a[148:151]
  v_cvt_pk_bf16_f32 v162, v164, v165
  v_mfma_f32_16x16x32_bf16 a[156:159], v[220:223], v[88:91], a[156:159]
  ds_write_b128 v23, a[48:51] offset:6144
  v_mfma_f32_16x16x32_bf16 a[156:159], v[228:231], v[96:99], a[156:159]
  v_cvt_pk_bf16_f32 v163, v166, v167
  v_mfma_f32_16x16x32_bf16 a[152:155], v[224:227], v[96:99], a[152:155]
  buffer_store_dwordx4 v[160:163], v24, s[12:15], s74 offen offset:3072 sc1
  v_mfma_f32_16x16x32_bf16 a[152:155], v[216:219], v[88:91], a[152:155]
  v_mfma_f32_16x16x32_bf16 a[160:163], v[216:219], v[96:99], a[160:163]
  ds_write_b128 v23, a[52:55] offset:7168
  v_mfma_f32_16x16x32_bf16 a[160:163], v[224:227], v[104:107], a[160:163]
  ds_read_b128 v[56:59], v9 offset:39008
  v_mfma_f32_16x16x32_bf16 a[164:167], v[228:231], v[104:107], a[164:167]
  v_mfma_f32_16x16x32_bf16 a[164:167], v[220:223], v[96:99], a[164:167]
  buffer_load_dwordx4 a[28:31], v13, s[12:15], s52 offen offset:1024 sc1
  v_mfma_f32_16x16x32_bf16 a[172:175], v[220:223], v[104:107], a[172:175]
  ds_write_b128 v23, a[64:67] offset:8192
  v_mfma_f32_16x16x32_bf16 a[172:175], v[228:231], v[108:111], a[172:175]
  v_mfma_f32_16x16x32_bf16 a[168:171], v[224:227], v[108:111], a[168:171]
  v_mfma_f32_16x16x32_bf16 a[168:171], v[216:219], v[104:107], a[168:171]
  s_mov_b32 s52, 204800
  v_mfma_f32_16x16x32_bf16 a[176:179], v[216:219], v[108:111], a[176:179]
  ds_write_b128 v23, a[68:71] offset:9216
  buffer_load_dwordx4 a[40:43], v13, s[12:15], s52 offen offset:0 sc1
  s_waitcnt lgkmcnt(13)
  v_mfma_f32_16x16x32_bf16 a[176:179], v[224:227], v[116:119], a[176:179]
  v_mfma_f32_16x16x32_bf16 a[180:183], v[228:231], v[116:119], a[180:183]
  v_mfma_f32_16x16x32_bf16 a[180:183], v[220:223], v[108:111], a[180:183]
  v_mfma_f32_16x16x32_bf16 a[188:191], v[220:223], v[116:119], a[188:191]
  s_waitcnt lgkmcnt(10)
  ds_write_b128 v23, a[80:83] offset:10240
  v_mfma_f32_16x16x32_bf16 a[188:191], v[228:231], v[112:115], a[188:191]
  ds_read_b128 v[52:55], v9 offset:39264
  buffer_load_dwordx4 a[44:47], v13, s[12:15], s52 offen offset:1024 sc1
  v_mfma_f32_16x16x32_bf16 a[184:187], v[224:227], v[112:115], a[184:187]
  v_mfma_f32_16x16x32_bf16 a[184:187], v[216:219], v[116:119], a[184:187]
  v_mfma_f32_16x16x32_bf16 a[128:131], v[184:187], v[92:95], a[128:131]
  ds_write_b128 v23, a[84:87] offset:11264
  v_mfma_f32_16x16x32_bf16 a[128:131], v[192:195], v[88:91], a[128:131]
  s_mov_b32 s52, 212992
  v_mfma_f32_16x16x32_bf16 a[132:135], v[196:199], v[88:91], a[132:135]
  buffer_load_dwordx4 a[56:59], v13, s[12:15], s52 offen offset:0 sc1
  v_mfma_f32_16x16x32_bf16 a[132:135], v[188:191], v[92:95], a[132:135]
  v_mfma_f32_16x16x32_bf16 a[140:143], v[188:191], v[88:91], a[140:143]
  ds_write_b128 v23, a[96:99] offset:12288
  v_mfma_f32_16x16x32_bf16 a[140:143], v[196:199], v[96:99], a[140:143]
  v_mfma_f32_16x16x32_bf16 a[136:139], v[192:195], v[96:99], a[136:139]
  v_mfma_f32_16x16x32_bf16 a[136:139], v[184:187], v[88:91], a[136:139]
  buffer_load_dwordx4 a[60:63], v13, s[12:15], s52 offen offset:1024 sc1
  v_mfma_f32_16x16x32_bf16 a[144:147], v[184:187], v[96:99], a[144:147]
  ds_write_b128 v23, a[100:103] offset:13312
  v_mfma_f32_16x16x32_bf16 a[144:147], v[192:195], v[104:107], a[144:147]
  ds_read_b128 v[60:63], v9 offset:39520
  v_mfma_f32_16x16x32_bf16 a[148:151], v[196:199], v[104:107], a[148:151]
  v_mfma_f32_16x16x32_bf16 a[148:151], v[188:191], v[96:99], a[148:151]
  s_mov_b32 s52, 221184
  v_mfma_f32_16x16x32_bf16 a[156:159], v[188:191], v[104:107], a[156:159]
  ds_write_b128 v23, a[112:115] offset:14336
  v_mfma_f32_16x16x32_bf16 a[156:159], v[196:199], v[108:111], a[156:159]
  buffer_load_dwordx4 a[72:75], v13, s[12:15], s52 offen offset:0 sc1
  v_mfma_f32_16x16x32_bf16 a[152:155], v[192:195], v[108:111], a[152:155]
  v_mfma_f32_16x16x32_bf16 a[152:155], v[184:187], v[104:107], a[152:155]
  v_mfma_f32_16x16x32_bf16 a[160:163], v[184:187], v[108:111], a[160:163]
  ds_write_b128 v23, a[116:119] offset:15360
  v_mfma_f32_16x16x32_bf16 a[160:163], v[192:195], v[116:119], a[160:163]
  buffer_load_dwordx4 a[76:79], v13, s[12:15], s52 offen offset:1024 sc1
  v_mfma_f32_16x16x32_bf16 a[164:167], v[196:199], v[116:119], a[164:167]
  v_mfma_f32_16x16x32_bf16 a[164:167], v[188:191], v[108:111], a[164:167]
  v_mfma_f32_16x16x32_bf16 a[172:175], v[188:191], v[116:119], a[172:175]
  v_mfma_f32_16x16x32_bf16 a[172:175], v[196:199], v[112:115], a[172:175]
  s_mov_b32 s52, 229376
  v_mfma_f32_16x16x32_bf16 a[168:171], v[192:195], v[112:115], a[168:171]
  s_waitcnt vmcnt(18)
  v_cmp_ne_u64 vcc, s[26:27], v[250:251]
  v_mfma_f32_16x16x32_bf16 a[168:171], v[184:187], v[116:119], a[168:171]
  buffer_load_dwordx4 a[88:91], v13, s[12:15], s52 offen offset:0 sc1
  v_mfma_f32_16x16x32_bf16 a[176:179], v[184:187], v[112:115], a[176:179]
  s_cbranch_vccnz L_slow_p1b
L_back_p1b:
  s_waitcnt lgkmcnt(14)
  v_mfma_f32_16x16x32_bf16 a[176:179], v[192:195], v[48:51], a[176:179]
  v_mfma_f32_16x16x32_bf16 a[180:183], v[196:199], v[48:51], a[180:183]
  v_mfma_f32_16x16x32_bf16 a[180:183], v[188:191], v[112:115], a[180:183]
  buffer_load_dwordx4 a[92:95], v13, s[12:15], s52 offen offset:1024 sc1
  v_mfma_f32_16x16x32_bf16 a[188:191], v[188:191], v[48:51], a[188:191]
  s_waitcnt lgkmcnt(0)
  s_barrier
  v_mfma_f32_16x16x32_bf16 a[188:191], v[196:199], v[56:59], a[188:191]
  ds_read_b128 v[200:203], v22 offset:0
  v_mfma_f32_16x16x32_bf16 a[184:187], v[192:195], v[56:59], a[184:187]
  v_mfma_f32_16x16x32_bf16 a[184:187], v[184:187], v[48:51], a[184:187]
  s_mov_b32 s52, 237568
  v_mfma_f32_16x16x32_bf16 a[128:131], v[232:235], v[96:99], a[128:131]
  s_waitcnt vmcnt(13)
  s_barrier
  ds_read_b128 v[168:171], v22 offset:21760
  v_mfma_f32_16x16x32_bf16 a[128:131], a[192:195], v[104:107], a[128:131]
  buffer_load_dwordx4 a[104:107], v13, s[12:15], s52 offen offset:0 sc1
  ds_read_b128 v[68:71], v9 offset:0
  v_mfma_f32_16x16x32_bf16 a[132:135], a[196:199], v[104:107], a[132:135]
  ds_read_b128 v[100:103], v9 offset:256
  v_mfma_f32_16x16x32_bf16 a[132:135], v[236:239], v[96:99], a[132:135]
  ds_read_b128 v[204:207], v22 offset:1024
  s_add_u32 m0, s29, 35904
  v_mfma_f32_16x16x32_bf16 a[140:143], v[236:239], v[104:107], a[140:143]
  ds_read_b128 v[64:67], v9 offset:512
  s_add_u32 s51, s49, 104448
  v_mfma_f32_16x16x32_bf16 a[140:143], a[196:199], v[108:111], a[140:143]
  buffer_load_dwordx4 v3, s[12:15], s51 offen sc1 lds
  v_mfma_f32_16x16x32_bf16 a[136:139], a[192:195], v[108:111], a[136:139]
  ds_read_b128 v[72:75], v9 offset:768
  ds_read_b128 v[172:175], v22 offset:22784
  v_mfma_f32_16x16x32_bf16 a[136:139], v[232:235], v[104:107], a[136:139]
  v_mfma_f32_16x16x32_bf16 a[144:147], v[232:235], v[108:111], a[144:147]
  ds_read_b128 v[76:79], v9 offset:1024
  s_add_u32 m0, s29, 44224
  v_mfma_f32_16x16x32_bf16 a[144:147], a[192:195], v[116:119], a[144:147]
  s_add_u32 s51, s49, 112640
  ds_read_b128 v[80:83], v9 offset:1280
  ds_read_b128 v[208:211], v22 offset:2048
  v_mfma_f32_16x16x32_bf16 a[148:151], a[196:199], v[116:119], a[148:151]
  buffer_load_dwordx4 v3, s[12:15], s51 offen sc1 lds
  v_mfma_f32_16x16x32_bf16 a[148:151], v[236:239], v[108:111], a[148:151]
  ds_read_b128 v[84:87], v9 offset:1536
  v_mfma_f32_16x16x32_bf16 a[156:159], v[236:239], v[116:119], a[156:159]
  ds_read_b128 v[176:179], v22 offset:23808
  v_mfma_f32_16x16x32_bf16 a[156:159], a[196:199], v[112:115], a[156:159]
  ds_read_b128 v[92:95], v9 offset:1792
  s_add_u32 m0, s29, 52544
  v_mfma_f32_16x16x32_bf16 a[152:155], a[192:195], v[112:115], a[152:155]
  s_add_u32 s51, s49, 120832
  v_mfma_f32_16x16x32_bf16 a[152:155], v[232:235], v[116:119], a[152:155]
  ds_read_b128 v[212:215], v22 offset:3072
  buffer_load_dwordx4 v3, s[12:15], s51 offen sc1 lds
  v_mfma_f32_16x16x32_bf16 a[160:163], v[232:235], v[112:115], a[160:163]
  v_mfma_f32_16x16x32_bf16 a[160:163], a[192:195], v[48:51], a[160:163]
  v_mfma_f32_16x16x32_bf16 a[164:167], a[196:199], v[48:51], a[164:167]
  ds_read_b128 v[180:183], v22 offset:24832
  s_add_u32 m0, s29, 60864
  v_mfma_f32_16x16x32_bf16 a[164:167], v[236:239], v[112:115], a[164:167]
  s_add_u32 s51, s49, 129024
  v_mfma_f32_16x16x32_bf16 a[172:175], v[236:239], v[48:51], a[172:175]
  buffer_load_dwordx4 v3, s[12:15], s51 offen sc1 lds
  v_mfma_f32_16x16x32_bf16 a[172:175], a[196:199], v[56:59], a[172:175]
  ds_read_b128 v[184:187], v21 offset:0
  v_mfma_f32_16x16x32_bf16 a[168:171], a[192:195], v[56:59], a[168:171]
  v_mfma_f32_16x16x32_bf16 a[168:171], v[232:235], v[48:51], a[168:171]
  s_add_u32 m0, s29, 36928
  v_mfma_f32_16x16x32_bf16 a[176:179], v[232:235], v[56:59], a[176:179]
  ds_read_b128 v[136:139], v21 offset:21760
  s_add_u32 s51, s49, 105472
  v_mfma_f32_16x16x32_bf16 a[176:179], a[192:195], v[52:55], a[176:179]
  buffer_load_dwordx4 v3, s[12:15], s51 offen sc1 lds
  v_mfma_f32_16x16x32_bf16 a[180:183], a[196:199], v[52:55], a[180:183]
  v_mfma_f32_16x16x32_bf16 a[180:183], v[236:239], v[56:59], a[180:183]
  ds_read_b128 v[188:191], v21 offset:1024
  v_mfma_f32_16x16x32_bf16 a[188:191], v[236:239], v[52:55], a[188:191]
  s_waitcnt lgkmcnt(15)
  s_add_u32 m0, s29, 45248
  v_add_f32 v200, v200, v168
  v_mfma_f32_16x16x32_bf16 a[188:191], a[196:199], v[60:63], a[188:191]
  s_add_u32 s51, s49, 113664
  v_add_f32 v201, v201, v169
  v_mfma_f32_16x16x32_bf16 a[184:187], a[192:195], v[60:63], a[184:187]
  ds_read_b128 v[140:143], v21 offset:22784
  buffer_load_dwordx4 v3, s[12:15], s51 offen sc1 lds
  v_mfma_f32_16x16x32_bf16 a[184:187], v[232:235], v[52:55], a[184:187]
  v_add_f32 v202, v202, v170
  v_add_f32 v203, v203, v171
  v_mfma_f32_16x16x32_bf16 a[128:131], a[200:203], v[68:71], a[128:131]
  s_waitcnt lgkmcnt(15)
  s_waitcnt lgkmcnt(12)
  v_add_f32 v204, v204, v172
  v_mfma_f32_16x16x32_bf16 a[128:131], a[208:211], v[100:103], a[128:131]
  s_add_u32 m0, s29, 53568
  ds_read_b128 v[88:91], v9 offset:2080
  ds_read_b128 v[192:195], v21 offset:2048
  v_mfma_f32_16x16x32_bf16 a[132:135], a[212:215], v[100:103], a[132:135]
  s_add_u32 s51, s49, 121856
  v_add_f32 v205, v205, v173
  v_mfma_f32_16x16x32_bf16 a[132:135], a[204:207], v[68:71], a[132:135]
  buffer_load_dwordx4 v3, s[12:15], s51 offen sc1 lds
  v_add_f32 v206, v206, v174
  v_mfma_f32_16x16x32_bf16 a[140:143], a[204:207], v[100:103], a[140:143]
  ds_read_b128 v[144:147], v21 offset:23808
  v_add_f32 v207, v207, v175
  v_mfma_f32_16x16x32_bf16 a[140:143], a[212:215], v[64:67], a[140:143]
  v_cvt_pk_bf16_f32 v200, v200, v201
  v_mfma_f32_16x16x32_bf16 a[136:139], a[208:211], v[64:67], a[136:139]
  s_add_u32 m0, s29, 61888
  v_cvt_pk_bf16_f32 v201, v202, v203
  v_mfma_f32_16x16x32_bf16 a[136:139], a[200:203], v[100:103], a[136:139]
  s_add_u32 s51, s49, 130048
  ds_read_b128 v[196:199], v21 offset:3072
  v_cvt_pk_bf16_f32 v202, v204, v205
  v_mfma_f32_16x16x32_bf16 a[144:147], a[200:203], v[64:67], a[144:147]
  buffer_load_dwordx4 v3, s[12:15], s51 offen sc1 lds
  v_cvt_pk_bf16_f32 v203, v206, v207
  v_mfma_f32_16x16x32_bf16 a[144:147], a[208:211], v[72:75], a[144:147]
  s_waitcnt lgkmcnt(13)
  s_waitcnt lgkmcnt(11)
  v_add_f32 v208, v208, v176
  v_mfma_f32_16x16x32_bf16 a[148:151], a[212:215], v[72:75], a[148:151]
  ds_read_b128 v[148:151], v21 offset:24832
  v_add_f32 v209, v209, v177
  v_mfma_f32_16x16x32_bf16 a[148:151], a[204:207], v[64:67], a[148:151]
  s_mul_i32 s74, s2, 24576
  v_add_f32 v210, v210, v178
  v_mfma_f32_16x16x32_bf16 a[156:159], a[204:207], v[72:75], a[156:159]
  s_add_u32 s74, s74, 4096
  v_add_f32 v211, v211, v179
  v_mfma_f32_16x16x32_bf16 a[156:159], a[212:215], v[76:79], a[156:159]
  s_waitcnt lgkmcnt(10)
  ds_read_b128 v[96:99], v9 offset:2336
  s_waitcnt lgkmcnt(10)
  buffer_store_dwordx4 v[200:203], v24, s[12:15], s74 offen offset:0 sc1
  v_add_f32 v212, v212, v180
  v_mfma_f32_16x16x32_bf16 a[152:155], a[208:211], v[76:79], a[152:155]
  v_add_f32 v213, v213, v181
  v_mfma_f32_16x16x32_bf16 a[152:155], a[200:203], v[72:75], a[152:155]
  v_add_f32 v214, v214, v182
  v_mfma_f32_16x16x32_bf16 a[160:163], a[200:203], v[76:79], a[160:163]
  s_mov_b32 m0, s31
  v_add_f32 v215, v215, v183
  v_mfma_f32_16x16x32_bf16 a[160:163], a[208:211], v[80:83], a[160:163]
  s_add_u32 s51, s49, 137216
  v_cvt_pk_bf16_f32 v208, v208, v209
  v_mfma_f32_16x16x32_bf16 a[164:167], a[212:215], v[80:83], a[164:167]
  buffer_load_dwordx4 v4, s[12:15], s51 offen sc1 lds
  v_cvt_pk_bf16_f32 v209, v210, v211
  v_mfma_f32_16x16x32_bf16 a[164:167], a[204:207], v[76:79], a[164:167]
  v_cvt_pk_bf16_f32 v210, v212, v213
  v_mfma_f32_16x16x32_bf16 a[172:175], a[204:207], v[80:83], a[172:175]
  v_cvt_pk_bf16_f32 v211, v214, v215
  v_mfma_f32_16x16x32_bf16 a[172:175], a[212:215], v[84:87], a[172:175]
  s_waitcnt lgkmcnt(9)
  s_waitcnt lgkmcnt(8)
  v_add_f32 v184, v184, v136
  v_mfma_f32_16x16x32_bf16 a[168:171], a[208:211], v[84:87], a[168:171]
  v_add_f32 v185, v185, v137
  v_mfma_f32_16x16x32_bf16 a[168:171], a[200:203], v[80:83], a[168:171]
  buffer_store_dwordx4 v[208:211], v24, s[12:15], s74 offen offset:1024 sc1
  v_add_f32 v186, v186, v138
  v_mfma_f32_16x16x32_bf16 a[176:179], a[200:203], v[84:87], a[176:179]
  v_add_f32 v187, v187, v139
  v_mfma_f32_16x16x32_bf16 a[176:179], a[208:211], v[92:95], a[176:179]
  s_waitcnt lgkmcnt(7)
  ds_read_b128 v[104:107], v9 offset:2592
  s_waitcnt lgkmcnt(7)
  v_mfma_f32_16x16x32_bf16 a[180:183], a[212:215], v[92:95], a[180:183]
  v_add_f32 v188, v188, v140
  v_add_f32 v189, v189, v141
  v_mfma_f32_16x16x32_bf16 a[180:183], a[204:207], v[84:87], a[180:183]
  v_add_f32 v190, v190, v142
  v_mfma_f32_16x16x32_bf16 a[188:191], a[204:207], v[92:95], a[188:191]
  buffer_load_dwordx4 a[108:111], v13, s[12:15], s52 offen offset:1024 sc1
  s_waitcnt lgkmcnt(6)
  v_mfma_f32_16x16x32_bf16 a[188:191], a[212:215], v[88:91], a[188:191]
  s_waitcnt lgkmcnt(5)
  s_waitcnt lgkmcnt(4)
  v_add_f32 v191, v191, v143
  v_mfma_f32_16x16x32_bf16 a[184:187], a[208:211], v[88:91], a[184:187]
  v_add_f32 v192, v192, v144
  v_add_f32 v193, v193, v145
  v_mfma_f32_16x16x32_bf16 a[184:187], a[200:203], v[92:95], a[184:187]
  v_add_f32 v194, v194, v146
  v_mfma_f32_16x16x32_bf16 a[128:131], a[216:219], v[64:67], a[128:131]
  s_mov_b32 s52, 245760
  v_add_f32 v195, v195, v147
  v_mfma_f32_16x16x32_bf16 a[128:131], a[224:227], v[72:75], a[128:131]
  s_waitcnt lgkmcnt(3)
  s_waitcnt lgkmcnt(2)
  v_add_f32 v196, v196, v148
  v_mfma_f32_16x16x32_bf16 a[132:135], a[228:231], v[72:75], a[132:135]
  buffer_load_dwordx4 a[120:123], v13, s[12:15], s52 offen offset:0 sc1
  v_add_f32 v197, v197, v149
  v_mfma_f32_16x16x32_bf16 a[132:135], a[220:223], v[64:67], a[132:135]
  v_add_f32 v198, v198, v150
  v_mfma_f32_16x16x32_bf16 a[140:143], a[220:223], v[72:75], a[140:143]
  v_add_f32 v199, v199, v151
  v_mfma_f32_16x16x32_bf16 a[140:143], a[228:231], v[76:79], a[140:143]
  ds_read_b128 v[108:111], v9 offset:2848
  v_mfma_f32_16x16x32_bf16 a[136:139], a[224:227], v[76:79], a[136:139]
  buffer_load_dwordx4 a[124:127], v13, s[12:15], s52 offen offset:1024 sc1
  v_mfma_f32_16x16x32_bf16 a[136:139], a[216:219], v[72:75], a[136:139]
  v_mfma_f32_16x16x32_bf16 a[144:147], a[216:219], v[76:79], a[144:147]
  v_mfma_f32_16x16x32_bf16 a[144:147], a[224:227], v[80:83], a[144:147]
  v_mfma_f32_16x16x32_bf16 a[148:151], a[228:231], v[80:83], a[148:151]
  s_mov_b32 s52, 253952
  v_mfma_f32_16x16x32_bf16 a[148:151], a[220:223], v[76:79], a[148:151]
  buffer_load_dwordx4 a[0:3], v13, s[12:15], s52 offen offset:0 sc1
  v_mfma_f32_16x16x32_bf16 a[156:159], a[220:223], v[80:83], a[156:159]
  v_mfma_f32_16x16x32_bf16 a[156:159], a[228:231], v[84:87], a[156:159]
  v_mfma_f32_16x16x32_bf16 a[152:155], a[224:227], v[84:87], a[152:155]
  v_mfma_f32_16x16x32_bf16 a[152:155], a[216:219], v[80:83], a[152:155]
  v_mfma_f32_16x16x32_bf16 a[160:163], a[216:219], v[84:87], a[160:163]
  buffer_load_dwordx4 a[4:7], v13, s[12:15], s52 offen offset:1024 sc1
  v_mfma_f32_16x16x32_bf16 a[160:163], a[224:227], v[92:95], a[160:163]
  ds_read_b128 v[116:119], v9 offset:3104
  v_mfma_f32_16x16x32_bf16 a[164:167], a[228:231], v[92:95], a[164:167]
  v_mfma_f32_16x16x32_bf16 a[164:167], a[220:223], v[84:87], a[164:167]
  v_mfma_f32_16x16x32_bf16 a[172:175], a[220:223], v[92:95], a[172:175]
  s_mov_b32 s52, 262144
  v_mfma_f32_16x16x32_bf16 a[172:175], a[228:231], v[88:91], a[172:175]
  buffer_load_dwordx4 a[16:19], v13, s[12:15], s52 offen offset:0 sc1
  v_mfma_f32_16x16x32_bf16 a[168:171], a[224:227], v[88:91], a[168:171]
  v_mfma_f32_16x16x32_bf16 a[168:171], a[216:219], v[92:95], a[168:171]
  v_mfma_f32_16x16x32_bf16 a[176:179], a[216:219], v[88:91], a[176:179]
  s_waitcnt lgkmcnt(3)
  v_mfma_f32_16x16x32_bf16 a[176:179], a[224:227], v[96:99], a[176:179]
  v_mfma_f32_16x16x32_bf16 a[180:183], a[228:231], v[96:99], a[180:183]
  buffer_load_dwordx4 a[20:23], v13, s[12:15], s52 offen offset:1024 sc1
  v_mfma_f32_16x16x32_bf16 a[180:183], a[220:223], v[88:91], a[180:183]
  v_mfma_f32_16x16x32_bf16 a[188:191], a[220:223], v[96:99], a[188:191]
L_it3:
  v_add_u32 v252, L_it3-standalone__self_sup_conv_stem_hubert__speech_kernel+3072, v253
  s_waitcnt lgkmcnt(2)
  v_mfma_f32_16x16x32_bf16 a[188:191], a[228:231], v[104:107], a[188:191]
  ds_read_b128 v[112:115], v9 offset:3360
  v_min_u32 v252, L_end-standalone__self_sup_conv_stem_hubert__speech_kernel-8, v252
  v_mfma_f32_16x16x32_bf16 a[184:187], a[224:227], v[104:107], a[184:187]
  v_mfma_f32_16x16x32_bf16 a[184:187], a[216:219], v[96:99], a[184:187]
  global_load_dword v255, v252, s[84:85]
  v_mfma_f32_16x16x32_bf16 a[128:131], a[232:235], v[76:79], a[128:131]
  v_mfma_f32_16x16x32_bf16 a[128:131], a[240:243], v[80:83], a[128:131]
  v_mfma_f32_16x16x32_bf16 a[132:135], a[244:247], v[80:83], a[132:135]
  v_mfma_f32_16x16x32_bf16 a[132:135], a[236:239], v[76:79], a[132:135]
  s_mov_b32 s52, 270336
  v_mfma_f32_16x16x32_bf16 a[140:143], a[236:239], v[80:83], a[140:143]
  buffer_load_dwordx4 a[32:35], v13, s[12:15], s52 offen offset:0 sc1
  v_mfma_f32_16x16x32_bf16 a[140:143], a[244:247], v[84:87], a[140:143]
  v_mfma_f32_16x16x32_bf16 a[136:139], a[240:243], v[84:87], a[136:139]
  v_mfma_f32_16x16x32_bf16 a[136:139], a[232:235], v[80:83], a[136:139]
  v_mfma_f32_16x16x32_bf16 a[144:147], a[232:235], v[84:87], a[144:147]
  v_mfma_f32_16x16x32_bf16 a[144:147], a[240:243], v[92:95], a[144:147]
  ds_read_b128 v[48:51], v9 offset:3616
  buffer_load_dwordx4 a[36:39], v13, s[12:15], s52 offen offset:1024 sc1
  v_mfma_f32_16x16x32_bf16 a[148:151], a[244:247], v[92:95], a[148:151]
  v_mfma_f32_16x16x32_bf16 a[148:151], a[236:239], v[84:87], a[148:151]
  v_mfma_f32_16x16x32_bf16 a[156:159], a[236:239], v[92:95], a[156:159]
  v_mfma_f32_16x16x32_bf16 a[156:159], a[244:247], v[88:91], a[156:159]
  s_mov_b32 s52, 278528
  v_mfma_f32_16x16x32_bf16 a[152:155], a[240:243], v[88:91], a[152:155]
  buffer_load_dwordx4 a[48:51], v13, s[12:15], s52 offen offset:0 sc1
  v_mfma_f32_16x16x32_bf16 a[152:155], a[232:235], v[92:95], a[152:155]
  v_mfma_f32_16x16x32_bf16 a[160:163], a[232:235], v[88:91], a[160:163]
  v_mfma_f32_16x16x32_bf16 a[160:163], a[240:243], v[96:99], a[160:163]
  v_mfma_f32_16x16x32_bf16 a[164:167], a[244:247], v[96:99], a[164:167]
  v_mfma_f32_16x16x32_bf16 a[164:167], a[236:239], v[88:91], a[164:167]
  buffer_load_dwordx4 a[52:55], v13, s[12:15], s52 offen offset:1024 sc1
  v_mfma_f32_16x16x32_bf16 a[172:175], a[236:239], v[96:99], a[172:175]
  v_mfma_f32_16x16x32_bf16 a[172:175], a[244:247], v[104:107], a[172:175]
  v_mfma_f32_16x16x32_bf16 a[168:171], a[240:243], v[104:107], a[168:171]
  v_mfma_f32_16x16x32_bf16 a[168:171], a[232:235], v[96:99], a[168:171]
  s_mov_b32 s52, 286720
  v_mfma_f32_16x16x32_bf16 a[176:179], a[232:235], v[104:107], a[176:179]
  buffer_load_dwordx4 a[64:67], v13, s[12:15], s52 offen offset:0 sc1
  s_waitcnt lgkmcnt(3)
  v_mfma_f32_16x16x32_bf16 a[176:179], a[240:243], v[108:111], a[176:179]
  v_mfma_f32_16x16x32_bf16 a[180:183], a[244:247], v[108:111], a[180:183]
  v_mfma_f32_16x16x32_bf16 a[180:183], a[236:239], v[104:107], a[180:183]
  v_mfma_f32_16x16x32_bf16 a[188:191], a[236:239], v[108:111], a[188:191]
  s_waitcnt lgkmcnt(2)
  v_mfma_f32_16x16x32_bf16 a[188:191], a[244:247], v[116:119], a[188:191]
  buffer_load_dwordx4 a[68:71], v13, s[12:15], s52 offen offset:1024 sc1
  v_mfma_f32_16x16x32_bf16 a[184:187], a[240:243], v[116:119], a[184:187]
  v_mfma_f32_16x16x32_bf16 a[184:187], a[232:235], v[108:111], a[184:187]
  v_mfma_f32_16x16x32_bf16 a[128:131], a[248:251], v[84:87], a[128:131]
  s_waitcnt vmcnt(15) lgkmcnt(0)
  s_barrier
  v_mfma_f32_16x16x32_bf16 a[128:131], a[8:11], v[92:95], a[128:131]
  ds_read_b128 v[56:59], v9 offset:35904
  s_mov_b32 s52, 294912
  v_mfma_f32_16x16x32_bf16 a[132:135], a[12:15], v[92:95], a[132:135]
  ds_read_b128 v[60:63], v9 offset:36160
  buffer_load_dwordx4 a[80:83], v13, s[12:15], s52 offen offset:0 sc1
  v_mfma_f32_16x16x32_bf16 a[132:135], a[252:255], v[84:87], a[132:135]
  v_mfma_f32_16x16x32_bf16 a[140:143], a[252:255], v[92:95], a[140:143]
  ds_read_b128 v[52:55], v9 offset:36416
  v_mfma_f32_16x16x32_bf16 a[140:143], a[12:15], v[88:91], a[140:143]
  s_add_u32 m0, s29, 0
  v_mfma_f32_16x16x32_bf16 a[136:139], a[8:11], v[88:91], a[136:139]
  ds_read_b128 v[68:71], v9 offset:36672
  s_add_u32 s51, s49, 139264
  v_mfma_f32_16x16x32_bf16 a[136:139], a[248:251], v[92:95], a[136:139]
  buffer_load_dwordx4 v3, s[12:15], s51 offen sc1 lds
  v_mfma_f32_16x16x32_bf16 a[144:147], a[248:251], v[88:91], a[144:147]
  ds_read_b128 v[100:103], v9 offset:36928
  v_mfma_f32_16x16x32_bf16 a[144:147], a[8:11], v[96:99], a[144:147]
  ds_read_b128 v[64:67], v9 offset:37184
  v_mfma_f32_16x16x32_bf16 a[148:151], a[12:15], v[96:99], a[148:151]
  s_add_u32 m0, s29, 8320
  v_mfma_f32_16x16x32_bf16 a[148:151], a[252:255], v[88:91], a[148:151]
  ds_read_b128 v[72:75], v9 offset:37440
  s_add_u32 s51, s49, 147456
  v_mfma_f32_16x16x32_bf16 a[156:159], a[252:255], v[96:99], a[156:159]
  buffer_load_dwordx4 v3, s[12:15], s51 offen sc1 lds
  v_mfma_f32_16x16x32_bf16 a[156:159], a[12:15], v[104:107], a[156:159]
  ds_read_b128 v[76:79], v9 offset:37696
  v_mfma_f32_16x16x32_bf16 a[152:155], a[8:11], v[104:107], a[152:155]
  v_mfma_f32_16x16x32_bf16 a[152:155], a[248:251], v[96:99], a[152:155]
  v_mfma_f32_16x16x32_bf16 a[160:163], a[248:251], v[104:107], a[160:163]
  s_waitcnt vmcnt(17)
  s_barrier
  v_mfma_f32_16x16x32_bf16 a[160:163], a[8:11], v[108:111], a[160:163]
  buffer_store_dwordx2 v[240:241], v37, s[12:15], 0 offen sc1
  v_mfma_f32_16x16x32_bf16 a[164:167], a[12:15], v[108:111], a[164:167]
  v_mfma_f32_16x16x32_bf16 a[164:167], a[252:255], v[104:107], a[164:167]
  v_mfma_f32_16x16x32_bf16 a[172:175], a[252:255], v[108:111], a[172:175]
  s_add_u32 m0, s29, 16640
  v_mfma_f32_16x16x32_bf16 a[172:175], a[12:15], v[116:119], a[172:175]
  s_add_u32 s51, s49, 155648
  v_mfma_f32_16x16x32_bf16 a[168:171], a[8:11], v[116:119], a[168:171]
  buffer_load_dwordx4 v3, s[12:15], s51 offen sc1 lds
  v_mfma_f32_16x16x32_bf16 a[168:171], a[248:251], v[108:111], a[168:171]
  v_mfma_f32_16x16x32_bf16 a[176:179], a[248:251], v[116:119], a[176:179]
  v_mfma_f32_16x16x32_bf16 a[176:179], a[8:11], v[112:115], a[176:179]
  s_add_u32 m0, s29, 24960
  v_mfma_f32_16x16x32_bf16 a[180:183], a[12:15], v[112:115], a[180:183]
  s_add_u32 s51, s49, 163840
  v_mfma_f32_16x16x32_bf16 a[180:183], a[252:255], v[116:119], a[180:183]
  buffer_load_dwordx4 v3, s[12:15], s51 offen sc1 lds
  v_mfma_f32_16x16x32_bf16 a[188:191], a[252:255], v[112:115], a[188:191]
  v_mfma_f32_16x16x32_bf16 a[188:191], a[12:15], v[48:51], a[188:191]
  v_mfma_f32_16x16x32_bf16 a[184:187], a[8:11], v[48:51], a[184:187]
  s_add_u32 m0, s29, 1024
  v_mfma_f32_16x16x32_bf16 a[184:187], a[248:251], v[112:115], a[184:187]
  s_add_u32 s51, s49, 140288
  s_waitcnt lgkmcnt(7)
  v_mfma_f32_16x16x32_bf16 a[128:131], a[24:27], v[56:59], a[128:131]
  buffer_load_dwordx4 v3, s[12:15], s51 offen sc1 lds
  s_waitcnt lgkmcnt(6)
  v_mfma_f32_16x16x32_bf16 a[128:131], a[40:43], v[60:63], a[128:131]
  ds_read_b128 v[80:83], v9 offset:37984
  v_mfma_f32_16x16x32_bf16 a[132:135], a[44:47], v[60:63], a[132:135]
  v_mfma_f32_16x16x32_bf16 a[132:135], a[28:31], v[56:59], a[132:135]
  s_add_u32 m0, s29, 9344
  v_mfma_f32_16x16x32_bf16 a[140:143], a[28:31], v[60:63], a[140:143]
  s_add_u32 s51, s49, 148480
  s_waitcnt lgkmcnt(6)
  v_mfma_f32_16x16x32_bf16 a[140:143], a[44:47], v[52:55], a[140:143]
  buffer_load_dwordx4 v3, s[12:15], s51 offen sc1 lds
  v_mfma_f32_16x16x32_bf16 a[136:139], a[40:43], v[52:55], a[136:139]
  v_mfma_f32_16x16x32_bf16 a[136:139], a[24:27], v[60:63], a[136:139]
  v_mfma_f32_16x16x32_bf16 a[144:147], a[24:27], v[52:55], a[144:147]
  s_add_u32 m0, s29, 17664
  s_waitcnt lgkmcnt(5)
  v_mfma_f32_16x16x32_bf16 a[144:147], a[40:43], v[68:71], a[144:147]
  s_add_u32 s51, s49, 156672
  v_mfma_f32_16x16x32_bf16 a[148:151], a[44:47], v[68:71], a[148:151]
  buffer_load_dwordx4 v3, s[12:15], s51 offen sc1 lds
  v_mfma_f32_16x16x32_bf16 a[148:151], a[28:31], v[52:55], a[148:151]
  v_mfma_f32_16x16x32_bf16 a[156:159], a[28:31], v[68:71], a[156:159]
  s_waitcnt lgkmcnt(4)
  v_mfma_f32_16x16x32_bf16 a[156:159], a[44:47], v[100:103], a[156:159]
  ds_read_b128 v[84:87], v9 offset:38240
  s_add_u32 m0, s29, 25984
  v_mfma_f32_16x16x32_bf16 a[152:155], a[40:43], v[100:103], a[152:155]
  s_add_u32 s51, s49, 164864
  v_mfma_f32_16x16x32_bf16 a[152:155], a[24:27], v[68:71], a[152:155]
  buffer_load_dwordx4 v3, s[12:15], s51 offen sc1 lds
  v_mfma_f32_16x16x32_bf16 a[160:163], a[24:27], v[100:103], a[160:163]
  s_waitcnt lgkmcnt(4)
  v_mfma_f32_16x16x32_bf16 a[160:163], a[40:43], v[64:67], a[160:163]
  v_mfma_f32_16x16x32_bf16 a[164:167], a[44:47], v[64:67], a[164:167]
  s_mov_b32 m0, s30
  v_mfma_f32_16x16x32_bf16 a[164:167], a[28:31], v[100:103], a[164:167]
  s_add_u32 s51, s49, 172032
  v_mfma_f32_16x16x32_bf16 a[172:175], a[28:31], v[64:67], a[172:175]
  buffer_load_dwordx4 v4, s[12:15], s51 offen sc1 lds
  s_waitcnt lgkmcnt(3)
  v_mfma_f32_16x16x32_bf16 a[172:175], a[44:47], v[72:75], a[172:175]
  v_mfma_f32_16x16x32_bf16 a[168:171], a[40:43], v[72:75], a[168:171]
  v_mfma_f32_16x16x32_bf16 a[168:171], a[24:27], v[64:67], a[168:171]
  v_mfma_f32_16x16x32_bf16 a[176:179], a[24:27], v[72:75], a[176:179]
  s_waitcnt lgkmcnt(2)
  v_mfma_f32_16x16x32_bf16 a[176:179], a[40:43], v[76:79], a[176:179]
  ds_read_b128 v[92:95], v9 offset:38496
  buffer_load_dwordx4 a[84:87], v13, s[12:15], s52 offen offset:1024 sc1
  v_mfma_f32_16x16x32_bf16 a[180:183], a[44:47], v[76:79], a[180:183]
  v_mfma_f32_16x16x32_bf16 a[180:183], a[28:31], v[72:75], a[180:183]
  v_mfma_f32_16x16x32_bf16 a[188:191], a[28:31], v[76:79], a[188:191]
  s_waitcnt lgkmcnt(2)
  v_mfma_f32_16x16x32_bf16 a[188:191], a[44:47], v[80:83], a[188:191]
  s_mov_b32 s52, 303104
  v_mfma_f32_16x16x32_bf16 a[184:187], a[40:43], v[80:83], a[184:187]
  buffer_load_dwordx4 a[96:99], v13, s[12:15], s52 offen offset:0 sc1
  v_mfma_f32_16x16x32_bf16 a[184:187], a[24:27], v[76:79], a[184:187]
  v_mfma_f32_16x16x32_bf16 a[128:131], a[56:59], v[52:55], a[128:131]
  v_mfma_f32_16x16x32_bf16 a[128:131], a[72:75], v[68:71], a[128:131]
  v_mfma_f32_16x16x32_bf16 a[132:135], a[76:79], v[68:71], a[132:135]
  v_mfma_f32_16x16x32_bf16 a[132:135], a[60:63], v[52:55], a[132:135]
  buffer_load_dwordx4 a[100:103], v13, s[12:15], s52 offen offset:1024 sc1
  v_mfma_f32_16x16x32_bf16 a[140:143], a[60:63], v[68:71], a[140:143]
  v_mfma_f32_16x16x32_bf16 a[140:143], a[76:79], v[100:103], a[140:143]
  ds_read_b128 v[88:91], v9 offset:38752
  v_mfma_f32_16x16x32_bf16 a[136:139], a[72:75], v[100:103], a[136:139]
  v_mfma_f32_16x16x32_bf16 a[136:139], a[56:59], v[68:71], a[136:139]
  s_mov_b32 s52, 311296
  v_mfma_f32_16x16x32_bf16 a[144:147], a[56:59], v[100:103], a[144:147]
  buffer_load_dwordx4 a[112:115], v13, s[12:15], s52 offen offset:0 sc1
  v_mfma_f32_16x16x32_bf16 a[144:147], a[72:75], v[64:67], a[144:147]
  v_mfma_f32_16x16x32_bf16 a[148:151], a[76:79], v[64:67], a[148:151]
  v_mfma_f32_16x16x32_bf16 a[148:151], a[60:63], v[100:103], a[148:151]
  v_mfma_f32_16x16x32_bf16 a[156:159], a[60:63], v[64:67], a[156:159]
  v_mfma_f32_16x16x32_bf16 a[156:159], a[76:79], v[72:75], a[156:159]
  buffer_load_dwordx4 a[116:119], v13, s[12:15], s52 offen offset:1024 sc1
  v_mfma_f32_16x16x32_bf16 a[152:155], a[72:75], v[72:75], a[152:155]
  v_mfma_f32_16x16x32_bf16 a[152:155], a[56:59], v[64:67], a[152:155]
  v_mfma_f32_16x16x32_bf16 a[160:163], a[56:59], v[72:75], a[160:163]
  v_mfma_f32_16x16x32_bf16 a[160:163], a[72:75], v[76:79], a[160:163]
  ds_read_b128 v[96:99], v9 offset:39008
  s_mov_b32 s52, 319488
  v_mfma_f32_16x16x32_bf16 a[164:167], a[76:79], v[76:79], a[164:167]
  buffer_load_dwordx4 a[192:195], v13, s[12:15], s52 offen offset:0 sc1
  v_mfma_f32_16x16x32_bf16 a[164:167], a[60:63], v[72:75], a[164:167]
  v_mfma_f32_16x16x32_bf16 a[172:175], a[60:63], v[76:79], a[172:175]
  v_mfma_f32_16x16x32_bf16 a[172:175], a[76:79], v[80:83], a[172:175]
  v_mfma_f32_16x16x32_bf16 a[168:171], a[72:75], v[80:83], a[168:171]
  v_mfma_f32_16x16x32_bf16 a[168:171], a[56:59], v[76:79], a[168:171]
  buffer_load_dwordx4 a[196:199], v13, s[12:15], s52 offen offset:1024 sc1
  v_mfma_f32_16x16x32_bf16 a[176:179], a[56:59], v[80:83], a[176:179]
  s_waitcnt lgkmcnt(3)
  v_mfma_f32_16x16x32_bf16 a[176:179], a[72:75], v[84:87], a[176:179]
  v_mfma_f32_16x16x32_bf16 a[180:183], a[76:79], v[84:87], a[180:183]
  v_mfma_f32_16x16x32_bf16 a[180:183], a[60:63], v[80:83], a[180:183]
  s_mov_b32 s52, 327680
  v_mfma_f32_16x16x32_bf16 a[188:191], a[60:63], v[84:87], a[188:191]
  buffer_load_dwordx4 a[200:203], v13, s[12:15], s52 offen offset:0 sc1
  s_waitcnt lgkmcnt(2)
  v_mfma_f32_16x16x32_bf16 a[188:191], a[76:79], v[92:95], a[188:191]
  ds_read_b128 v[104:107], v9 offset:39264
  v_mfma_f32_16x16x32_bf16 a[184:187], a[72:75], v[92:95], a[184:187]
  v_mfma_f32_16x16x32_bf16 a[184:187], a[56:59], v[84:87], a[184:187]
  v_mfma_f32_16x16x32_bf16 a[128:131], a[88:91], v[100:103], a[128:131]
  v_mfma_f32_16x16x32_bf16 a[128:131], a[104:107], v[64:67], a[128:131]
  buffer_load_dwordx4 a[204:207], v13, s[12:15], s52 offen offset:1024 sc1
  s_waitcnt vmcnt(33)
  v_mfma_f32_16x16x32_bf16 a[132:135], a[108:111], v[64:67], a[132:135]
  v_mfma_f32_16x16x32_bf16 a[132:135], a[92:95], v[100:103], a[132:135]
  v_mfma_f32_16x16x32_bf16 a[140:143], a[92:95], v[64:67], a[140:143]
  v_mfma_f32_16x16x32_bf16 a[140:143], a[108:111], v[72:75], a[140:143]
  s_mov_b32 s52, 335872
  v_mfma_f32_16x16x32_bf16 a[136:139], a[104:107], v[72:75], a[136:139]
  buffer_load_dwordx4 a[208:211], v13, s[12:15], s52 offen offset:0 sc1
  v_mfma_f32_16x16x32_bf16 a[136:139], a[88:91], v[64:67], a[136:139]
  v_mfma_f32_16x16x32_bf16 a[144:147], a[88:91], v[72:75], a[144:147]
  v_mfma_f32_16x16x32_bf16 a[144:147], a[104:107], v[76:79], a[144:147]
  ds_read_b128 v[108:111], v9 offset:39520
  v_mfma_f32_16x16x32_bf16 a[148:151], a[108:111], v[76:79], a[148:151]
  v_mfma_f32_16x16x32_bf16 a[148:151], a[92:95], v[72:75], a[148:151]
  buffer_load_dwordx4 a[212:215], v13, s[12:15], s52 offen offset:1024 sc1
  v_mfma_f32_16x16x32_bf16 a[156:159], a[92:95], v[76:79], a[156:159]
  v_mfma_f32_16x16x32_bf16 a[156:159], a[108:111], v[80:83], a[156:159]
  v_mfma_f32_16x16x32_bf16 a[152:155], a[104:107], v[80:83], a[152:155]
  v_mfma_f32_16x16x32_bf16 a[152:155], a[88:91], v[76:79], a[152:155]
  v_mfma_f32_16x16x32_bf16 a[160:163], a[88:91], v[80:83], a[160:163]
  buffer_load_dwordx2 v[250:251], v38, s[12:15], 0 offen sc1
  v_mfma_f32_16x16x32_bf16 a[160:163], a[104:107], v[84:87], a[160:163]
  v_mfma_f32_16x16x32_bf16 a[164:167], a[108:111], v[84:87], a[164:167]
  v_mfma_f32_16x16x32_bf16 a[164:167], a[92:95], v[80:83], a[164:167]
  v_mfma_f32_16x16x32_bf16 a[172:175], a[92:95], v[84:87], a[172:175]
  s_mov_b32 s52, 344064
  v_mfma_f32_16x16x32_bf16 a[172:175], a[108:111], v[92:95], a[172:175]
  buffer_load_dwordx4 a[216:219], v13, s[12:15], s52 offen offset:0 sc1
  v_mfma_f32_16x16x32_bf16 a[168:171], a[104:107], v[92:95], a[168:171]
  v_mfma_f32_16x16x32_bf16 a[168:171], a[88:91], v[84:87], a[168:171]
  v_mfma_f32_16x16x32_bf16 a[176:179], a[88:91], v[92:95], a[176:179]
  s_waitcnt lgkmcnt(3)
  v_mfma_f32_16x16x32_bf16 a[176:179], a[104:107], v[88:91], a[176:179]
  v_mfma_f32_16x16x32_bf16 a[180:183], a[108:111], v[88:91], a[180:183]
  buffer_load_dwordx4 a[220:223], v13, s[12:15], s52 offen offset:1024 sc1
  v_mfma_f32_16x16x32_bf16 a[180:183], a[92:95], v[92:95], a[180:183]
  v_mfma_f32_16x16x32_bf16 a[188:191], a[92:95], v[88:91], a[188:191]
  s_waitcnt lgkmcnt(2)
  v_mfma_f32_16x16x32_bf16 a[188:191], a[108:111], v[96:99], a[188:191]
  v_mfma_f32_16x16x32_bf16 a[184:187], a[104:107], v[96:99], a[184:187]
  s_mov_b32 s52, 352256
  v_mfma_f32_16x16x32_bf16 a[184:187], a[88:91], v[88:91], a[184:187]
  buffer_load_dwordx4 a[224:227], v13, s[12:15], s52 offen offset:0 sc1
  s_waitcnt vmcnt(38)
  v_mfma_f32_16x16x32_bf16 a[128:131], a[120:123], v[72:75], a[128:131]
  s_waitcnt vmcnt(15) lgkmcnt(0)
  s_barrier
  v_mfma_f32_16x16x32_bf16 a[128:131], a[0:3], v[76:79], a[128:131]
  ds_read_b128 v[116:119], v9 offset:0
  v_mfma_f32_16x16x32_bf16 a[132:135], a[4:7], v[76:79], a[132:135]
  ds_read_b128 v[48:51], v9 offset:256
  s_add_u32 m0, s29, 35904
  v_mfma_f32_16x16x32_bf16 a[132:135], a[124:127], v[72:75], a[132:135]
  s_add_u32 s51, s49, 174080
  v_mfma_f32_16x16x32_bf16 a[140:143], a[124:127], v[76:79], a[140:143]
  ds_read_b128 v[112:115], v9 offset:512
  buffer_load_dwordx4 v3, s[12:15], s51 offen sc1 lds
  v_mfma_f32_16x16x32_bf16 a[140:143], a[4:7], v[80:83], a[140:143]
  v_mfma_f32_16x16x32_bf16 a[136:139], a[0:3], v[80:83], a[136:139]
  ds_read_b128 v[56:59], v9 offset:768
  v_mfma_f32_16x16x32_bf16 a[136:139], a[120:123], v[76:79], a[136:139]
  s_add_u32 m0, s29, 44224
  v_mfma_f32_16x16x32_bf16 a[144:147], a[120:123], v[80:83], a[144:147]
  ds_read_b128 v[60:63], v9 offset:1024
  s_add_u32 s51, s49, 182272
  v_mfma_f32_16x16x32_bf16 a[144:147], a[0:3], v[84:87], a[144:147]
  ds_read_b128 v[52:55], v9 offset:1280
  buffer_load_dwordx4 v3, s[12:15], s51 offen sc1 lds
  v_mfma_f32_16x16x32_bf16 a[148:151], a[4:7], v[84:87], a[148:151]
  v_mfma_f32_16x16x32_bf16 a[148:151], a[124:127], v[80:83], a[148:151]
  ds_read_b128 v[68:71], v9 offset:1536
  v_mfma_f32_16x16x32_bf16 a[156:159], a[124:127], v[84:87], a[156:159]
  s_add_u32 m0, s29, 52544
  v_mfma_f32_16x16x32_bf16 a[156:159], a[4:7], v[92:95], a[156:159]
  ds_read_b128 v[100:103], v9 offset:1792
  s_add_u32 s51, s49, 190464
  v_mfma_f32_16x16x32_bf16 a[152:155], a[0:3], v[92:95], a[152:155]
  buffer_load_dwordx4 v3, s[12:15], s51 offen sc1 lds
  v_mfma_f32_16x16x32_bf16 a[152:155], a[120:123], v[84:87], a[152:155]
  v_mfma_f32_16x16x32_bf16 a[160:163], a[120:123], v[92:95], a[160:163]
  v_mfma_f32_16x16x32_bf16 a[160:163], a[0:3], v[88:91], a[160:163]
  s_add_u32 m0, s29, 60864
  v_mfma_f32_16x16x32_bf16 a[164:167], a[4:7], v[88:91], a[164:167]
  s_add_u32 s51, s49, 198656
  v_mfma_f32_16x16x32_bf16 a[164:167], a[124:127], v[92:95], a[164:167]
  buffer_load_dwordx4 v3, s[12:15], s51 offen sc1 lds
  v_mfma_f32_16x16x32_bf16 a[172:175], a[124:127], v[88:91], a[172:175]
  v_mfma_f32_16x16x32_bf16 a[172:175], a[4:7], v[96:99], a[172:175]
  v_mfma_f32_16x16x32_bf16 a[168:171], a[0:3], v[96:99], a[168:171]
  s_add_u32 m0, s29, 36928
  v_mfma_f32_16x16x32_bf16 a[168:171], a[120:123], v[88:91], a[168:171]
  s_add_u32 s51, s49, 175104
  v_mfma_f32_16x16x32_bf16 a[176:179], a[120:123], v[96:99], a[176:179]
  buffer_load_dwordx4 v3, s[12:15], s51 offen sc1 lds
  v_mfma_f32_16x16x32_bf16 a[176:179], a[0:3], v[104:107], a[176:179]
  v_mfma_f32_16x16x32_bf16 a[180:183], a[4:7], v[104:107], a[180:183]
  v_mfma_f32_16x16x32_bf16 a[180:183], a[124:127], v[96:99], a[180:183]
  s_add_u32 m0, s29, 45248
  v_mfma_f32_16x16x32_bf16 a[188:191], a[124:127], v[104:107], a[188:191]
  s_add_u32 s51, s49, 183296
  v_mfma_f32_16x16x32_bf16 a[188:191], a[4:7], v[108:111], a[188:191]
  buffer_load_dwordx4 v3, s[12:15], s51 offen sc1 lds
  v_mfma_f32_16x16x32_bf16 a[184:187], a[0:3], v[108:111], a[184:187]
  v_mfma_f32_16x16x32_bf16 a[184:187], a[120:123], v[104:107], a[184:187]
  s_waitcnt lgkmcnt(7)
  v_mfma_f32_16x16x32_bf16 a[128:131], a[16:19], v[116:119], a[128:131]
  s_add_u32 m0, s29, 53568
  s_waitcnt lgkmcnt(6)
  v_mfma_f32_16x16x32_bf16 a[128:131], a[32:35], v[48:51], a[128:131]
  ds_read_b128 v[64:67], v9 offset:2080
  s_add_u32 s51, s49, 191488
  v_mfma_f32_16x16x32_bf16 a[132:135], a[36:39], v[48:51], a[132:135]
  buffer_load_dwordx4 v3, s[12:15], s51 offen sc1 lds
  v_mfma_f32_16x16x32_bf16 a[132:135], a[20:23], v[116:119], a[132:135]
  v_mfma_f32_16x16x32_bf16 a[140:143], a[20:23], v[48:51], a[140:143]
  s_waitcnt lgkmcnt(6)
  v_mfma_f32_16x16x32_bf16 a[140:143], a[36:39], v[112:115], a[140:143]
  s_add_u32 m0, s29, 61888
  v_mfma_f32_16x16x32_bf16 a[136:139], a[32:35], v[112:115], a[136:139]
  s_add_u32 s51, s49, 199680
  v_mfma_f32_16x16x32_bf16 a[136:139], a[16:19], v[48:51], a[136:139]
  buffer_load_dwordx4 v3, s[12:15], s51 offen sc1 lds
  v_mfma_f32_16x16x32_bf16 a[144:147], a[16:19], v[112:115], a[144:147]
  s_waitcnt lgkmcnt(5)
  v_mfma_f32_16x16x32_bf16 a[144:147], a[32:35], v[56:59], a[144:147]
  v_mfma_f32_16x16x32_bf16 a[148:151], a[36:39], v[56:59], a[148:151]
  s_mov_b32 m0, s31
  v_mfma_f32_16x16x32_bf16 a[148:151], a[20:23], v[112:115], a[148:151]
  s_add_u32 s51, s49, 206848
  v_mfma_f32_16x16x32_bf16 a[156:159], a[20:23], v[56:59], a[156:159]
  buffer_load_dwordx4 v4, s[12:15], s51 offen sc1 lds
  s_waitcnt lgkmcnt(4)
  v_mfma_f32_16x16x32_bf16 a[156:159], a[36:39], v[60:63], a[156:159]
  ds_read_b128 v[72:75], v9 offset:2336
  v_mfma_f32_16x16x32_bf16 a[152:155], a[32:35], v[60:63], a[152:155]
  v_mfma_f32_16x16x32_bf16 a[152:155], a[16:19], v[56:59], a[152:155]
  v_mfma_f32_16x16x32_bf16 a[160:163], a[16:19], v[60:63], a[160:163]
  s_waitcnt lgkmcnt(4)
  v_mfma_f32_16x16x32_bf16 a[160:163], a[32:35], v[52:55], a[160:163]
  buffer_load_dwordx4 a[228:231], v13, s[12:15], s52 offen offset:1024 sc1
  v_mfma_f32_16x16x32_bf16 a[164:167], a[36:39], v[52:55], a[164:167]
  v_mfma_f32_16x16x32_bf16 a[164:167], a[20:23], v[60:63], a[164:167]
  v_mfma_f32_16x16x32_bf16 a[172:175], a[20:23], v[52:55], a[172:175]
  s_waitcnt lgkmcnt(3)
  v_mfma_f32_16x16x32_bf16 a[172:175], a[36:39], v[68:71], a[172:175]
  s_mov_b32 s52, 360448
  v_mfma_f32_16x16x32_bf16 a[168:171], a[32:35], v[68:71], a[168:171]
  s_waitcnt vmcnt(13)
  v_cmp_ne_u64 vcc, s[26:27], v[250:251]
  v_mfma_f32_16x16x32_bf16 a[168:171], a[16:19], v[52:55], a[168:171]
  buffer_load_dwordx4 a[232:235], v13, s[12:15], s52 offen offset:0 sc1
  v_mfma_f32_16x16x32_bf16 a[176:179], a[16:19], v[68:71], a[176:179]
  s_cbranch_vccnz L_slow_p2
L_back_p2:
  s_waitcnt lgkmcnt(2)
  v_mfma_f32_16x16x32_bf16 a[176:179], a[32:35], v[100:103], a[176:179]
  ds_read_b128 v[76:79], v9 offset:2592
  s_xor_b32 s74, s2, 16
  v_mfma_f32_16x16x32_bf16 a[180:183], a[36:39], v[100:103], a[180:183]
  s_mul_i32 s74, s74, 24576
  v_mfma_f32_16x16x32_bf16 a[180:183], a[20:23], v[68:71], a[180:183]
  buffer_load_dwordx4 v[120:123], v24, s[12:15], s74 offen offset:0 sc1
  v_mfma_f32_16x16x32_bf16 a[188:191], a[20:23], v[100:103], a[188:191]
  s_waitcnt lgkmcnt(2)
  v_mfma_f32_16x16x32_bf16 a[188:191], a[36:39], v[64:67], a[188:191]
  v_mfma_f32_16x16x32_bf16 a[184:187], a[32:35], v[64:67], a[184:187]
  v_mfma_f32_16x16x32_bf16 a[184:187], a[16:19], v[100:103], a[184:187]
  v_mfma_f32_16x16x32_bf16 a[128:131], a[48:51], v[112:115], a[128:131]
  buffer_load_dwordx4 v[124:127], v24, s[12:15], s74 offen offset:1024 sc1
  v_mfma_f32_16x16x32_bf16 a[128:131], a[64:67], v[56:59], a[128:131]
  v_mfma_f32_16x16x32_bf16 a[132:135], a[68:71], v[56:59], a[132:135]
  v_mfma_f32_16x16x32_bf16 a[132:135], a[52:55], v[112:115], a[132:135]
  s_xor_b32 s74, s2, 48
  v_mfma_f32_16x16x32_bf16 a[140:143], a[52:55], v[56:59], a[140:143]
  s_mul_i32 s74, s74, 24576
  v_mfma_f32_16x16x32_bf16 a[140:143], a[68:71], v[60:63], a[140:143]
  ds_read_b128 v[80:83], v9 offset:2848
  buffer_load_dwordx4 v[128:131], v24, s[12:15], s74 offen offset:2048 sc1
  v_mfma_f32_16x16x32_bf16 a[136:139], a[64:67], v[60:63], a[136:139]
  v_mfma_f32_16x16x32_bf16 a[136:139], a[48:51], v[56:59], a[136:139]
  v_mfma_f32_16x16x32_bf16 a[144:147], a[48:51], v[60:63], a[144:147]
  v_mfma_f32_16x16x32_bf16 a[144:147], a[64:67], v[52:55], a[144:147]
  v_mfma_f32_16x16x32_bf16 a[148:151], a[68:71], v[52:55], a[148:151]
  buffer_load_dwordx4 v[132:135], v24, s[12:15], s74 offen offset:3072 sc1
  v_mfma_f32_16x16x32_bf16 a[148:151], a[52:55], v[60:63], a[148:151]
  v_mfma_f32_16x16x32_bf16 a[156:159], a[52:55], v[52:55], a[156:159]
  s_xor_b32 s74, s2, 32
  v_mfma_f32_16x16x32_bf16 a[156:159], a[68:71], v[68:71], a[156:159]
  s_mul_i32 s74, s74, 24576
  v_mfma_f32_16x16x32_bf16 a[152:155], a[64:67], v[68:71], a[152:155]
  s_add_u32 s74, s74, 4096
  v_mfma_f32_16x16x32_bf16 a[152:155], a[48:51], v[52:55], a[152:155]
  buffer_load_dwordx4 v[136:139], v24, s[12:15], s74 offen offset:0 sc1
  v_mfma_f32_16x16x32_bf16 a[160:163], a[48:51], v[68:71], a[160:163]
  v_mfma_f32_16x16x32_bf16 a[160:163], a[64:67], v[100:103], a[160:163]
  ds_read_b128 v[84:87], v9 offset:3104
  v_mfma_f32_16x16x32_bf16 a[164:167], a[68:71], v[100:103], a[164:167]
  v_mfma_f32_16x16x32_bf16 a[164:167], a[52:55], v[68:71], a[164:167]
  v_mfma_f32_16x16x32_bf16 a[172:175], a[52:55], v[100:103], a[172:175]
  buffer_load_dwordx4 v[140:143], v24, s[12:15], s74 offen offset:1024 sc1
  v_mfma_f32_16x16x32_bf16 a[172:175], a[68:71], v[64:67], a[172:175]
  v_mfma_f32_16x16x32_bf16 a[168:171], a[64:67], v[64:67], a[168:171]
  v_mfma_f32_16x16x32_bf16 a[168:171], a[48:51], v[100:103], a[168:171]
  v_mfma_f32_16x16x32_bf16 a[176:179], a[48:51], v[64:67], a[176:179]
  s_waitcnt lgkmcnt(3)
  v_mfma_f32_16x16x32_bf16 a[176:179], a[64:67], v[72:75], a[176:179]
  buffer_load_dwordx4 a[236:239], v13, s[12:15], s52 offen offset:1024 sc1
  v_mfma_f32_16x16x32_bf16 a[180:183], a[68:71], v[72:75], a[180:183]
  v_mfma_f32_16x16x32_bf16 a[180:183], a[52:55], v[64:67], a[180:183]
  v_mfma_f32_16x16x32_bf16 a[188:191], a[52:55], v[72:75], a[188:191]
  s_waitcnt lgkmcnt(2)
  v_mfma_f32_16x16x32_bf16 a[188:191], a[68:71], v[76:79], a[188:191]
  ds_read_b128 v[92:95], v9 offset:3360
  s_mov_b32 s52, 368640
  v_mfma_f32_16x16x32_bf16 a[184:187], a[64:67], v[76:79], a[184:187]
  buffer_load_dwordx4 a[240:243], v13, s[12:15], s52 offen offset:0 sc1
  v_mfma_f32_16x16x32_bf16 a[184:187], a[48:51], v[72:75], a[184:187]
  v_mfma_f32_16x16x32_bf16 a[128:131], a[80:83], v[60:63], a[128:131]
  v_mfma_f32_16x16x32_bf16 a[128:131], a[96:99], v[52:55], a[128:131]
  v_mfma_f32_16x16x32_bf16 a[132:135], a[100:103], v[52:55], a[132:135]
  v_mfma_f32_16x16x32_bf16 a[132:135], a[84:87], v[60:63], a[132:135]
  buffer_load_dwordx4 a[244:247], v13, s[12:15], s52 offen offset:1024 sc1
  v_mfma_f32_16x16x32_bf16 a[140:143], a[84:87], v[52:55], a[140:143]
  v_mfma_f32_16x16x32_bf16 a[140:143], a[100:103], v[68:71], a[140:143]
  v_mfma_f32_16x16x32_bf16 a[136:139], a[96:99], v[68:71], a[136:139]
  v_mfma_f32_16x16x32_bf16 a[136:139], a[80:83], v[52:55], a[136:139]
  s_mov_b32 s52, 376832
  v_mfma_f32_16x16x32_bf16 a[144:147], a[80:83], v[68:71], a[144:147]
  buffer_load_dwordx4 a[248:251], v13, s[12:15], s52 offen offset:0 sc1
  v_mfma_f32_16x16x32_bf16 a[144:147], a[96:99], v[100:103], a[144:147]
  ds_read_b128 v[88:91], v9 offset:3616
  v_mfma_f32_16x16x32_bf16 a[148:151], a[100:103], v[100:103], a[148:151]
  v_mfma_f32_16x16x32_bf16 a[148:151], a[84:87], v[68:71], a[148:151]
  v_mfma_f32_16x16x32_bf16 a[156:159], a[84:87], v[100:103], a[156:159]
  v_mfma_f32_16x16x32_bf16 a[156:159], a[100:103], v[64:67], a[156:159]
  buffer_load_dwordx4 a[252:255], v13, s[12:15], s52 offen offset:1024 sc1
  v_mfma_f32_16x16x32_bf16 a[152:155], a[96:99], v[64:67], a[152:155]
  v_mfma_f32_16x16x32_bf16 a[152:155], a[80:83], v[100:103], a[152:155]
  v_mfma_f32_16x16x32_bf16 a[160:163], a[80:83], v[64:67], a[160:163]
  v_mfma_f32_16x16x32_bf16 a[160:163], a[96:99], v[72:75], a[160:163]
  s_mov_b32 s52, 385024
  v_mfma_f32_16x16x32_bf16 a[164:167], a[100:103], v[72:75], a[164:167]
  buffer_load_dwordx4 a[8:11], v13, s[12:15], s52 offen offset:0 sc1
  v_mfma_f32_16x16x32_bf16 a[164:167], a[84:87], v[64:67], a[164:167]
  v_mfma_f32_16x16x32_bf16 a[172:175], a[84:87], v[72:75], a[172:175]
  v_mfma_f32_16x16x32_bf16 a[172:175], a[100:103], v[76:79], a[172:175]
  v_mfma_f32_16x16x32_bf16 a[168:171], a[96:99], v[76:79], a[168:171]
  v_mfma_f32_16x16x32_bf16 a[168:171], a[80:83], v[72:75], a[168:171]
  buffer_load_dwordx4 a[12:15], v13, s[12:15], s52 offen offset:1024 sc1
  v_mfma_f32_16x16x32_bf16 a[176:179], a[80:83], v[76:79], a[176:179]
  s_waitcnt lgkmcnt(3)
  v_mfma_f32_16x16x32_bf16 a[176:179], a[96:99], v[80:83], a[176:179]
  v_mfma_f32_16x16x32_bf16 a[180:183], a[100:103], v[80:83], a[180:183]
  v_mfma_f32_16x16x32_bf16 a[180:183], a[84:87], v[76:79], a[180:183]
  s_mov_b32 s52, 393216
  v_mfma_f32_16x16x32_bf16 a[188:191], a[84:87], v[80:83], a[188:191]
  buffer_load_dwordx4 a[24:27], v13, s[12:15], s52 offen offset:0 sc1
  s_waitcnt lgkmcnt(2)
  v_mfma_f32_16x16x32_bf16 a[188:191], a[100:103], v[84:87], a[188:191]
  v_mfma_f32_16x16x32_bf16 a[184:187], a[96:99], v[84:87], a[184:187]
  v_mfma_f32_16x16x32_bf16 a[184:187], a[80:83], v[80:83], a[184:187]
  v_mfma_f32_16x16x32_bf16 a[128:131], a[112:115], v[68:71], a[128:131]
  s_waitcnt vmcnt(16) lgkmcnt(0)
  s_barrier
  v_mfma_f32_16x16x32_bf16 a[128:131], a[192:195], v[100:103], a[128:131]
  ds_read_b128 v[96:99], v9 offset:35904
  buffer_load_dwordx4 a[28:31], v13, s[12:15], s52 offen offset:1024 sc1
  v_mfma_f32_16x16x32_bf16 a[132:135], a[196:199], v[100:103], a[132:135]
  ds_read_b128 v[108:111], v9 offset:36160
  v_mfma_f32_16x16x32_bf16 a[132:135], a[116:119], v[68:71], a[132:135]
  v_mfma_f32_16x16x32_bf16 a[140:143], a[116:119], v[100:103], a[140:143]
  ds_read_b128 v[104:107], v9 offset:36416
  v_mfma_f32_16x16x32_bf16 a[140:143], a[196:199], v[64:67], a[140:143]
  s_mov_b32 s52, 401408
  v_mfma_f32_16x16x32_bf16 a[136:139], a[192:195], v[64:67], a[136:139]
  ds_read_b128 v[116:119], v9 offset:36672
  buffer_load_dwordx4 a[40:43], v13, s[12:15], s52 offen offset:0 sc1
  v_mfma_f32_16x16x32_bf16 a[136:139], a[112:115], v[100:103], a[136:139]
  v_mfma_f32_16x16x32_bf16 a[144:147], a[112:115], v[64:67], a[144:147]
  ds_read_b128 v[48:51], v9 offset:36928
  v_mfma_f32_16x16x32_bf16 a[144:147], a[192:195], v[72:75], a[144:147]
  ds_read_b128 v[112:115], v9 offset:37184
  v_mfma_f32_16x16x32_bf16 a[148:151], a[196:199], v[72:75], a[148:151]
  v_mfma_f32_16x16x32_bf16 a[148:151], a[116:119], v[64:67], a[148:151]
  ds_read_b128 v[56:59], v9 offset:37440
  buffer_load_dwordx4 a[44:47], v13, s[12:15], s52 offen offset:1024 sc1
  v_mfma_f32_16x16x32_bf16 a[156:159], a[116:119], v[72:75], a[156:159]
  v_mfma_f32_16x16x32_bf16 a[156:159], a[196:199], v[76:79], a[156:159]
  ds_read_b128 v[60:63], v9 offset:37696
  v_mfma_f32_16x16x32_bf16 a[152:155], a[192:195], v[76:79], a[152:155]
  s_add_u32 m0, s29, 0
  v_mfma_f32_16x16x32_bf16 a[152:155], a[112:115], v[72:75], a[152:155]
  s_add_u32 s51, s49, 208896
  v_mfma_f32_16x16x32_bf16 a[160:163], a[112:115], v[76:79], a[160:163]
  buffer_load_dwordx4 v3, s[12:15], s51 offen sc1 lds
  v_mfma_f32_16x16x32_bf16 a[160:163], a[192:195], v[80:83], a[160:163]
  v_mfma_f32_16x16x32_bf16 a[164:167], a[196:199], v[80:83], a[164:167]
  v_mfma_f32_16x16x32_bf16 a[164:167], a[116:119], v[76:79], a[164:167]
  s_add_u32 m0, s29, 8320
  v_mfma_f32_16x16x32_bf16 a[172:175], a[116:119], v[80:83], a[172:175]
  s_add_u32 s51, s49, 217088
  v_mfma_f32_16x16x32_bf16 a[172:175], a[196:199], v[84:87], a[172:175]
  buffer_load_dwordx4 v3, s[12:15], s51 offen sc1 lds
  v_mfma_f32_16x16x32_bf16 a[168:171], a[192:195], v[84:87], a[168:171]
  v_mfma_f32_16x16x32_bf16 a[168:171], a[112:115], v[80:83], a[168:171]
  v_mfma_f32_16x16x32_bf16 a[176:179], a[112:115], v[84:87], a[176:179]
  s_add_u32 m0, s29, 16640
  v_mfma_f32_16x16x32_bf16 a[176:179], a[192:195], v[92:95], a[176:179]
  s_add_u32 s51, s49, 225280
  v_mfma_f32_16x16x32_bf16 a[180:183], a[196:199], v[92:95], a[180:183]
  buffer_load_dwordx4 v3, s[12:15], s51 offen sc1 lds
  v_mfma_f32_16x16x32_bf16 a[180:183], a[116:119], v[84:87], a[180:183]
  v_mfma_f32_16x16x32_bf16 a[188:191], a[116:119], v[92:95], a[188:191]
  v_mfma_f32_16x16x32_bf16 a[188:191], a[196:199], v[88:91], a[188:191]
  s_add_u32 m0, s29, 24960
  v_mfma_f32_16x16x32_bf16 a[184:187], a[192:195], v[88:91], a[184:187]
  s_add_u32 s51, s49, 233472
  v_mfma_f32_16x16x32_bf16 a[184:187], a[112:115], v[92:95], a[184:187]
  buffer_load_dwordx4 v3, s[12:15], s51 offen sc1 lds
  s_waitcnt lgkmcnt(7)
  v_mfma_f32_16x16x32_bf16 a[128:131], a[200:203], v[96:99], a[128:131]
  s_waitcnt lgkmcnt(6)
  v_mfma_f32_16x16x32_bf16 a[128:131], a[208:211], v[108:111], a[128:131]
  ds_read_b128 v[52:55], v9 offset:37984
  v_mfma_f32_16x16x32_bf16 a[132:135], a[212:215], v[108:111], a[132:135]
  s_add_u32 m0, s29, 1024
  v_mfma_f32_16x16x32_bf16 a[132:135], a[204:207], v[96:99], a[132:135]
  s_add_u32 s51, s49, 209920
  v_mfma_f32_16x16x32_bf16 a[140:143], a[204:207], v[108:111], a[140:143]
  buffer_load_dwordx4 v3, s[12:15], s51 offen sc1 lds
  s_waitcnt lgkmcnt(6)
  v_mfma_f32_16x16x32_bf16 a[140:143], a[212:215], v[104:107], a[140:143]
  v_mfma_f32_16x16x32_bf16 a[136:139], a[208:211], v[104:107], a[136:139]
  v_mfma_f32_16x16x32_bf16 a[136:139], a[200:203], v[108:111], a[136:139]
  s_add_u32 m0, s29, 9344
  v_mfma_f32_16x16x32_bf16 a[144:147], a[200:203], v[104:107], a[144:147]
  s_add_u32 s51, s49, 218112
  s_waitcnt lgkmcnt(5)
  v_mfma_f32_16x16x32_bf16 a[144:147], a[208:211], v[116:119], a[144:147]
  buffer_load_dwordx4 v3, s[12:15], s51 offen sc1 lds
  v_mfma_f32_16x16x32_bf16 a[148:151], a[212:215], v[116:119], a[148:151]
  v_mfma_f32_16x16x32_bf16 a[148:151], a[204:207], v[104:107], a[148:151]
  v_mfma_f32_16x16x32_bf16 a[156:159], a[204:207], v[116:119], a[156:159]
  s_add_u32 m0, s29, 17664
  s_waitcnt lgkmcnt(4)
  v_mfma_f32_16x16x32_bf16 a[156:159], a[212:215], v[48:51], a[156:159]
  ds_read_b128 v[68:71], v9 offset:38240
  s_add_u32 s51, s49, 226304
  v_mfma_f32_16x16x32_bf16 a[152:155], a[208:211], v[48:51], a[152:155]
  buffer_load_dwordx4 v3, s[12:15], s51 offen sc1 lds
  v_mfma_f32_16x16x32_bf16 a[152:155], a[200:203], v[116:119], a[152:155]
  v_mfma_f32_16x16x32_bf16 a[160:163], a[200:203], v[48:51], a[160:163]
  s_waitcnt lgkmcnt(4)
  v_mfma_f32_16x16x32_bf16 a[160:163], a[208:211], v[112:115], a[160:163]
  s_add_u32 m0, s29, 25984
  v_mfma_f32_16x16x32_bf16 a[164:167], a[212:215], v[112:115], a[164:167]
  s_add_u32 s51, s49, 234496
  v_mfma_f32_16x16x32_bf16 a[164:167], a[204:207], v[48:51], a[164:167]
  buffer_load_dwordx4 v3, s[12:15], s51 offen sc1 lds
  v_mfma_f32_16x16x32_bf16 a[172:175], a[204:207], v[112:115], a[172:175]
  s_waitcnt lgkmcnt(3)
  v_mfma_f32_16x16x32_bf16 a[172:175], a[212:215], v[56:59], a[172:175]
  v_mfma_f32_16x16x32_bf16 a[168:171], a[208:211], v[56:59], a[168:171]
  s_mov_b32 m0, s30
  v_mfma_f32_16x16x32_bf16 a[168:171], a[200:203], v[112:115], a[168:171]
  s_add_u32 s51, s49, 241664
  v_mfma_f32_16x16x32_bf16 a[176:179], a[200:203], v[56:59], a[176:179]
  buffer_load_dwordx4 v4, s[12:15], s51 offen sc1 lds
  s_waitcnt lgkmcnt(2)
  v_mfma_f32_16x16x32_bf16 a[176:179], a[208:211], v[60:63], a[176:179]
  ds_read_b128 v[100:103], v9 offset:38496
  v_mfma_f32_16x16x32_bf16 a[180:183], a[212:215], v[60:63], a[180:183]
  v_mfma_f32_16x16x32_bf16 a[180:183], a[204:207], v[56:59], a[180:183]
  v_mfma_f32_16x16x32_bf16 a[188:191], a[204:207], v[60:63], a[188:191]
  s_mov_b32 s52, 409600
  s_waitcnt lgkmcnt(2)
  v_mfma_f32_16x16x32_bf16 a[188:191], a[212:215], v[52:55], a[188:191]
  buffer_load_dwordx4 a[56:59], v13, s[12:15], s52 offen offset:0 sc1
  v_mfma_f32_16x16x32_bf16 a[184:187], a[208:211], v[52:55], a[184:187]
  v_mfma_f32_16x16x32_bf16 a[184:187], a[200:203], v[60:63], a[184:187]
  v_mfma_f32_16x16x32_bf16 a[128:131], a[216:219], v[104:107], a[128:131]
  v_mfma_f32_16x16x32_bf16 a[128:131], a[224:227], v[116:119], a[128:131]
  s_waitcnt vmcnt(28)
  v_mfma_f32_16x16x32_bf16 a[132:135], a[228:231], v[116:119], a[132:135]
  buffer_load_dwordx4 a[60:63], v13, s[12:15], s52 offen offset:1024 sc1
  v_mfma_f32_16x16x32_bf16 a[132:135], a[220:223], v[104:107], a[132:135]
  v_mfma_f32_16x16x32_bf16 a[140:143], a[220:223], v[116:119], a[140:143]
  s_waitcnt vmcnt(27)
  v_lshlrev_b32 v152, 16, v120
  v_mfma_f32_16x16x32_bf16 a[140:143], a[228:231], v[48:51], a[140:143]
  s_waitcnt vmcnt(25)
  ds_read_b128 v[64:67], v9 offset:38752
  v_lshlrev_b32 v168, 16, v128
  v_mfma_f32_16x16x32_bf16 a[136:139], a[224:227], v[48:51], a[136:139]
  s_mov_b32 s52, 417792
  v_and_b32 v153, 0xffff0000, v120
  v_mfma_f32_16x16x32_bf16 a[136:139], a[216:219], v[116:119], a[136:139]
  buffer_load_dwordx4 a[72:75], v13, s[12:15], s52 offen offset:0 sc1
  v_and_b32 v169, 0xffff0000, v128
  v_mfma_f32_16x16x32_bf16 a[144:147], a[216:219], v[48:51], a[144:147]
  v_lshlrev_b32 v154, 16, v121
  v_mfma_f32_16x16x32_bf16 a[144:147], a[224:227], v[112:115], a[144:147]
  v_lshlrev_b32 v170, 16, v129
  v_mfma_f32_16x16x32_bf16 a[148:151], a[228:231], v[112:115], a[148:151]
  v_and_b32 v155, 0xffff0000, v121
  v_mfma_f32_16x16x32_bf16 a[148:151], a[220:223], v[48:51], a[148:151]
  v_and_b32 v171, 0xffff0000, v129
  v_mfma_f32_16x16x32_bf16 a[156:159], a[220:223], v[112:115], a[156:159]
  buffer_load_dwordx4 a[76:79], v13, s[12:15], s52 offen offset:1024 sc1
  v_add_f32 v152, v152, v168
  v_mfma_f32_16x16x32_bf16 a[156:159], a[228:231], v[56:59], a[156:159]
  v_add_f32 v153, v153, v169
  v_mfma_f32_16x16x32_bf16 a[152:155], a[224:227], v[56:59], a[152:155]
  v_add_f32 v154, v154, v170
  v_mfma_f32_16x16x32_bf16 a[152:155], a[216:219], v[112:115], a[152:155]
  v_add_f32 v155, v155, v171
  v_mfma_f32_16x16x32_bf16 a[160:163], a[216:219], v[56:59], a[160:163]
  s_mov_b32 s52, 425984
  ds_write_b128 v34, v[152:155] offset:0
  v_mfma_f32_16x16x32_bf16 a[160:163], a[224:227], v[60:63], a[160:163]
  ds_read_b128 v[72:75], v9 offset:39008
  buffer_load_dwordx4 a[88:91], v13, s[12:15], s52 offen offset:0 sc1
  v_mfma_f32_16x16x32_bf16 a[164:167], a[228:231], v[60:63], a[164:167]
  v_lshlrev_b32 v156, 16, v122
  v_mfma_f32_16x16x32_bf16 a[164:167], a[220:223], v[56:59], a[164:167]
  v_lshlrev_b32 v172, 16, v130
  v_mfma_f32_16x16x32_bf16 a[172:175], a[220:223], v[60:63], a[172:175]
  v_and_b32 v157, 0xffff0000, v122
  v_mfma_f32_16x16x32_bf16 a[172:175], a[228:231], v[52:55], a[172:175]
  v_and_b32 v173, 0xffff0000, v130
  v_mfma_f32_16x16x32_bf16 a[168:171], a[224:227], v[52:55], a[168:171]
  buffer_load_dwordx4 a[92:95], v13, s[12:15], s52 offen offset:1024 sc1
  v_lshlrev_b32 v158, 16, v123
  v_mfma_f32_16x16x32_bf16 a[168:171], a[216:219], v[60:63], a[168:171]
  v_lshlrev_b32 v174, 16, v131
  v_mfma_f32_16x16x32_bf16 a[176:179], a[216:219], v[52:55], a[176:179]
  s_waitcnt lgkmcnt(4)
  v_and_b32 v159, 0xffff0000, v123
  v_mfma_f32_16x16x32_bf16 a[176:179], a[224:227], v[68:71], a[176:179]
  v_and_b32 v175, 0xffff0000, v131
  v_mfma_f32_16x16x32_bf16 a[180:183], a[228:231], v[68:71], a[180:183]
  s_mov_b32 s52, 434176
  v_add_f32 v156, v156, v172
  v_mfma_f32_16x16x32_bf16 a[180:183], a[220:223], v[52:55], a[180:183]
  buffer_load_dwordx4 a[104:107], v13, s[12:15], s52 offen offset:0 sc1
  v_add_f32 v157, v157, v173
  v_mfma_f32_16x16x32_bf16 a[188:191], a[220:223], v[68:71], a[188:191]
  s_waitcnt lgkmcnt(3)
  v_add_f32 v158, v158, v174
  v_mfma_f32_16x16x32_bf16 a[188:191], a[228:231], v[100:103], a[188:191]
  ds_read_b128 v[76:79], v9 offset:39264
  v_add_f32 v159, v159, v175
  v_mfma_f32_16x16x32_bf16 a[184:187], a[224:227], v[100:103], a[184:187]
  ds_write_b128 v34, v[156:159] offset:1024
  v_mfma_f32_16x16x32_bf16 a[184:187], a[216:219], v[68:71], a[184:187]
  v_lshlrev_b32 v160, 16, v124
  v_mfma_f32_16x16x32_bf16 a[128:131], a[232:235], v[48:51], a[128:131]
  buffer_load_dwordx4 a[108:111], v13, s[12:15], s52 offen offset:1024 sc1
  s_waitcnt vmcnt(30)
  s_waitcnt vmcnt(26)
  v_mfma_f32_16x16x32_bf16 a[128:131], a[240:243], v[112:115], a[128:131]
  s_waitcnt vmcnt(25)
  v_lshlrev_b32 v176, 16, v132
  v_and_b32 v161, 0xffff0000, v124
  v_mfma_f32_16x16x32_bf16 a[132:135], a[244:247], v[112:115], a[132:135]
  v_and_b32 v177, 0xffff0000, v132
  v_mfma_f32_16x16x32_bf16 a[132:135], a[236:239], v[48:51], a[132:135]
  v_lshlrev_b32 v162, 16, v125
  v_mfma_f32_16x16x32_bf16 a[140:143], a[236:239], v[112:115], a[140:143]
  s_mov_b32 s52, 442368
  v_lshlrev_b32 v178, 16, v133
  v_mfma_f32_16x16x32_bf16 a[140:143], a[244:247], v[56:59], a[140:143]
  buffer_load_dwordx4 a[120:123], v13, s[12:15], s52 offen offset:0 sc1
  v_and_b32 v163, 0xffff0000, v125
  v_mfma_f32_16x16x32_bf16 a[136:139], a[240:243], v[56:59], a[136:139]
  v_and_b32 v179, 0xffff0000, v133
  v_mfma_f32_16x16x32_bf16 a[136:139], a[232:235], v[112:115], a[136:139]
  v_add_f32 v160, v160, v176
  v_mfma_f32_16x16x32_bf16 a[144:147], a[232:235], v[56:59], a[144:147]
  v_add_f32 v161, v161, v177
  v_mfma_f32_16x16x32_bf16 a[144:147], a[240:243], v[60:63], a[144:147]
  ds_read_b128 v[80:83], v9 offset:39520
  v_add_f32 v162, v162, v178
  v_mfma_f32_16x16x32_bf16 a[148:151], a[244:247], v[60:63], a[148:151]
  buffer_load_dwordx4 a[124:127], v13, s[12:15], s52 offen offset:1024 sc1
  v_add_f32 v163, v163, v179
  v_mfma_f32_16x16x32_bf16 a[148:151], a[236:239], v[56:59], a[148:151]
  ds_write_b128 v34, v[160:163] offset:2048
  v_mfma_f32_16x16x32_bf16 a[156:159], a[236:239], v[60:63], a[156:159]
  v_lshlrev_b32 v164, 16, v126
  v_mfma_f32_16x16x32_bf16 a[156:159], a[244:247], v[52:55], a[156:159]
  v_lshlrev_b32 v180, 16, v134
  v_mfma_f32_16x16x32_bf16 a[152:155], a[240:243], v[52:55], a[152:155]
  s_mov_b32 s52, 450560
  v_and_b32 v165, 0xffff0000, v126
  v_mfma_f32_16x16x32_bf16 a[152:155], a[232:235], v[60:63], a[152:155]
  buffer_load_dwordx4 a[0:3], v13, s[12:15], s52 offen offset:0 sc1
  v_and_b32 v181, 0xffff0000, v134
  v_mfma_f32_16x16x32_bf16 a[160:163], a[232:235], v[52:55], a[160:163]
  v_lshlrev_b32 v166, 16, v127
  v_mfma_f32_16x16x32_bf16 a[160:163], a[240:243], v[68:71], a[160:163]
  v_lshlrev_b32 v182, 16, v135
  v_mfma_f32_16x16x32_bf16 a[164:167], a[244:247], v[68:71], a[164:167]
  v_and_b32 v167, 0xffff0000, v127
  v_mfma_f32_16x16x32_bf16 a[164:167], a[236:239], v[52:55], a[164:167]
  v_and_b32 v183, 0xffff0000, v135
  v_mfma_f32_16x16x32_bf16 a[172:175], a[236:239], v[68:71], a[172:175]
  buffer_load_dwordx4 a[4:7], v13, s[12:15], s52 offen offset:1024 sc1
  v_add_f32 v164, v164, v180
  v_mfma_f32_16x16x32_bf16 a[172:175], a[244:247], v[100:103], a[172:175]
  v_add_f32 v165, v165, v181
  v_mfma_f32_16x16x32_bf16 a[168:171], a[240:243], v[100:103], a[168:171]
  v_add_f32 v166, v166, v182
  v_mfma_f32_16x16x32_bf16 a[168:171], a[232:235], v[68:71], a[168:171]
  v_add_f32 v167, v167, v183
  v_mfma_f32_16x16x32_bf16 a[176:179], a[232:235], v[100:103], a[176:179]
  s_mov_b32 s52, 458752
  ds_write_b128 v34, v[164:167] offset:3072
  s_waitcnt lgkmcnt(7)
  v_mfma_f32_16x16x32_bf16 a[176:179], a[240:243], v[64:67], a[176:179]
  buffer_load_dwordx4 a[16:19], v13, s[12:15], s52 offen offset:0 sc1
  v_lshlrev_b32 v168, 16, v136
  v_mfma_f32_16x16x32_bf16 a[180:183], a[244:247], v[64:67], a[180:183]
  v_and_b32 v169, 0xffff0000, v136
  v_mfma_f32_16x16x32_bf16 a[180:183], a[236:239], v[100:103], a[180:183]
  v_lshlrev_b32 v170, 16, v137
  v_mfma_f32_16x16x32_bf16 a[188:191], a[236:239], v[64:67], a[188:191]
  s_waitcnt lgkmcnt(5)
  v_and_b32 v171, 0xffff0000, v137
  v_mfma_f32_16x16x32_bf16 a[188:191], a[244:247], v[72:75], a[188:191]
  v_add_f32 v184, v184, v168
  v_mfma_f32_16x16x32_bf16 a[184:187], a[240:243], v[72:75], a[184:187]
  buffer_load_dwordx4 a[20:23], v13, s[12:15], s52 offen offset:1024 sc1
  v_add_f32 v185, v185, v169
  v_mfma_f32_16x16x32_bf16 a[184:187], a[232:235], v[64:67], a[184:187]
  s_waitcnt vmcnt(30)
  v_add_f32 v186, v186, v170
  v_mfma_f32_16x16x32_bf16 a[128:131], a[248:251], v[56:59], a[128:131]
  s_waitcnt vmcnt(14) lgkmcnt(2)
  s_barrier
  v_mfma_f32_16x16x32_bf16 a[128:131], a[8:11], v[60:63], a[128:131]
  s_add_u32 m0, s29, 35904
  ds_read_b128 v[84:87], v9 offset:0
  v_add_f32 v187, v187, v171
  v_mfma_f32_16x16x32_bf16 a[132:135], a[12:15], v[60:63], a[132:135]
  ds_read_b128 v[88:91], v9 offset:256
  s_add_u32 s51, s49, 243712
  v_mfma_f32_16x16x32_bf16 a[132:135], a[252:255], v[56:59], a[132:135]
  buffer_load_dwordx4 v3, s[12:15], s51 offen sc1 lds
  ds_write_b128 v32, v[184:187] offset:0
  v_mfma_f32_16x16x32_bf16 a[140:143], a[252:255], v[60:63], a[140:143]
  ds_read_b128 v[92:95], v9 offset:512
  v_lshlrev_b32 v172, 16, v138
  v_mfma_f32_16x16x32_bf16 a[140:143], a[12:15], v[52:55], a[140:143]
  v_and_b32 v173, 0xffff0000, v138
  v_mfma_f32_16x16x32_bf16 a[136:139], a[8:11], v[52:55], a[136:139]
  ds_read_b128 v[96:99], v9 offset:768
  v_lshlrev_b32 v174, 16, v139
  v_mfma_f32_16x16x32_bf16 a[136:139], a[248:251], v[60:63], a[136:139]
  s_mov_b32 s52, 466944
  v_and_b32 v175, 0xffff0000, v139
  v_mfma_f32_16x16x32_bf16 a[144:147], a[248:251], v[52:55], a[144:147]
  ds_read_b128 v[108:111], v9 offset:1024
  buffer_load_dwordx4 a[32:35], v13, s[12:15], s52 offen offset:0 sc1
  v_mfma_f32_16x16x32_bf16 a[144:147], a[8:11], v[68:71], a[144:147]
  ds_read_b128 v[104:107], v9 offset:1280
  v_add_f32 v188, v188, v172
  v_mfma_f32_16x16x32_bf16 a[148:151], a[12:15], v[68:71], a[148:151]
  v_add_f32 v189, v189, v173
  v_mfma_f32_16x16x32_bf16 a[148:151], a[252:255], v[52:55], a[148:151]
  ds_read_b128 v[116:119], v9 offset:1536
  v_add_f32 v190, v190, v174
  v_mfma_f32_16x16x32_bf16 a[156:159], a[252:255], v[68:71], a[156:159]
  v_add_f32 v191, v191, v175
  v_mfma_f32_16x16x32_bf16 a[156:159], a[12:15], v[100:103], a[156:159]
  ds_read_b128 v[48:51], v9 offset:1792
  buffer_load_dwordx4 a[36:39], v13, s[12:15], s52 offen offset:1024 sc1
  v_mfma_f32_16x16x32_bf16 a[152:155], a[8:11], v[100:103], a[152:155]
  ds_write_b128 v32, v[188:191] offset:1024
  v_mfma_f32_16x16x32_bf16 a[152:155], a[248:251], v[68:71], a[152:155]
  v_lshlrev_b32 v176, 16, v140
  v_mfma_f32_16x16x32_bf16 a[160:163], a[248:251], v[100:103], a[160:163]
  s_add_u32 m0, s29, 44224
  v_and_b32 v177, 0xffff0000, v140
  v_mfma_f32_16x16x32_bf16 a[160:163], a[8:11], v[64:67], a[160:163]
  s_add_u32 s51, s49, 251904
  v_lshlrev_b32 v178, 16, v141
  v_mfma_f32_16x16x32_bf16 a[164:167], a[12:15], v[64:67], a[164:167]
  buffer_load_dwordx4 v3, s[12:15], s51 offen sc1 lds
  v_and_b32 v179, 0xffff0000, v141
  v_mfma_f32_16x16x32_bf16 a[164:167], a[252:255], v[100:103], a[164:167]
  v_add_f32 v192, v192, v176
  v_mfma_f32_16x16x32_bf16 a[172:175], a[252:255], v[64:67], a[172:175]
  v_add_f32 v193, v193, v177
  v_mfma_f32_16x16x32_bf16 a[172:175], a[12:15], v[72:75], a[172:175]
  v_add_f32 v194, v194, v178
  v_mfma_f32_16x16x32_bf16 a[168:171], a[8:11], v[72:75], a[168:171]
  s_mov_b32 s52, 475136
  v_add_f32 v195, v195, v179
  v_mfma_f32_16x16x32_bf16 a[168:171], a[248:251], v[64:67], a[168:171]
  buffer_load_dwordx4 a[48:51], v13, s[12:15], s52 offen offset:0 sc1
  ds_write_b128 v32, v[192:195] offset:2048
  v_mfma_f32_16x16x32_bf16 a[176:179], a[248:251], v[72:75], a[176:179]
  v_lshlrev_b32 v180, 16, v142
  v_mfma_f32_16x16x32_bf16 a[176:179], a[8:11], v[76:79], a[176:179]
  v_and_b32 v181, 0xffff0000, v142
  v_mfma_f32_16x16x32_bf16 a[180:183], a[12:15], v[76:79], a[180:183]
  v_lshlrev_b32 v182, 16, v143
  v_mfma_f32_16x16x32_bf16 a[180:183], a[252:255], v[72:75], a[180:183]
  v_and_b32 v183, 0xffff0000, v143
  v_mfma_f32_16x16x32_bf16 a[188:191], a[252:255], v[76:79], a[188:191]
  buffer_load_dwordx4 a[52:55], v13, s[12:15], s52 offen offset:1024 sc1
  v_add_f32 v196, v196, v180
  v_mfma_f32_16x16x32_bf16 a[188:191], a[12:15], v[80:83], a[188:191]
  v_add_f32 v197, v197, v181
  v_mfma_f32_16x16x32_bf16 a[184:187], a[8:11], v[80:83], a[184:187]
  v_add_f32 v198, v198, v182
  v_mfma_f32_16x16x32_bf16 a[184:187], a[248:251], v[76:79], a[184:187]
  s_add_u32 m0, s29, 52544
  s_waitcnt lgkmcnt(10)
  v_add_f32 v199, v199, v183
  v_mfma_f32_16x16x32_bf16 a[128:131], a[24:27], v[84:87], a[128:131]
  s_add_u32 s51, s49, 260096
  ds_write_b128 v32, v[196:199] offset:3072
  s_waitcnt lgkmcnt(10)
  v_mfma_f32_16x16x32_bf16 a[128:131], a[40:43], v[88:91], a[128:131]
  ds_read_b128 v[112:115], v9 offset:2080
  buffer_load_dwordx4 v3, s[12:15], s51 offen sc1 lds
  v_mfma_f32_16x16x32_bf16 a[132:135], a[44:47], v[88:91], a[132:135]
  v_mfma_f32_16x16x32_bf16 a[132:135], a[28:31], v[84:87], a[132:135]
  v_mfma_f32_16x16x32_bf16 a[140:143], a[28:31], v[88:91], a[140:143]
  s_add_u32 m0, s29, 60864
  s_waitcnt lgkmcnt(9)
  v_mfma_f32_16x16x32_bf16 a[140:143], a[44:47], v[92:95], a[140:143]
  s_add_u32 s51, s49, 268288
  v_mfma_f32_16x16x32_bf16 a[136:139], a[40:43], v[92:95], a[136:139]
  buffer_load_dwordx4 v3, s[12:15], s51 offen sc1 lds
  v_mfma_f32_16x16x32_bf16 a[136:139], a[24:27], v[88:91], a[136:139]
  v_mfma_f32_16x16x32_bf16 a[144:147], a[24:27], v[92:95], a[144:147]
  s_waitcnt lgkmcnt(8)
  v_mfma_f32_16x16x32_bf16 a[144:147], a[40:43], v[96:99], a[144:147]
  v_mfma_f32_16x16x32_bf16 a[148:151], a[44:47], v[96:99], a[148:151]
  s_mov_b32 s52, 483328
  v_mfma_f32_16x16x32_bf16 a[148:151], a[28:31], v[92:95], a[148:151]
  buffer_load_dwordx4 a[64:67], v13, s[12:15], s52 offen offset:0 sc1
  v_mfma_f32_16x16x32_bf16 a[156:159], a[28:31], v[96:99], a[156:159]
  s_waitcnt lgkmcnt(1)
  s_barrier
  v_mfma_f32_16x16x32_bf16 a[156:159], a[44:47], v[108:111], a[156:159]
  ds_read_b128 v[56:59], v9 offset:2336
  ds_read_b128 v[152:155], v31 offset:0
  v_mfma_f32_16x16x32_bf16 a[152:155], a[40:43], v[108:111], a[152:155]
  v_mfma_f32_16x16x32_bf16 a[152:155], a[24:27], v[96:99], a[152:155]
  v_mfma_f32_16x16x32_bf16 a[160:163], a[24:27], v[108:111], a[160:163]
  buffer_load_dwordx4 a[68:71], v13, s[12:15], s52 offen offset:1024 sc1
  ds_read_b128 v[160:163], v31 offset:4096
  v_mfma_f32_16x16x32_bf16 a[160:163], a[40:43], v[104:107], a[160:163]
  v_mfma_f32_16x16x32_bf16 a[164:167], a[44:47], v[104:107], a[164:167]
  v_mfma_f32_16x16x32_bf16 a[164:167], a[28:31], v[108:111], a[164:167]
  s_add_u32 m0, s29, 36928
  ds_read_b128 v[156:159], v31 offset:256
  v_mfma_f32_16x16x32_bf16 a[172:175], a[28:31], v[104:107], a[172:175]
  s_add_u32 s51, s49, 244736
  v_mfma_f32_16x16x32_bf16 a[172:175], a[44:47], v[116:119], a[172:175]
  buffer_load_dwordx4 v3, s[12:15], s51 offen sc1 lds
  v_mfma_f32_16x16x32_bf16 a[168:171], a[40:43], v[116:119], a[168:171]
  ds_read_b128 v[164:167], v31 offset:4352
  v_mfma_f32_16x16x32_bf16 a[168:171], a[24:27], v[104:107], a[168:171]
  v_mfma_f32_16x16x32_bf16 a[176:179], a[24:27], v[116:119], a[176:179]
  s_add_u32 m0, s29, 45248
  v_mfma_f32_16x16x32_bf16 a[176:179], a[40:43], v[48:51], a[176:179]
  ds_read_b128 v[60:63], v9 offset:2592
  s_add_u32 s51, s49, 252928
  v_mfma_f32_16x16x32_bf16 a[180:183], a[44:47], v[48:51], a[180:183]
  buffer_load_dwordx4 v3, s[12:15], s51 offen sc1 lds
  ds_read_b128 v[216:219], v25 offset:0
  v_mfma_f32_16x16x32_bf16 a[180:183], a[28:31], v[116:119], a[180:183]
  v_mfma_f32_16x16x32_bf16 a[188:191], a[28:31], v[48:51], a[188:191]
  s_waitcnt lgkmcnt(7)
  v_mfma_f32_16x16x32_bf16 a[188:191], a[44:47], v[112:115], a[188:191]
  ds_read_b128 v[168:171], v25 offset:4096
  v_mfma_f32_16x16x32_bf16 a[184:187], a[40:43], v[112:115], a[184:187]
  s_mov_b32 s52, 491520
  v_mfma_f32_16x16x32_bf16 a[184:187], a[24:27], v[48:51], a[184:187]
  buffer_load_dwordx4 a[80:83], v13, s[12:15], s52 offen offset:0 sc1
  s_waitcnt vmcnt(26)
  v_mfma_f32_16x16x32_bf16 a[128:131], a[56:59], v[92:95], a[128:131]
  ds_read_b128 v[220:223], v25 offset:256
  s_waitcnt vmcnt(24)
  v_mfma_f32_16x16x32_bf16 a[128:131], a[72:75], v[96:99], a[128:131]
  s_waitcnt vmcnt(23)
  v_mfma_f32_16x16x32_bf16 a[132:135], a[76:79], v[96:99], a[132:135]
  v_mfma_f32_16x16x32_bf16 a[132:135], a[60:63], v[92:95], a[132:135]
  ds_read_b128 v[172:175], v25 offset:4352
  v_mfma_f32_16x16x32_bf16 a[140:143], a[60:63], v[96:99], a[140:143]
  buffer_load_dwordx4 a[84:87], v13, s[12:15], s52 offen offset:1024 sc1
  v_mfma_f32_16x16x32_bf16 a[140:143], a[76:79], v[108:111], a[140:143]
  ds_read_b128 v[52:55], v9 offset:2848
  v_mfma_f32_16x16x32_bf16 a[136:139], a[72:75], v[108:111], a[136:139]
  ds_read_b128 v[224:227], v25 offset:2048
  v_mfma_f32_16x16x32_bf16 a[136:139], a[56:59], v[96:99], a[136:139]
  s_add_u32 m0, s29, 53568
  v_mfma_f32_16x16x32_bf16 a[144:147], a[56:59], v[108:111], a[144:147]
  s_add_u32 s51, s49, 261120
  v_mfma_f32_16x16x32_bf16 a[144:147], a[72:75], v[104:107], a[144:147]
  buffer_load_dwordx4 v3, s[12:15], s51 offen sc1 lds
  ds_read_b128 v[176:179], v25 offset:6144
  v_mfma_f32_16x16x32_bf16 a[148:151], a[76:79], v[104:107], a[148:151]
  v_mfma_f32_16x16x32_bf16 a[148:151], a[60:63], v[108:111], a[148:151]
  v_mfma_f32_16x16x32_bf16 a[156:159], a[60:63], v[104:107], a[156:159]
  s_add_u32 m0, s29, 61888
  ds_read_b128 v[228:231], v25 offset:2304
  v_mfma_f32_16x16x32_bf16 a[156:159], a[76:79], v[116:119], a[156:159]
  s_add_u32 s51, s49, 269312
  v_mfma_f32_16x16x32_bf16 a[152:155], a[72:75], v[116:119], a[152:155]
  buffer_load_dwordx4 v3, s[12:15], s51 offen sc1 lds
  v_mfma_f32_16x16x32_bf16 a[152:155], a[56:59], v[104:107], a[152:155]
  ds_read_b128 v[180:183], v25 offset:6400
  v_mfma_f32_16x16x32_bf16 a[160:163], a[56:59], v[116:119], a[160:163]
  v_mfma_f32_16x16x32_bf16 a[160:163], a[72:75], v[48:51], a[160:163]
  ds_read_b128 v[68:71], v9 offset:3104
  v_mfma_f32_16x16x32_bf16 a[164:167], a[76:79], v[48:51], a[164:167]
  s_mov_b32 s52, 499712
  ds_read_b128 v[184:187], v27 offset:0
  v_mfma_f32_16x16x32_bf16 a[164:167], a[60:63], v[116:119], a[164:167]
  buffer_load_dwordx4 a[96:99], v13, s[12:15], s52 offen offset:0 sc1
  v_mfma_f32_16x16x32_bf16 a[172:175], a[60:63], v[48:51], a[172:175]
  v_mfma_f32_16x16x32_bf16 a[172:175], a[76:79], v[112:115], a[172:175]
  ds_read_b128 v[188:191], v27 offset:256
  v_mfma_f32_16x16x32_bf16 a[168:171], a[72:75], v[112:115], a[168:171]
  v_mfma_f32_16x16x32_bf16 a[168:171], a[56:59], v[48:51], a[168:171]
  v_mfma_f32_16x16x32_bf16 a[176:179], a[56:59], v[112:115], a[176:179]
  buffer_load_dwordx4 a[100:103], v13, s[12:15], s52 offen offset:1024 sc1
  ds_read_b32 v248, v33
  s_waitcnt lgkmcnt(15)
  v_mfma_f32_16x16x32_bf16 a[176:179], a[72:75], v[56:59], a[176:179]
  v_mfma_f32_16x16x32_bf16 a[180:183], a[76:79], v[56:59], a[180:183]
  v_mfma_f32_16x16x32_bf16 a[180:183], a[60:63], v[112:115], a[180:183]
  s_mov_b32 m0, s31
  ds_read_b32 v249, v33 offset:4096
  v_mfma_f32_16x16x32_bf16 a[188:191], a[60:63], v[56:59], a[188:191]
  s_add_u32 s51, s49, 276480
  s_waitcnt lgkmcnt(14)
  v_mfma_f32_16x16x32_bf16 a[188:191], a[76:79], v[60:63], a[188:191]
  ds_read_b128 v[100:103], v9 offset:3360
  buffer_load_dwordx4 v4, s[12:15], s51 offen sc1 lds
  v_mfma_f32_16x16x32_bf16 a[184:187], a[72:75], v[60:63], a[184:187]
  v_mfma_f32_16x16x32_bf16 a[184:187], a[56:59], v[56:59], a[184:187]
  s_waitcnt vmcnt(28)
  v_mfma_f32_16x16x32_bf16 a[128:131], a[88:91], v[108:111], a[128:131]
  s_waitcnt vmcnt(26)
  v_mfma_f32_16x16x32_bf16 a[128:131], a[104:107], v[104:107], a[128:131]
  s_waitcnt vmcnt(25)
  v_add_f32 v152, v152, v160
  v_mfma_f32_16x16x32_bf16 a[132:135], a[108:111], v[104:107], a[132:135]
  s_mov_b32 s52, 507904
  v_add_f32 v153, v153, v161
  v_mfma_f32_16x16x32_bf16 a[132:135], a[92:95], v[108:111], a[132:135]
  buffer_load_dwordx4 a[192:195], v13, s[12:15], s52 offen offset:0 sc1
  v_add_f32 v154, v154, v162
  v_mfma_f32_16x16x32_bf16 a[140:143], a[92:95], v[104:107], a[140:143]
  v_add_f32 v155, v155, v163
  v_mfma_f32_16x16x32_bf16 a[140:143], a[108:111], v[116:119], a[140:143]
  v_add_f32 v156, v156, v164
  v_mfma_f32_16x16x32_bf16 a[136:139], a[104:107], v[116:119], a[136:139]
  v_add_f32 v157, v157, v165
  v_mfma_f32_16x16x32_bf16 a[136:139], a[88:91], v[104:107], a[136:139]
  v_add_f32 v158, v158, v166
  v_mfma_f32_16x16x32_bf16 a[144:147], a[88:91], v[116:119], a[144:147]
  buffer_load_dwordx4 a[196:199], v13, s[12:15], s52 offen offset:1024 sc1
  v_add_f32 v159, v159, v167
  v_mfma_f32_16x16x32_bf16 a[144:147], a[104:107], v[48:51], a[144:147]
  s_waitcnt lgkmcnt(13)
  ds_read_b128 v[64:67], v9 offset:3616
  s_waitcnt lgkmcnt(10)
  v_mfma_f32_16x16x32_bf16 a[148:151], a[108:111], v[48:51], a[148:151]
  v_sub_f32 v232, -v168, v224
  v_sub_f32 v233, -v169, v225
  v_mfma_f32_16x16x32_bf16 a[148:151], a[92:95], v[116:119], a[148:151]
  v_sub_f32 v234, -v170, v226
  v_mfma_f32_16x16x32_bf16 a[156:159], a[92:95], v[48:51], a[156:159]
  v_sub_f32 v235, -v171, v227
  v_mfma_f32_16x16x32_bf16 a[156:159], a[108:111], v[112:115], a[156:159]
  s_waitcnt lgkmcnt(8)
  v_sub_f32 v236, -v172, v228
  v_mfma_f32_16x16x32_bf16 a[152:155], a[104:107], v[112:115], a[152:155]
  v_sub_f32 v237, -v173, v229
  v_mfma_f32_16x16x32_bf16 a[152:155], a[88:91], v[48:51], a[152:155]
  v_sub_f32 v238, -v174, v230
  v_mfma_f32_16x16x32_bf16 a[160:163], a[88:91], v[112:115], a[160:163]
  v_sub_f32 v239, -v175, v231
  v_mfma_f32_16x16x32_bf16 a[160:163], a[104:107], v[56:59], a[160:163]
  s_waitcnt lgkmcnt(5)
  v_sub_f32 v240, -v176, v184
  v_mfma_f32_16x16x32_bf16 a[164:167], a[108:111], v[56:59], a[164:167]
  v_sub_f32 v241, -v177, v185
  v_mfma_f32_16x16x32_bf16 a[164:167], a[92:95], v[112:115], a[164:167]
  v_sub_f32 v242, -v178, v186
  v_mfma_f32_16x16x32_bf16 a[172:175], a[92:95], v[56:59], a[172:175]
  v_sub_f32 v243, -v179, v187
  v_mfma_f32_16x16x32_bf16 a[172:175], a[108:111], v[60:63], a[172:175]
  s_mov_b32 s52, 516096
  s_waitcnt lgkmcnt(4)
  v_sub_f32 v244, -v180, v188
  v_mfma_f32_16x16x32_bf16 a[168:171], a[104:107], v[60:63], a[168:171]
  buffer_load_dwordx4 a[112:115], v13, s[12:15], s52 offen offset:0 sc1
  v_sub_f32 v245, -v181, v189
  v_mfma_f32_16x16x32_bf16 a[168:171], a[88:91], v[56:59], a[168:171]
  v_sub_f32 v246, -v182, v190
  v_mfma_f32_16x16x32_bf16 a[176:179], a[88:91], v[60:63], a[176:179]
  v_sub_f32 v247, -v183, v191
  v_mfma_f32_16x16x32_bf16 a[176:179], a[104:107], v[52:55], a[176:179]
  v_add_f32 v216, v216, v168
  v_mfma_f32_16x16x32_bf16 a[180:183], a[108:111], v[52:55], a[180:183]
  v_add_f32 v217, v217, v169
  v_mfma_f32_16x16x32_bf16 a[180:183], a[92:95], v[60:63], a[180:183]
  buffer_load_dwordx4 a[116:119], v13, s[12:15], s52 offen offset:1024 sc1
  v_add_f32 v218, v218, v170
  v_mfma_f32_16x16x32_bf16 a[188:191], a[92:95], v[52:55], a[188:191]
  v_add_f32 v219, v219, v171
  v_mfma_f32_16x16x32_bf16 a[188:191], a[108:111], v[68:71], a[188:191]
  v_add_f32 v220, v220, v172
  v_mfma_f32_16x16x32_bf16 a[184:187], a[104:107], v[68:71], a[184:187]
  v_add_f32 v221, v221, v173
  v_mfma_f32_16x16x32_bf16 a[184:187], a[88:91], v[52:55], a[184:187]
  s_waitcnt vmcnt(28)
  v_add_f32 v222, v222, v174
  v_mfma_f32_16x16x32_bf16 a[128:131], a[120:123], v[116:119], a[128:131]
  s_waitcnt vmcnt(4) lgkmcnt(0)
  s_barrier
  v_mfma_f32_16x16x32_bf16 a[128:131], a[0:3], v[48:51], a[128:131]
  ds_read_b128 v[72:75], v9 offset:35904
  v_add_f32 v223, v223, v175
  v_mfma_f32_16x16x32_bf16 a[132:135], a[4:7], v[48:51], a[132:135]
  ds_read_b128 v[80:83], v9 offset:36160
  v_add_f32 v224, v224, v176
  v_mfma_f32_16x16x32_bf16 a[132:135], a[124:127], v[116:119], a[132:135]
  v_add_f32 v225, v225, v177
  v_add_f32 v226, v226, v178
  v_mfma_f32_16x16x32_bf16 a[140:143], a[124:127], v[48:51], a[140:143]
  ds_read_b128 v[76:79], v9 offset:36416
  v_add_f32 v227, v227, v179
  v_mfma_f32_16x16x32_bf16 a[140:143], a[4:7], v[112:115], a[140:143]
  v_add_f32 v228, v228, v180
  v_mfma_f32_16x16x32_bf16 a[136:139], a[0:3], v[112:115], a[136:139]
  ds_read_b128 v[84:87], v9 offset:36672
  v_add_f32 v229, v229, v181
  v_mfma_f32_16x16x32_bf16 a[136:139], a[120:123], v[48:51], a[136:139]
  v_add_f32 v230, v230, v182
  v_mfma_f32_16x16x32_bf16 a[144:147], a[120:123], v[112:115], a[144:147]
  ds_read_b128 v[88:91], v9 offset:36928
  v_add_f32 v231, v231, v183
  v_mfma_f32_16x16x32_bf16 a[144:147], a[0:3], v[56:59], a[144:147]
  ds_read_b128 v[92:95], v9 offset:37184
  v_sub_f32 v216, v216, v152
  v_mfma_f32_16x16x32_bf16 a[148:151], a[4:7], v[56:59], a[148:151]
  v_sub_f32 v232, v232, v152
  v_mfma_f32_16x16x32_bf16 a[148:151], a[124:127], v[112:115], a[148:151]
  ds_read_b128 v[96:99], v9 offset:37440
  v_sub_f32 v217, v217, v153
  v_mfma_f32_16x16x32_bf16 a[156:159], a[124:127], v[56:59], a[156:159]
  v_sub_f32 v233, v233, v153
  v_mfma_f32_16x16x32_bf16 a[156:159], a[4:7], v[60:63], a[156:159]
  ds_read_b128 v[108:111], v9 offset:37696
  v_sub_f32 v218, v218, v154
  v_mfma_f32_16x16x32_bf16 a[152:155], a[0:3], v[60:63], a[152:155]
  v_sub_f32 v234, v234, v154
  v_mfma_f32_16x16x32_bf16 a[152:155], a[120:123], v[56:59], a[152:155]
  v_sub_f32 v219, v219, v155
  v_mfma_f32_16x16x32_bf16 a[160:163], a[120:123], v[60:63], a[160:163]
  v_sub_f32 v235, v235, v155
  v_mfma_f32_16x16x32_bf16 a[160:163], a[0:3], v[52:55], a[160:163]
  v_sub_f32 v220, v220, v156
  v_mfma_f32_16x16x32_bf16 a[164:167], a[4:7], v[52:55], a[164:167]
  v_sub_f32 v236, v236, v156
  v_mfma_f32_16x16x32_bf16 a[164:167], a[124:127], v[60:63], a[164:167]
  v_sub_f32 v221, v221, v157
  v_mfma_f32_16x16x32_bf16 a[172:175], a[124:127], v[52:55], a[172:175]
  v_sub_f32 v237, v237, v157
  v_mfma_f32_16x16x32_bf16 a[172:175], a[4:7], v[68:71], a[172:175]
  v_sub_f32 v222, v222, v158
  v_mfma_f32_16x16x32_bf16 a[168:171], a[0:3], v[68:71], a[168:171]
  v_sub_f32 v238, v238, v158
  v_mfma_f32_16x16x32_bf16 a[168:171], a[120:123], v[52:55], a[168:171]
  v_sub_f32 v223, v223, v159
  v_mfma_f32_16x16x32_bf16 a[176:179], a[120:123], v[68:71], a[176:179]
  v_sub_f32 v239, v239, v159
  v_mfma_f32_16x16x32_bf16 a[176:179], a[0:3], v[100:103], a[176:179]
  v_sub_f32 v224, v224, v152
  v_mfma_f32_16x16x32_bf16 a[180:183], a[4:7], v[100:103], a[180:183]
  v_sub_f32 v240, v240, v152
  v_mfma_f32_16x16x32_bf16 a[180:183], a[124:127], v[68:71], a[180:183]
  v_sub_f32 v225, v225, v153
  v_mfma_f32_16x16x32_bf16 a[188:191], a[124:127], v[100:103], a[188:191]
  v_sub_f32 v241, v241, v153
  v_mfma_f32_16x16x32_bf16 a[188:191], a[4:7], v[64:67], a[188:191]
  v_sub_f32 v226, v226, v154
  v_mfma_f32_16x16x32_bf16 a[184:187], a[0:3], v[64:67], a[184:187]
  v_sub_f32 v242, v242, v154
  v_mfma_f32_16x16x32_bf16 a[184:187], a[120:123], v[100:103], a[184:187]
  s_waitcnt lgkmcnt(7)
  v_sub_f32 v227, v227, v155
  v_mfma_f32_16x16x32_bf16 a[128:131], a[16:19], v[72:75], a[128:131]
  s_waitcnt lgkmcnt(6)
  v_sub_f32 v243, v243, v155
  v_mfma_f32_16x16x32_bf16 a[128:131], a[32:35], v[80:83], a[128:131]
  s_waitcnt lgkmcnt(5)
  ds_read_b128 v[104:107], v9 offset:37984
  v_sub_f32 v228, v228, v156
  v_mfma_f32_16x16x32_bf16 a[128:131], a[48:51], v[76:79], a[128:131]
  s_waitcnt lgkmcnt(5)
  v_sub_f32 v244, v244, v156
  v_mfma_f32_16x16x32_bf16 a[128:131], a[64:67], v[84:87], a[128:131]
  s_waitcnt lgkmcnt(4)
  v_sub_f32 v229, v229, v157
  v_mfma_f32_16x16x32_bf16 a[128:131], a[80:83], v[88:91], a[128:131]
  s_waitcnt lgkmcnt(3)
  ds_read_b128 v[116:119], v9 offset:38240
  v_sub_f32 v245, v245, v157
  v_mfma_f32_16x16x32_bf16 a[128:131], a[96:99], v[92:95], a[128:131]
  s_waitcnt lgkmcnt(3)
  s_waitcnt vmcnt(3)
  v_sub_f32 v230, v230, v158
  v_mfma_f32_16x16x32_bf16 a[128:131], a[192:195], v[96:99], a[128:131]
  s_waitcnt lgkmcnt(2)
  s_waitcnt vmcnt(1)
  v_sub_f32 v246, v246, v158
  v_mfma_f32_16x16x32_bf16 a[128:131], a[112:115], v[108:111], a[128:131]
  ds_read_b128 v[48:51], v9 offset:38496
  v_sub_f32 v231, v231, v159
  v_mfma_f32_16x16x32_bf16 a[144:147], a[16:19], v[76:79], a[144:147]
  v_sub_f32 v247, v247, v159
  v_mfma_f32_16x16x32_bf16 a[144:147], a[32:35], v[84:87], a[144:147]
  v_add_f32 v248, v248, v249
  v_mfma_f32_16x16x32_bf16 a[144:147], a[48:51], v[88:91], a[144:147]
  ds_read_b128 v[112:115], v9 offset:38752
  v_lshlrev_b32 v47, 16, v47
  v_mfma_f32_16x16x32_bf16 a[144:147], a[64:67], v[92:95], a[144:147]
  v_lshlrev_b32 v45, 16, v45
  v_mfma_f32_16x16x32_bf16 a[144:147], a[80:83], v[96:99], a[144:147]
  v_lshlrev_b32 v46, 16, v46
  v_mfma_f32_16x16x32_bf16 a[144:147], a[96:99], v[108:111], a[144:147]
  s_waitcnt lgkmcnt(3)
  ds_read_b128 v[56:59], v9 offset:39008
  v_add_f32 v248, v248, v47
  v_mfma_f32_16x16x32_bf16 a[144:147], a[192:195], v[104:107], a[144:147]
  s_waitcnt lgkmcnt(3)
  v_cndmask_b32 v216, 0, v216, s[64:65]
  v_mfma_f32_16x16x32_bf16 a[144:147], a[112:115], v[116:119], a[144:147]
  v_cndmask_b32 v217, 0, v217, s[64:65]
  v_mfma_f32_16x16x32_bf16 a[160:163], a[16:19], v[88:91], a[160:163]
  ds_read_b128 v[60:63], v9 offset:39264
  ds_write_b128 v23, a[128:131] offset:0
  v_mfma_f32_16x16x32_bf16 a[160:163], a[32:35], v[92:95], a[160:163]
  v_cndmask_b32 v218, 0, v218, s[64:65]
  v_cndmask_b32 v219, 0, v219, s[64:65]
  v_mfma_f32_16x16x32_bf16 a[160:163], a[48:51], v[96:99], a[160:163]
  v_cndmask_b32 v220, 0, v220, s[64:65]
  v_mfma_f32_16x16x32_bf16 a[160:163], a[64:67], v[108:111], a[160:163]
  ds_read_b128 v[52:55], v9 offset:39520
  v_cndmask_b32 v221, 0, v221, s[64:65]
  v_mfma_f32_16x16x32_bf16 a[160:163], a[80:83], v[104:107], a[160:163]
  v_cndmask_b32 v222, 0, v222, s[64:65]
  v_mfma_f32_16x16x32_bf16 a[160:163], a[96:99], v[116:119], a[160:163]
  s_waitcnt lgkmcnt(5)
  v_cndmask_b32 v223, 0, v223, s[64:65]
  v_mfma_f32_16x16x32_bf16 a[160:163], a[192:195], v[48:51], a[160:163]
  s_waitcnt lgkmcnt(4)
  v_cndmask_b32 v224, 0, v224, s[68:69]
  v_mfma_f32_16x16x32_bf16 a[160:163], a[112:115], v[112:115], a[160:163]
  v_cndmask_b32 v225, 0, v225, s[68:69]
  v_mfma_f32_16x16x32_bf16 a[176:179], a[16:19], v[96:99], a[176:179]
  ds_write_b128 v23, a[144:147] offset:4096
  v_mfma_f32_16x16x32_bf16 a[176:179], a[32:35], v[108:111], a[176:179]
  v_cndmask_b32 v226, 0, v226, s[68:69]
  v_cndmask_b32 v227, 0, v227, s[68:69]
  v_mfma_f32_16x16x32_bf16 a[176:179], a[48:51], v[104:107], a[176:179]
  v_cndmask_b32 v228, 0, v228, s[68:69]
  v_mfma_f32_16x16x32_bf16 a[176:179], a[64:67], v[116:119], a[176:179]
  v_cndmask_b32 v229, 0, v229, s[68:69]
  v_mfma_f32_16x16x32_bf16 a[176:179], a[80:83], v[48:51], a[176:179]
  v_cndmask_b32 v230, 0, v230, s[68:69]
  v_mfma_f32_16x16x32_bf16 a[176:179], a[96:99], v[112:115], a[176:179]
  s_waitcnt lgkmcnt(4)
  v_cndmask_b32 v231, 0, v231, s[68:69]
  v_mfma_f32_16x16x32_bf16 a[176:179], a[192:195], v[56:59], a[176:179]
  s_waitcnt lgkmcnt(3)
  v_add_f32 v120, v216, v224
  v_mfma_f32_16x16x32_bf16 a[176:179], a[112:115], v[60:63], a[176:179]
  v_mul_f32 v128, v216, v216
  v_mfma_f32_16x16x32_bf16 a[184:187], a[16:19], v[108:111], a[184:187]
  ds_write_b128 v23, a[160:163] offset:8192
  v_mfma_f32_16x16x32_bf16 a[184:187], a[32:35], v[104:107], a[184:187]
  v_add_f32 v121, v217, v225
  v_mul_f32 v129, v217, v217
  v_mfma_f32_16x16x32_bf16 a[184:187], a[48:51], v[116:119], a[184:187]
  v_add_f32 v122, v218, v226
  v_mfma_f32_16x16x32_bf16 a[184:187], a[64:67], v[48:51], a[184:187]
  v_mul_f32 v130, v218, v218
  v_mfma_f32_16x16x32_bf16 a[184:187], a[80:83], v[112:115], a[184:187]
  v_add_f32 v123, v219, v227
  v_mfma_f32_16x16x32_bf16 a[184:187], a[96:99], v[56:59], a[184:187]
  v_mul_f32 v131, v219, v219
  v_mfma_f32_16x16x32_bf16 a[184:187], a[192:195], v[60:63], a[184:187]
  s_waitcnt lgkmcnt(2)
  v_add_f32 v124, v220, v228
  v_mfma_f32_16x16x32_bf16 a[184:187], a[112:115], v[52:55], a[184:187]
  v_mul_f32 v132, v220, v220
  v_mfma_f32_16x16x32_bf16 a[168:171], a[16:19], v[92:95], a[168:171]
  ds_write_b128 v23, a[176:179] offset:12288
  v_mfma_f32_16x16x32_bf16 a[168:171], a[32:35], v[96:99], a[168:171]
  v_add_f32 v125, v221, v229
  v_mul_f32 v133, v221, v221
  v_mfma_f32_16x16x32_bf16 a[168:171], a[48:51], v[108:111], a[168:171]
  v_add_f32 v126, v222, v230
  v_mfma_f32_16x16x32_bf16 a[168:171], a[64:67], v[104:107], a[168:171]
  v_mul_f32 v134, v222, v222
  v_mfma_f32_16x16x32_bf16 a[168:171], a[80:83], v[116:119], a[168:171]
  v_add_f32 v127, v223, v231
  v_mfma_f32_16x16x32_bf16 a[168:171], a[96:99], v[48:51], a[168:171]
  v_mul_f32 v135, v223, v223
  v_mfma_f32_16x16x32_bf16 a[168:171], a[192:195], v[112:115], a[168:171]
  v_fmac_f32 v128, v224, v224
  v_mfma_f32_16x16x32_bf16 a[168:171], a[112:115], v[56:59], a[168:171]
  s_waitcnt lgkmcnt(0)
  s_barrier
  v_mfma_f32_16x16x32_bf16 a[152:155], a[16:19], v[84:87], a[152:155]
  ds_write_b128 v23, a[184:187] offset:14336
  v_mfma_f32_16x16x32_bf16 a[152:155], a[32:35], v[88:91], a[152:155]
  ds_read_b128 v[152:155], v21 offset:0
  v_fmac_f32 v129, v225, v225
  v_mfma_f32_16x16x32_bf16 a[152:155], a[48:51], v[92:95], a[152:155]
  ds_read_b128 v[168:171], v21 offset:21760
  v_fmac_f32 v130, v226, v226
  v_mfma_f32_16x16x32_bf16 a[152:155], a[64:67], v[96:99], a[152:155]
  ds_read_b128 v[184:187], v22 offset:0
  v_fmac_f32 v131, v227, v227
  v_mfma_f32_16x16x32_bf16 a[152:155], a[80:83], v[108:111], a[152:155]
  ds_read_b128 v[200:203], v22 offset:21760
  v_fmac_f32 v132, v228, v228
  v_mfma_f32_16x16x32_bf16 a[152:155], a[96:99], v[104:107], a[152:155]
  v_fmac_f32 v133, v229, v229
  v_fmac_f32 v134, v230, v230
  v_mfma_f32_16x16x32_bf16 a[152:155], a[192:195], v[116:119], a[152:155]
  v_fmac_f32 v135, v231, v231
  v_mov_b32 v252, 0xc0135761
  v_mfma_f32_16x16x32_bf16 a[152:155], a[112:115], v[48:51], a[152:155]
  s_waitcnt lgkmcnt(3)
  s_waitcnt lgkmcnt(2)
  v_mov_b32 v253, 0xc0135761
  v_mfma_f32_16x16x32_bf16 a[136:139], a[16:19], v[80:83], a[136:139]
  ds_write_b128 v23, a[168:171] offset:10240
  v_mfma_f32_16x16x32_bf16 a[136:139], a[32:35], v[76:79], a[136:139]
  v_add_f32 v152, v152, v168
  v_add_f32 v153, v153, v169
  v_mfma_f32_16x16x32_bf16 a[136:139], a[48:51], v[84:87], a[136:139]
  s_waitcnt lgkmcnt(2)
  s_waitcnt lgkmcnt(1)
  v_add_f32 v154, v154, v170
  v_mfma_f32_16x16x32_bf16 a[136:139], a[64:67], v[88:91], a[136:139]
  v_add_f32 v155, v155, v171
  v_add_f32 v184, v184, v200
  v_mfma_f32_16x16x32_bf16 a[136:139], a[80:83], v[92:95], a[136:139]
  v_add_f32 v185, v185, v201
  v_add_f32 v186, v186, v202
  v_mfma_f32_16x16x32_bf16 a[136:139], a[96:99], v[96:99], a[136:139]
  v_add_f32 v187, v187, v203
  v_add_f32 v232, v232, v152
  v_mfma_f32_16x16x32_bf16 a[136:139], a[192:195], v[108:111], a[136:139]
  v_add_f32 v233, v233, v153
  v_add_f32 v234, v234, v154
  v_mfma_f32_16x16x32_bf16 a[136:139], a[112:115], v[104:107], a[136:139]
  v_add_f32 v235, v235, v155
  v_add_f32 v232, v232, v184
  v_mfma_f32_16x16x32_bf16 a[132:135], a[20:23], v[72:75], a[132:135]
  ds_write_b128 v23, a[152:155] offset:6144
  v_add_f32 v233, v233, v185
  v_add_f32 v234, v234, v186
  v_add_f32 v235, v235, v187
  v_mfma_f32_16x16x32_bf16 a[132:135], a[36:39], v[80:83], a[132:135]
  s_mov_b64 exec, s[66:67]
  v_add_f32 v120, v120, v232
  v_fmac_f32 v128, v232, v232
  s_mov_b64 exec, -1
  v_mfma_f32_16x16x32_bf16 a[132:135], a[52:55], v[76:79], a[132:135]
  s_mov_b64 exec, s[66:67]
  v_add_f32 v121, v121, v233
  v_fmac_f32 v129, v233, v233
  s_mov_b64 exec, -1
  v_mfma_f32_16x16x32_bf16 a[132:135], a[68:71], v[84:87], a[132:135]
  s_mov_b64 exec, s[66:67]
  v_add_f32 v122, v122, v234
  v_fmac_f32 v130, v234, v234
  s_mov_b64 exec, -1
  v_mfma_f32_16x16x32_bf16 a[132:135], a[84:87], v[88:91], a[132:135]
  s_mov_b64 exec, s[66:67]
  v_add_f32 v123, v123, v235
  v_fmac_f32 v131, v235, v235
  s_mov_b64 exec, -1
  v_mfma_f32_16x16x32_bf16 a[132:135], a[100:103], v[92:95], a[132:135]
  v_mfma_f32_16x16x32_bf16 a[132:135], a[196:199], v[96:99], a[132:135]
  s_waitcnt vmcnt(0)
  v_mfma_f32_16x16x32_bf16 a[132:135], a[116:119], v[108:111], a[132:135]
  v_mfma_f32_16x16x32_bf16 a[148:151], a[20:23], v[76:79], a[148:151]
  ds_write_b128 v23, a[136:139] offset:2048
  v_mfma_f32_16x16x32_bf16 a[148:151], a[36:39], v[84:87], a[148:151]
  v_mfma_f32_16x16x32_bf16 a[148:151], a[52:55], v[88:91], a[148:151]
  v_mfma_f32_16x16x32_bf16 a[148:151], a[68:71], v[92:95], a[148:151]
  v_mfma_f32_16x16x32_bf16 a[148:151], a[84:87], v[96:99], a[148:151]
  v_mfma_f32_16x16x32_bf16 a[148:151], a[100:103], v[108:111], a[148:151]
  v_mfma_f32_16x16x32_bf16 a[148:151], a[196:199], v[104:107], a[148:151]
  v_mfma_f32_16x16x32_bf16 a[148:151], a[116:119], v[116:119], a[148:151]
  s_waitcnt lgkmcnt(0)
  s_barrier
  v_mfma_f32_16x16x32_bf16 a[164:167], a[20:23], v[88:91], a[164:167]
  ds_write_b128 v23, a[132:135] offset:1024
  v_mfma_f32_16x16x32_bf16 a[164:167], a[36:39], v[92:95], a[164:167]
  ds_read_b128 v[160:163], v21 offset:2048
  ds_read_b128 v[176:179], v21 offset:23808
  v_mfma_f32_16x16x32_bf16 a[164:167], a[52:55], v[96:99], a[164:167]
  ds_read_b128 v[192:195], v22 offset:2048
  v_mfma_f32_16x16x32_bf16 a[164:167], a[68:71], v[108:111], a[164:167]
  ds_read_b128 v[208:211], v22 offset:23808
  v_mfma_f32_16x16x32_bf16 a[164:167], a[84:87], v[104:107], a[164:167]
  v_mfma_f32_16x16x32_bf16 a[164:167], a[100:103], v[116:119], a[164:167]
  v_mfma_f32_16x16x32_bf16 a[164:167], a[196:199], v[48:51], a[164:167]
  v_mfma_f32_16x16x32_bf16 a[164:167], a[116:119], v[112:115], a[164:167]
  s_waitcnt lgkmcnt(3)
  s_waitcnt lgkmcnt(2)
  v_add_f32 v160, v160, v176
  v_mfma_f32_16x16x32_bf16 a[180:183], a[20:23], v[96:99], a[180:183]
  s_mov_b32 s84, 1.0
  ds_write_b128 v23, a[148:151] offset:5120
  v_mfma_f32_16x16x32_bf16 a[180:183], a[36:39], v[108:111], a[180:183]
  s_mov_b32 s85, 1.0
  v_add_f32 v161, v161, v177
  v_add_f32 v162, v162, v178
  v_mfma_f32_16x16x32_bf16 a[180:183], a[52:55], v[104:107], a[180:183]
  s_waitcnt lgkmcnt(2)
  s_waitcnt lgkmcnt(1)
  v_add_f32 v163, v163, v179
  v_mfma_f32_16x16x32_bf16 a[180:183], a[68:71], v[116:119], a[180:183]
  v_add_f32 v192, v192, v208
  v_add_f32 v193, v193, v209
  v_mfma_f32_16x16x32_bf16 a[180:183], a[84:87], v[48:51], a[180:183]
  v_add_f32 v194, v194, v210
  v_add_f32 v195, v195, v211
  v_mfma_f32_16x16x32_bf16 a[180:183], a[100:103], v[112:115], a[180:183]
  v_add_f32 v240, v240, v160
  v_add_f32 v241, v241, v161
  v_mfma_f32_16x16x32_bf16 a[180:183], a[196:199], v[56:59], a[180:183]
  v_add_f32 v242, v242, v162
  v_add_f32 v243, v243, v163
  v_mfma_f32_16x16x32_bf16 a[180:183], a[116:119], v[60:63], a[180:183]
  v_add_f32 v240, v240, v192
  v_add_f32 v241, v241, v193
  v_mfma_f32_16x16x32_bf16 a[188:191], a[20:23], v[108:111], a[188:191]
  ds_write_b128 v23, a[164:167] offset:9216
  v_add_f32 v242, v242, v194
  v_add_f32 v243, v243, v195
  v_mfma_f32_16x16x32_bf16 a[188:191], a[36:39], v[104:107], a[188:191]
  s_mov_b64 exec, s[70:71]
  v_add_f32 v120, v120, v240
  v_fmac_f32 v128, v240, v240
  s_mov_b64 exec, -1
  v_mfma_f32_16x16x32_bf16 a[188:191], a[52:55], v[116:119], a[188:191]
  s_mov_b64 exec, s[70:71]
  v_add_f32 v121, v121, v241
  v_fmac_f32 v129, v241, v241
  s_mov_b64 exec, -1
  v_mfma_f32_16x16x32_bf16 a[188:191], a[68:71], v[48:51], a[188:191]
  s_mov_b64 exec, s[70:71]
  v_add_f32 v122, v122, v242
  v_fmac_f32 v130, v242, v242
  s_mov_b64 exec, -1
  v_mfma_f32_16x16x32_bf16 a[188:191], a[84:87], v[112:115], a[188:191]
  s_mov_b64 exec, s[70:71]
  v_add_f32 v123, v123, v243
  v_fmac_f32 v131, v243, v243
  s_mov_b64 exec, -1
  v_mfma_f32_16x16x32_bf16 a[188:191], a[100:103], v[56:59], a[188:191]
  s_nop 0
  v_add_f32_dpp v120, v120, v120 row_ror:8 row_mask:0xf bank_mask:0x3
  v_mfma_f32_16x16x32_bf16 a[188:191], a[196:199], v[60:63], a[188:191]
  v_add_f32_dpp v121, v121, v121 row_ror:8 row_mask:0xf bank_mask:0x3
  v_add_f32_dpp v122, v122, v122 row_ror:8 row_mask:0xf bank_mask:0x3
  v_mfma_f32_16x16x32_bf16 a[188:191], a[116:119], v[52:55], a[188:191]
  v_add_f32_dpp v123, v123, v123 row_ror:8 row_mask:0xf bank_mask:0x3
  v_add_f32_dpp v120, v128, v128 row_ror:8 row_mask:0xf bank_mask:0xc
  v_mfma_f32_16x16x32_bf16 a[172:175], a[20:23], v[92:95], a[172:175]
  ds_write_b128 v23, a[180:183] offset:13312
  v_add_f32_dpp v121, v129, v129 row_ror:8 row_mask:0xf bank_mask:0xc
  v_mfma_f32_16x16x32_bf16 a[172:175], a[36:39], v[96:99], a[172:175]
  v_add_f32_dpp v122, v130, v130 row_ror:8 row_mask:0xf bank_mask:0xc
  v_add_f32_dpp v123, v131, v131 row_ror:8 row_mask:0xf bank_mask:0xc
  v_mfma_f32_16x16x32_bf16 a[172:175], a[52:55], v[108:111], a[172:175]
  v_add_f32_dpp v120, v120, v120 row_half_mirror row_mask:0xf bank_mask:0x5
  v_add_f32_dpp v121, v121, v121 row_half_mirror row_mask:0xf bank_mask:0x5
  v_mfma_f32_16x16x32_bf16 a[172:175], a[68:71], v[104:107], a[172:175]
  v_add_f32_dpp v122, v122, v122 row_half_mirror row_mask:0xf bank_mask:0x5
  v_add_f32_dpp v123, v123, v123 row_half_mirror row_mask:0xf bank_mask:0x5
  s_waitcnt lgkmcnt(0)
  s_barrier
  v_mfma_f32_16x16x32_bf16 a[172:175], a[84:87], v[116:119], a[172:175]
  ds_read_b128 v[156:159], v21 offset:1024
  v_mfma_f32_16x16x32_bf16 a[172:175], a[100:103], v[48:51], a[172:175]
  ds_read_b128 v[172:175], v21 offset:22784
  v_mfma_f32_16x16x32_bf16 a[172:175], a[196:199], v[112:115], a[172:175]
  ds_read_b128 v[188:191], v22 offset:1024
  v_mfma_f32_16x16x32_bf16 a[172:175], a[116:119], v[56:59], a[172:175]
  ds_read_b128 v[204:207], v22 offset:22784
  v_mfma_f32_16x16x32_bf16 a[156:159], a[20:23], v[84:87], a[156:159]
  ds_write_b32 v23, a188 offset:15360
  v_mfma_f32_16x16x32_bf16 a[156:159], a[36:39], v[88:91], a[156:159]
  v_mfma_f32_16x16x32_bf16 a[156:159], a[52:55], v[92:95], a[156:159]
  ds_write_b32 v23, a189 offset:15364
  v_mfma_f32_16x16x32_bf16 a[156:159], a[68:71], v[96:99], a[156:159]
  v_mfma_f32_16x16x32_bf16 a[156:159], a[84:87], v[108:111], a[156:159]
  ds_write_b32 v23, a190 offset:15368
  v_mfma_f32_16x16x32_bf16 a[156:159], a[100:103], v[104:107], a[156:159]
  v_mfma_f32_16x16x32_bf16 a[156:159], a[196:199], v[116:119], a[156:159]
  ds_write_b32 v23, a191 offset:15372
  v_mfma_f32_16x16x32_bf16 a[156:159], a[116:119], v[48:51], a[156:159]
  v_mfma_f32_16x16x32_bf16 a[140:143], a[20:23], v[80:83], a[140:143]
  ds_write_b32 v23, a172 offset:11264
  v_mfma_f32_16x16x32_bf16 a[140:143], a[36:39], v[76:79], a[140:143]
  v_mfma_f32_16x16x32_bf16 a[140:143], a[52:55], v[84:87], a[140:143]
  ds_write_b32 v23, a173 offset:11268
  v_mfma_f32_16x16x32_bf16 a[140:143], a[68:71], v[88:91], a[140:143]
  v_mfma_f32_16x16x32_bf16 a[140:143], a[84:87], v[92:95], a[140:143]
  ds_write_b32 v23, a174 offset:11272
  v_mfma_f32_16x16x32_bf16 a[140:143], a[100:103], v[96:99], a[140:143]
  v_mfma_f32_16x16x32_bf16 a[140:143], a[196:199], v[108:111], a[140:143]
  ds_write_b32 v23, a175 offset:11276
  v_mfma_f32_16x16x32_bf16 a[140:143], a[116:119], v[104:107], a[140:143]
  ds_write_b128 v23, a[156:159] offset:7168
  s_nop 6
  ds_write_b128 v23, a[140:143] offset:3072
  s_waitcnt lgkmcnt(0)
  s_barrier
  ds_read_b128 v[164:167], v21 offset:3072
  ds_read_b128 v[180:183], v21 offset:24832
  ds_read_b128 v[196:199], v22 offset:3072
  ds_read_b128 v[212:215], v22 offset:24832
  v_pk_add_f32 v[156:157], v[156:157], v[172:173]
  v_pk_add_f32 v[188:189], v[188:189], v[204:205]
  v_pk_add_f32 v[158:159], v[158:159], v[174:175]
  v_pk_add_f32 v[190:191], v[190:191], v[206:207]
  v_pk_add_f32 v[236:237], v[236:237], v[156:157]
  v_pk_add_f32 v[238:239], v[238:239], v[158:159]
  v_pk_add_f32 v[236:237], v[236:237], v[188:189]
  v_pk_add_f32 v[238:239], v[238:239], v[190:191]
  s_mov_b64 exec, s[66:67]
  v_pk_add_f32 v[124:125], v[124:125], v[236:237]
  v_pk_fma_f32 v[132:133], v[236:237], v[236:237], v[132:133]
  v_pk_add_f32 v[126:127], v[126:127], v[238:239]
  v_pk_fma_f32 v[134:135], v[238:239], v[238:239], v[134:135]
  s_mov_b64 exec, -1
  s_waitcnt lgkmcnt(3)
  s_waitcnt lgkmcnt(2)
  v_pk_add_f32 v[164:165], v[164:165], v[180:181]
  s_waitcnt lgkmcnt(1)
  s_waitcnt lgkmcnt(0)
  v_pk_add_f32 v[196:197], v[196:197], v[212:213]
  v_pk_add_f32 v[166:167], v[166:167], v[182:183]
  v_pk_add_f32 v[198:199], v[198:199], v[214:215]
  v_pk_add_f32 v[244:245], v[244:245], v[164:165]
  v_pk_add_f32 v[246:247], v[246:247], v[166:167]
  v_pk_add_f32 v[244:245], v[244:245], v[196:197]
  v_pk_add_f32 v[246:247], v[246:247], v[198:199]
  s_mov_b64 exec, s[70:71]
  v_pk_add_f32 v[124:125], v[124:125], v[244:245]
  v_pk_fma_f32 v[132:133], v[244:245], v[244:245], v[132:133]
  v_pk_add_f32 v[126:127], v[126:127], v[246:247]
  v_pk_fma_f32 v[134:135], v[246:247], v[246:247], v[134:135]
  s_mov_b64 exec, -1
  s_nop 0
  v_add_f32_dpp v124, v124, v124 row_ror:8 row_mask:0xf bank_mask:0x3
  v_add_f32_dpp v125, v125, v125 row_ror:8 row_mask:0xf bank_mask:0x3
  v_add_f32_dpp v126, v126, v126 row_ror:8 row_mask:0xf bank_mask:0x3
  v_add_f32_dpp v127, v127, v127 row_ror:8 row_mask:0xf bank_mask:0x3
  v_add_f32_dpp v124, v132, v132 row_ror:8 row_mask:0xf bank_mask:0xc
  v_add_f32_dpp v125, v133, v133 row_ror:8 row_mask:0xf bank_mask:0xc
  v_add_f32_dpp v126, v134, v134 row_ror:8 row_mask:0xf bank_mask:0xc
  v_add_f32_dpp v127, v135, v135 row_ror:8 row_mask:0xf bank_mask:0xc
  v_add_f32_dpp v120, v124, v124 row_half_mirror row_mask:0xf bank_mask:0xa
  v_add_f32_dpp v121, v125, v125 row_half_mirror row_mask:0xf bank_mask:0xa
  v_add_f32_dpp v122, v126, v126 row_half_mirror row_mask:0xf bank_mask:0xa
  v_add_f32_dpp v123, v127, v127 row_half_mirror row_mask:0xf bank_mask:0xa
  v_add_f32_dpp v120, v120, v120 quad_perm:[1,0,3,2] row_mask:0xf bank_mask:0xf
  v_add_f32_dpp v121, v121, v121 quad_perm:[1,0,3,2] row_mask:0xf bank_mask:0xf
  v_add_f32_dpp v122, v122, v122 quad_perm:[1,0,3,2] row_mask:0xf bank_mask:0xf
  v_add_f32_dpp v123, v123, v123 quad_perm:[1,0,3,2] row_mask:0xf bank_mask:0xf
  v_add_f32_dpp v120, v120, v120 quad_perm:[2,3,0,1] row_mask:0xf bank_mask:0xf
  v_add_f32_dpp v121, v121, v121 quad_perm:[2,3,0,1] row_mask:0xf bank_mask:0xf
  v_add_f32_dpp v122, v122, v122 quad_perm:[2,3,0,1] row_mask:0xf bank_mask:0xf
  v_add_f32_dpp v123, v123, v123 quad_perm:[2,3,0,1] row_mask:0xf bank_mask:0xf
  s_mov_b32 exec_lo, 0x11111111
  s_mov_b32 exec_hi, 0x11111111
  ds_write_b128 v39, v[120:123]
  s_mov_b64 exec, -1
  s_waitcnt lgkmcnt(0)
  s_barrier
  ds_read2_b32 v[152:153], v40 offset0:0 offset1:8
  ds_read2_b32 v[154:155], v40 offset0:64 offset1:72
  ds_read2_b32 v[156:157], v40 offset0:128 offset1:136
  ds_read2_b32 v[158:159], v40 offset0:192 offset1:200
  s_waitcnt lgkmcnt(0)
  v_pk_add_f32 v[152:153], v[152:153], v[154:155]
  v_pk_add_f32 v[156:157], v[156:157], v[158:159]
  v_pk_add_f32 v[152:153], v[152:153], v[156:157]
  v_mul_f32 v154, s73, v152
  v_fma_f32 v157, -v152, v154, v153
  v_add_f32 v156, v248, v154
  v_max_f32 v157, 0, v157
  buffer_store_dwordx2 v[156:157], v35, s[12:15], 0 offen sc1
  s_cmp_lg_u32 s28, 0
  s_cbranch_scc1 L_wab
  buffer_load_dwordx2 v[160:161], v36, s[12:15], 0 offen offset:0 sc1
  buffer_load_dwordx2 v[162:163], v36, s[12:15], 0 offen offset:256 sc1
  buffer_load_dwordx2 v[164:165], v36, s[12:15], 0 offen offset:512 sc1
  buffer_load_dwordx2 v[166:167], v36, s[12:15], 0 offen offset:768 sc1
  s_mov_b32 s74, 0x4000
L_poll3:
  s_waitcnt vmcnt(0)
  v_max3_u32 v152, v161, v163, v165
  v_max_u32 v152, v152, v167
  v_cmp_eq_u32 vcc, -1, v152
  s_nop 3
  s_cbranch_vccz L_got3_0
  buffer_load_dwordx2 v[160:161], v36, s[12:15], 0 offen offset:0 sc1
  buffer_load_dwordx2 v[162:163], v36, s[12:15], 0 offen offset:256 sc1
  buffer_load_dwordx2 v[164:165], v36, s[12:15], 0 offen offset:512 sc1
  buffer_load_dwordx2 v[166:167], v36, s[12:15], 0 offen offset:768 sc1
  s_sub_u32 s74, s74, 1
  s_cmp_lg_u32 s74, 0
  s_cbranch_scc1 L_poll3
  s_waitcnt vmcnt(0)
  s_branch L_got3_0
L_got3_0:
  v_mov_b32 v88, v160
  v_mov_b32 v89, v161
  v_mov_b32 v90, v162
  v_mov_b32 v91, v163
  v_mov_b32 v92, v164
  v_mov_b32 v93, v165
  v_mov_b32 v94, v166
  v_mov_b32 v95, v167
L_got3_c:
  v_add_f32 v152, v88, v90
  v_add_f32 v152, v152, v92
  v_mul_f32 v152, s86, v152
  v_fmac_f32 v152, v44, v94
  v_add_f32 v154, v89, v91
  v_mov_b32 v153, v152
  v_add_f32 v155, v93, v95
  v_add_f32 v154, v154, v155
  v_permlane32_swap_b32 v152, v153
  v_mul_f32 v154, s87, v154
  v_add_f32 v152, v152, v153
  v_sub_f32 v88, v88, v152
  v_sub_f32 v90, v90, v152
  v_sub_f32 v92, v92, v152
  v_sub_f32 v94, v94, v152
  v_mul_f32 v155, v88, v88
  v_fmac_f32 v155, v90, v90
  v_fmac_f32 v155, v92, v92
  v_mul_f32 v156, v44, v94
  v_fma_f32 v154, s86, v155, v154
  v_fmac_f32 v154, v156, v94
  v_sub_f32 v156, v248, v152
  v_mov_b32 v155, v154
  s_nop 1
  v_permlane32_swap_b32 v154, v155
  v_add_f32 v154, v154, v155
  v_add_f32 v154, 0x3727c5ac, v154
  v_rsq_f32 v154, v154
  s_nop 0
  v_mul_f32 v154, v45, v154
  v_fma_f32 v155, v156, v154, v46
  ds_write2_b32 v41, v154, v155 offset0:0 offset1:32
  s_waitcnt lgkmcnt(0)
L_wab:
  s_barrier
  ds_read_b128 v[168:171], v42
  ds_read_b128 v[172:175], v42 offset:16
  ds_read_b128 v[176:179], v42 offset:128
  ds_read_b128 v[180:183], v42 offset:144
  s_waitcnt lgkmcnt(0)
  v_pk_fma_f32 v[216:217], v[216:217], v[168:169], v[176:177]
  v_pk_fma_f32 v[218:219], v[218:219], v[170:171], v[178:179]
  v_pk_fma_f32 v[220:221], v[220:221], v[172:173], v[180:181]
  v_pk_fma_f32 v[222:223], v[222:223], v[174:175], v[182:183]
  v_pk_mul_f32 v[184:185], v[216:217], v[216:217]
  v_pk_mul_f32 v[186:187], v[218:219], v[218:219]
  v_pk_mul_f32 v[188:189], v[220:221], v[220:221]
  v_pk_mul_f32 v[190:191], v[222:223], v[222:223]
  v_pk_fma_f32 v[184:185], v[184:185], s[82:83], v[252:253]
  v_pk_fma_f32 v[186:187], v[186:187], s[82:83], v[252:253]
  v_pk_fma_f32 v[188:189], v[188:189], s[82:83], v[252:253]
  v_pk_fma_f32 v[190:191], v[190:191], s[82:83], v[252:253]
  v_pk_mul_f32 v[184:185], v[184:185], v[216:217]
  v_pk_mul_f32 v[186:187], v[186:187], v[218:219]
  v_pk_mul_f32 v[188:189], v[188:189], v[220:221]
  v_pk_mul_f32 v[190:191], v[190:191], v[222:223]
  v_exp_f32 v184, v184
  v_exp_f32 v185, v185
  v_exp_f32 v186, v186
  v_exp_f32 v187, v187
  v_exp_f32 v188, v188
  v_exp_f32 v189, v189
  v_exp_f32 v190, v190
  v_exp_f32 v191, v191
  v_pk_add_f32 v[184:185], v[184:185], s[84:85]
  v_pk_add_f32 v[186:187], v[186:187], s[84:85]
  v_pk_add_f32 v[188:189], v[188:189], s[84:85]
  v_pk_add_f32 v[190:191], v[190:191], s[84:85]
  v_rcp_f32 v184, v184
  v_rcp_f32 v185, v185
  v_rcp_f32 v186, v186
  v_rcp_f32 v187, v187
  v_rcp_f32 v188, v188
  v_rcp_f32 v189, v189
  v_rcp_f32 v190, v190
  v_rcp_f32 v191, v191
  v_pk_mul_f32 v[184:185], v[184:185], v[216:217]
  v_pk_mul_f32 v[186:187], v[186:187], v[218:219]
  v_pk_mul_f32 v[188:189], v[188:189], v[220:221]
  v_pk_mul_f32 v[190:191], v[190:191], v[222:223]
  v_cvt_pk_bf16_f32 v200, v184, v185
  v_cvt_pk_bf16_f32 v201, v186, v187
  v_cvt_pk_bf16_f32 v202, v188, v189
  v_cvt_pk_bf16_f32 v203, v190, v191
  buffer_store_dwordx4 v[200:203], v43, s[16:19], s72 offen offset:0 sc0 sc1
  v_pk_fma_f32 v[232:233], v[232:233], v[168:169], v[176:177]
  v_pk_fma_f32 v[234:235], v[234:235], v[170:171], v[178:179]
  v_pk_fma_f32 v[236:237], v[236:237], v[172:173], v[180:181]
  v_pk_fma_f32 v[238:239], v[238:239], v[174:175], v[182:183]
  v_pk_mul_f32 v[192:193], v[232:233], v[232:233]
  v_pk_mul_f32 v[194:195], v[234:235], v[234:235]
  v_pk_mul_f32 v[196:197], v[236:237], v[236:237]
  v_pk_mul_f32 v[198:199], v[238:239], v[238:239]
  v_pk_fma_f32 v[192:193], v[192:193], s[82:83], v[252:253]
  v_pk_fma_f32 v[194:195], v[194:195], s[82:83], v[252:253]
  v_pk_fma_f32 v[196:197], v[196:197], s[82:83], v[252:253]
  v_pk_fma_f32 v[198:199], v[198:199], s[82:83], v[252:253]
  v_pk_mul_f32 v[192:193], v[192:193], v[232:233]
  v_pk_mul_f32 v[194:195], v[194:195], v[234:235]
  v_pk_mul_f32 v[196:197], v[196:197], v[236:237]
  v_pk_mul_f32 v[198:199], v[198:199], v[238:239]
  v_exp_f32 v192, v192
  v_exp_f32 v193, v193
  v_exp_f32 v194, v194
  v_exp_f32 v195, v195
  v_exp_f32 v196, v196
  v_exp_f32 v197, v197
  v_exp_f32 v198, v198
  v_exp_f32 v199, v199
  v_pk_add_f32 v[192:193], v[192:193], s[84:85]
  v_pk_add_f32 v[194:195], v[194:195], s[84:85]
  v_pk_add_f32 v[196:197], v[196:197], s[84:85]
  v_pk_add_f32 v[198:199], v[198:199], s[84:85]
  v_rcp_f32 v192, v192
  v_rcp_f32 v193, v193
  v_rcp_f32 v194, v194
  v_rcp_f32 v195, v195
  v_rcp_f32 v196, v196
  v_rcp_f32 v197, v197
  v_rcp_f32 v198, v198
  v_rcp_f32 v199, v199
  v_pk_mul_f32 v[192:193], v[192:193], v[232:233]
  v_pk_mul_f32 v[194:195], v[194:195], v[234:235]
  v_pk_mul_f32 v[196:197], v[196:197], v[236:237]
  v_pk_mul_f32 v[198:199], v[198:199], v[238:239]
  v_cvt_pk_bf16_f32 v204, v192, v193
  v_cvt_pk_bf16_f32 v205, v194, v195
  v_cvt_pk_bf16_f32 v206, v196, v197
  v_cvt_pk_bf16_f32 v207, v198, v199
  buffer_store_dwordx4 v[204:207], v43, s[16:19], s72 offen offset:1024 sc0 sc1
  v_pk_fma_f32 v[224:225], v[224:225], v[168:169], v[176:177]
  v_pk_fma_f32 v[226:227], v[226:227], v[170:171], v[178:179]
  v_pk_fma_f32 v[228:229], v[228:229], v[172:173], v[180:181]
  v_pk_fma_f32 v[230:231], v[230:231], v[174:175], v[182:183]
  v_pk_mul_f32 v[184:185], v[224:225], v[224:225]
  v_pk_mul_f32 v[186:187], v[226:227], v[226:227]
  v_pk_mul_f32 v[188:189], v[228:229], v[228:229]
  v_pk_mul_f32 v[190:191], v[230:231], v[230:231]
  v_pk_fma_f32 v[184:185], v[184:185], s[82:83], v[252:253]
  v_pk_fma_f32 v[186:187], v[186:187], s[82:83], v[252:253]
  v_pk_fma_f32 v[188:189], v[188:189], s[82:83], v[252:253]
  v_pk_fma_f32 v[190:191], v[190:191], s[82:83], v[252:253]
  v_pk_mul_f32 v[184:185], v[184:185], v[224:225]
  v_pk_mul_f32 v[186:187], v[186:187], v[226:227]
  v_pk_mul_f32 v[188:189], v[188:189], v[228:229]
  v_pk_mul_f32 v[190:191], v[190:191], v[230:231]
  v_exp_f32 v184, v184
  v_exp_f32 v185, v185
  v_exp_f32 v186, v186
  v_exp_f32 v187, v187
  v_exp_f32 v188, v188
  v_exp_f32 v189, v189
  v_exp_f32 v190, v190
  v_exp_f32 v191, v191
  v_pk_add_f32 v[184:185], v[184:185], s[84:85]
  v_pk_add_f32 v[186:187], v[186:187], s[84:85]
  v_pk_add_f32 v[188:189], v[188:189], s[84:85]
  v_pk_add_f32 v[190:191], v[190:191], s[84:85]
  v_rcp_f32 v184, v184
  v_rcp_f32 v185, v185
  v_rcp_f32 v186, v186
  v_rcp_f32 v187, v187
  v_rcp_f32 v188, v188
  v_rcp_f32 v189, v189
  v_rcp_f32 v190, v190
  v_rcp_f32 v191, v191
  v_pk_mul_f32 v[184:185], v[184:185], v[224:225]
  v_pk_mul_f32 v[186:187], v[186:187], v[226:227]
  v_pk_mul_f32 v[188:189], v[188:189], v[228:229]
  v_pk_mul_f32 v[190:191], v[190:191], v[230:231]
  v_cvt_pk_bf16_f32 v208, v184, v185
  v_cvt_pk_bf16_f32 v209, v186, v187
  v_cvt_pk_bf16_f32 v210, v188, v189
  v_cvt_pk_bf16_f32 v211, v190, v191
  buffer_store_dwordx4 v[208:211], v43, s[16:19], s72 offen offset:2048 sc0 sc1
  v_pk_fma_f32 v[240:241], v[240:241], v[168:169], v[176:177]
  v_pk_fma_f32 v[242:243], v[242:243], v[170:171], v[178:179]
  v_pk_fma_f32 v[244:245], v[244:245], v[172:173], v[180:181]
  v_pk_fma_f32 v[246:247], v[246:247], v[174:175], v[182:183]
  v_pk_mul_f32 v[192:193], v[240:241], v[240:241]
  v_pk_mul_f32 v[194:195], v[242:243], v[242:243]
  v_pk_mul_f32 v[196:197], v[244:245], v[244:245]
  v_pk_mul_f32 v[198:199], v[246:247], v[246:247]
  v_pk_fma_f32 v[192:193], v[192:193], s[82:83], v[252:253]
  v_pk_fma_f32 v[194:195], v[194:195], s[82:83], v[252:253]
  v_pk_fma_f32 v[196:197], v[196:197], s[82:83], v[252:253]
  v_pk_fma_f32 v[198:199], v[198:199], s[82:83], v[252:253]
  v_pk_mul_f32 v[192:193], v[192:193], v[240:241]
  v_pk_mul_f32 v[194:195], v[194:195], v[242:243]
  v_pk_mul_f32 v[196:197], v[196:197], v[244:245]
  v_pk_mul_f32 v[198:199], v[198:199], v[246:247]
  v_exp_f32 v192, v192
  v_exp_f32 v193, v193
  v_exp_f32 v194, v194
  v_exp_f32 v195, v195
  v_exp_f32 v196, v196
  v_exp_f32 v197, v197
  v_exp_f32 v198, v198
  v_exp_f32 v199, v199
  v_pk_add_f32 v[192:193], v[192:193], s[84:85]
  v_pk_add_f32 v[194:195], v[194:195], s[84:85]
  v_pk_add_f32 v[196:197], v[196:197], s[84:85]
  v_pk_add_f32 v[198:199], v[198:199], s[84:85]
  v_rcp_f32 v192, v192
  v_rcp_f32 v193, v193
  v_rcp_f32 v194, v194
  v_rcp_f32 v195, v195
  v_rcp_f32 v196, v196
  v_rcp_f32 v197, v197
  v_rcp_f32 v198, v198
  v_rcp_f32 v199, v199
  v_pk_mul_f32 v[192:193], v[192:193], v[240:241]
  v_pk_mul_f32 v[194:195], v[194:195], v[242:243]
  v_pk_mul_f32 v[196:197], v[196:197], v[244:245]
  v_pk_mul_f32 v[198:199], v[198:199], v[246:247]
  v_cvt_pk_bf16_f32 v212, v192, v193
  v_cvt_pk_bf16_f32 v213, v194, v195
  v_cvt_pk_bf16_f32 v214, v196, v197
  v_cvt_pk_bf16_f32 v215, v198, v199
  buffer_store_dwordx4 v[212:215], v43, s[16:19], s72 offen offset:3072 sc0 sc1
  s_branch L_end
L_slow_non:
  s_mov_b32 s75, 0x8000
L_spin_non:
  buffer_load_dwordx2 v[240:241], off, s[20:23], 0 sc1
  s_waitcnt vmcnt(0)
  v_readfirstlane_b32 s26, v240
  v_readfirstlane_b32 s27, v241
  s_nop 3
  s_cmp_lg_u32 s26, 0
  s_cbranch_scc1 L_back_non
  s_sleep 4
  s_sub_u32 s75, s75, 1
  s_cmp_lg_u32 s75, 0
  s_cbranch_scc1 L_spin_non
  s_branch L_back_non
L_slow_p1:
  s_mov_b32 s75, 0x8000
L_spin_p1:
  buffer_load_dwordx2 v[250:251], v20, s[12:15], 0 offen offset:0 sc1
  s_waitcnt vmcnt(0)
  v_cmp_ne_u64 vcc, s[26:27], v[250:251]
  s_nop 3
  s_cbranch_vccz L_back_p1
  s_sleep 4
  s_sub_u32 s75, s75, 1
  s_cmp_lg_u32 s75, 0
  s_cbranch_scc1 L_spin_p1
  s_branch L_back_p1
L_slow_p1b:
  s_mov_b32 s75, 0x8000
L_spin_p1b:
  buffer_load_dwordx2 v[250:251], v20, s[12:15], 0 offen offset:8 sc1
  s_waitcnt vmcnt(0)
  v_cmp_ne_u64 vcc, s[26:27], v[250:251]
  s_nop 3
  s_cbranch_vccz L_back_p1b
  s_sleep 4
  s_sub_u32 s75, s75, 1
  s_cmp_lg_u32 s75, 0
  s_cbranch_scc1 L_spin_p1b
  s_branch L_back_p1b
L_slow_p2:
  s_mov_b32 s75, 0x8000
L_spin_p2:
  buffer_load_dwordx2 v[250:251], v38, s[12:15], 0 offen sc1
  s_waitcnt vmcnt(0)
  v_cmp_ne_u64 vcc, s[26:27], v[250:251]
  s_nop 3
  s_cbranch_vccz L_back_p2
  s_sleep 4
  s_sub_u32 s75, s75, 1
  s_cmp_lg_u32 s75, 0
  s_cbranch_scc1 L_spin_p2
  s_branch L_back_p2
L_end:
s_endpgm
.section .rodata,"a"
.p2align 6
.amdhsa_kernel standalone__self_sup_conv_stem_hubert__speech_kernel
  .amdhsa_next_free_vgpr 512
  .amdhsa_next_free_sgpr 102
  .amdhsa_accum_offset 256
  .amdhsa_group_segment_fixed_size 0
  .amdhsa_kernarg_size 64
  .amdhsa_user_sgpr_count 2
  .amdhsa_user_sgpr_kernarg_segment_ptr 1
  .amdhsa_system_sgpr_workgroup_id_x 1
.end_amdhsa_kernel
```
